```python
import torch

def _softmax(x, axis=-1):
    return torch.softmax(x, dim=axis)
def _gelu(x):
    return torch.nn.functional.gelu(x, approximate="tanh")
def _silu(x):
    return torch.nn.functional.silu(x)
def _sigmoid(x):
    return torch.sigmoid(x)
def _layernorm(x, axis=-1, eps=1e-5):
    m = x.mean(dim=axis, keepdim=True)
    v = x.var(dim=axis, keepdim=True, unbiased=False)
    return (x - m) / torch.sqrt(v + eps)
def _scatter_add(tgt, idx, src, axis=0):
    return tgt.clone().index_add_(axis, idx, src)
def _segment_sum(src, seg, n):
    out = torch.zeros((n,) + src.shape[1:], dtype=src.dtype)
    return out.index_add_(0, seg, src)
def _pad(x, pw):
    flat = tuple(v for pair in reversed(pw) for v in pair)
    return torch.nn.functional.pad(x, flat)

kernel_name = 'interleave_layers__ssm_conv_h3__sliding_local_dilated__prompt'

def setup_inputs():

    _w = (lambda a: (lambda t: t.to(torch.bfloat16) if t.is_floating_point() else t)(torch.as_tensor(a)))
    def _A_setup():
        B, S, D = 1, 2048, 640
        ks = 4
        return {
            "q": _w((lambda *s: torch.randn(*s, dtype=torch.bfloat16) * 0.05)(B, S, D)),
            "k": _w((lambda *s: torch.randn(*s, dtype=torch.bfloat16) * 0.4)(B, S, D)),
            "v": _w((lambda *s: torch.randn(*s, dtype=torch.bfloat16) * 0.4)(B, S, D)),
            "shift_k": _w((lambda *s: torch.randn(*s, dtype=torch.bfloat16) * 0.4)(D, ks) * 0.5),
            "ssm_k": _w((lambda *s: torch.randn(*s, dtype=torch.bfloat16) * 0.4)(D, S) * (1.0 / S ** 0.5)),
            "ssm_D": _w((lambda *s: torch.randn(*s, dtype=torch.bfloat16) * 0.4)(D)),
        }
    _A_in = _A_setup()

    def _B_setup():
        B, S, D = 1, 2048, 640
        return {
            "x": _w((lambda *s: torch.randn(*s, dtype=torch.bfloat16) * 0.05)(B, S, D)),
            "wqkv": _w((lambda *s: torch.randn(*s, dtype=torch.bfloat16) * 0.05)(D, 3 * D)),
            "wo": _w((lambda *s: torch.randn(*s, dtype=torch.bfloat16) * 0.05)(D, D)),
        }
    _B_in = _B_setup()

    return {
        "A_q": _A_in["q"],
        "A_k": _A_in["k"],
        "A_v": _A_in["v"],
        "A_shift_k": _A_in["shift_k"],
        "A_ssm_k": _A_in["ssm_k"],
        "A_ssm_D": _A_in["ssm_D"],
        "B_x": _B_in["x"],
        "B_wqkv": _B_in["wqkv"],
        "B_wo": _B_in["wo"],
    }

def reference(A_q, A_k, A_v, A_shift_k, A_ssm_k, A_ssm_D, B_x, B_wqkv, B_wo):
    def _A_ref(q, k, v, shift_k, ssm_k, ssm_D):
        B, S, D = q.shape
        ks = shift_k.shape[-1]
        k_pad = _pad(k, ((0, 0), (ks - 1, 0), (0, 0)))
        k_shift = torch.zeros_like(k)
        for t in range(ks):
            k_shift = k_shift + k_pad[:, t:t + S, :] * shift_k[:, ks - 1 - t][None, None, :]
        kv = k_shift * v
        L = 2 * S
        kv_pad = _pad(kv, ((0, 0), (0, S), (0, 0)))
        kf_pad = _pad(ssm_k, ((0, 0), (0, S)))
        kv_f = (lambda x, axes=(-2,-1): torch.fft.rfft2(x.float(), dim=axes))(kv_pad[:, None, :, :], axes=(1, 2))
        kf_f = (lambda x, axes=(-2,-1): torch.fft.rfft2(x.float(), dim=axes))(kf_pad[:, None, :], axes=(1, 2))
        kf_f = (lambda x, *d: x.permute(*d))(kf_f, 1, 2, 0)
        y_f = kv_f * kf_f[None, :, :, :]
        y = (lambda x, s, axes=(-2,-1): torch.fft.irfft2(x, s=s, dim=axes).to(torch.bfloat16))(y_f, (1, L), axes=(1, 2))[:, 0, :S, :]
        y = y + kv * ssm_D[None, None, :]
        return q * y

    def _B_ref(x, wqkv, wo):
        B, S, D = x.shape
        H = 32; Dh = D // H
        W, dil = 8, 2
        qkv = (lambda x, *d: x.permute(*d))((x @ wqkv).reshape(B, S, 3, H, Dh), 2, 0, 3, 1, 4)
        q, k, v = qkv[0], qkv[1], qkv[2]
        scale = Dh ** -0.5
        pos = torch.arange(S)
        off = torch.arange(W) * dil
        idx = pos[:, None] - off[None, :]
        mask = idx >= 0
        idx_c = torch.where(mask, idx, 0).reshape(-1)
        kg = k[:, :, idx_c, :].reshape(B, H, S, W, Dh)
        vg = v[:, :, idx_c, :].reshape(B, H, S, W, Dh)
        logits = torch.einsum("bhsd,bhswd->bhsw", q, kg) * scale
        logits = torch.where(mask[None, None, :, :], logits, -1e9)
        attn = _softmax(logits, axis=-1)
        o = torch.einsum("bhsw,bhswd->bhsd", attn, vg)
        return (lambda x, *d: x.permute(*d))(o, 0, 2, 1, 3).reshape(B, S, D) @ wo

    x = A_q
    x = x + _A_ref(_layernorm(x, axis=-1), A_k, A_v, A_shift_k, A_ssm_k, A_ssm_D)
    x = x + _B_ref(_layernorm(x, axis=-1), B_wqkv, B_wo)
    x = x + _A_ref(_layernorm(x, axis=-1), A_k, A_v, A_shift_k, A_ssm_k, A_ssm_D)
    x = x + _B_ref(_layernorm(x, axis=-1), B_wqkv, B_wo)
    return x
```

```asm
; @launch kernel=pre_kernel grid=(256,1,1) block=(320,1,1) lds=24576
; @launch kernel=conv_kernel grid=(256,1,1) block=(256,1,1) lds=101504
; @launch kernel=interleave_layers__ssm_conv_h3__sliding_local_dilated__prompt_kernel grid=(256,1,1) block=(256,1,1) lds=163840
.amdgcn_target "amdgcn-amd-amdhsa--gfx950"
.text
.globl pre_kernel
.p2align 8
.type pre_kernel,@function
pre_kernel:
    s_cmp_ge_u32 s2, 256
    s_cbranch_scc1 L_pre_end
    s_load_dwordx4 s[4:7], s[0:1], 0
    s_load_dwordx4 s[8:11], s[0:1], 16
    s_load_dwordx2 s[12:13], s[0:1], 88
    s_load_dwordx4 s[16:19], s[0:1], 56
    s_load_dwordx2 s[14:15], s[0:1], 32
    v_and_b32 v1, 63, v0
    v_lshrrev_b32 v2, 6, v0
    v_and_b32 v3, 3, v1
    v_lshrrev_b32 v4, 2, v1
    s_cmp_ge_u32 s2, 128
    s_cbranch_scc1 L_pre_q
    s_lshr_b32 s20, s2, 2
    s_and_b32 s21, s2, 3
    s_lshl_b32 s20, s20, 6
    s_mul_i32 s21, s21, 160
    v_lshl_add_u32 v15, v2, 2, v3
    v_lshl_add_u32 v5, v4, 2, s20
    v_lshl_add_u32 v6, v15, 3, s21
    s_movk_i32 s22, 1280
    v_mul_lo_u32 v7, v5, s22
    v_lshl_add_u32 v7, v6, 1, v7
    v_add_u32 v8, -1280, v7
    v_add_u32 v9, -2560, v7
    v_add_u32 v10, -3840, v7
    v_lshlrev_b32 v11, 3, v6
    s_waitcnt vmcnt(0) lgkmcnt(0)
    s_mov_b32 s24, s6
    s_mov_b32 s25, s7
    s_mov_b32 s26, 2621440
    s_mov_b32 s27, 0x20000
    buffer_load_dwordx4 v[16:19], v10, s[24:27], 0 offen
    buffer_load_dwordx4 v[20:23], v9, s[24:27], 0 offen
    buffer_load_dwordx4 v[24:27], v8, s[24:27], 0 offen
    buffer_load_dwordx4 v[28:31], v7, s[24:27], 0 offen offset:0
    buffer_load_dwordx4 v[32:35], v7, s[24:27], 0 offen offset:1280
    buffer_load_dwordx4 v[36:39], v7, s[24:27], 0 offen offset:2560
    buffer_load_dwordx4 v[40:43], v7, s[24:27], 0 offen offset:3840
    s_mov_b32 s28, s8
    s_mov_b32 s29, s9
    s_mov_b32 s30, 2621440
    s_mov_b32 s31, 0x20000
    s_mov_b32 s32, s10
    s_mov_b32 s33, s11
    s_mov_b32 s34, 5120
    s_mov_b32 s35, 0x20000
    buffer_load_dwordx4 v[44:47], v7, s[28:31], 0 offen offset:0
    buffer_load_dwordx4 v[48:51], v7, s[28:31], 0 offen offset:1280
    buffer_load_dwordx4 v[52:55], v7, s[28:31], 0 offen offset:2560
    buffer_load_dwordx4 v[56:59], v7, s[28:31], 0 offen offset:3840
    buffer_load_dwordx4 v[60:63], v11, s[32:35], 0 offen offset:0
    buffer_load_dwordx4 v[64:67], v11, s[32:35], 0 offen offset:16
    buffer_load_dwordx4 v[68:71], v11, s[32:35], 0 offen offset:32
    buffer_load_dwordx4 v[72:75], v11, s[32:35], 0 offen offset:48
    v_lshlrev_b32 v14, 7, v0
    s_getpc_b64 s[56:57]
AL_pc_1:
    s_sub_u32 s56, s56, AL_pc_1-pre_kernel
    s_subb_u32 s57, s57, 0
    s_mov_b32 s58, code_end-pre_kernel
    s_mov_b32 s59, 0x20000
    s_mov_b32 s43, 0
    buffer_load_dword v250, v14, s[56:59], s43 offen
    s_mov_b32 s43, 40960
    buffer_load_dword v251, v14, s[56:59], s43 offen
    s_mov_b32 s36, s12
    s_mov_b32 s37, s13
    s_mov_b32 s38, 2621440
    s_mov_b32 s39, 0x20000
    v_lshlrev_b32 v12, 3, v4
    v_sub_u32 v12, 120, v12
    v_lshl_add_u32 v12, v3, 5, v12
    v_and_b32 v12, 127, v12
    v_lshl_add_u32 v12, v15, 10, v12
    v_and_b32 v13, 7, v0
    v_lshrrev_b32 v76, 3, v0
    s_sub_u32 s23, 1984, s20
    s_lshl_b32 s23, s23, 1
    s_lshl_b32 s22, s21, 12
    s_add_u32 s23, s23, s22
    s_waitcnt vmcnt(16)
    v_lshlrev_b32 v112, 16, v16
    v_and_b32 v113, 0xffff0000, v16
    v_lshlrev_b32 v114, 16, v17
    v_and_b32 v115, 0xffff0000, v17
    v_lshlrev_b32 v116, 16, v18
    v_and_b32 v117, 0xffff0000, v18
    v_lshlrev_b32 v118, 16, v19
    v_and_b32 v119, 0xffff0000, v19
    s_waitcnt vmcnt(15)
    v_lshlrev_b32 v120, 16, v20
    v_and_b32 v121, 0xffff0000, v20
    v_lshlrev_b32 v122, 16, v21
    v_and_b32 v123, 0xffff0000, v21
    v_lshlrev_b32 v124, 16, v22
    v_and_b32 v125, 0xffff0000, v22
    v_lshlrev_b32 v126, 16, v23
    v_and_b32 v127, 0xffff0000, v23
    s_waitcnt vmcnt(14)
    v_lshlrev_b32 v128, 16, v24
    v_and_b32 v129, 0xffff0000, v24
    v_lshlrev_b32 v130, 16, v25
    v_and_b32 v131, 0xffff0000, v25
    v_lshlrev_b32 v132, 16, v26
    v_and_b32 v133, 0xffff0000, v26
    v_lshlrev_b32 v134, 16, v27
    v_and_b32 v135, 0xffff0000, v27
    s_waitcnt vmcnt(13)
    v_lshlrev_b32 v136, 16, v28
    v_and_b32 v137, 0xffff0000, v28
    v_lshlrev_b32 v138, 16, v29
    v_and_b32 v139, 0xffff0000, v29
    v_lshlrev_b32 v140, 16, v30
    v_and_b32 v141, 0xffff0000, v30
    v_lshlrev_b32 v142, 16, v31
    v_and_b32 v143, 0xffff0000, v31
    s_waitcnt vmcnt(12)
    v_lshlrev_b32 v144, 16, v32
    v_and_b32 v145, 0xffff0000, v32
    v_lshlrev_b32 v146, 16, v33
    v_and_b32 v147, 0xffff0000, v33
    v_lshlrev_b32 v148, 16, v34
    v_and_b32 v149, 0xffff0000, v34
    v_lshlrev_b32 v150, 16, v35
    v_and_b32 v151, 0xffff0000, v35
    s_waitcnt vmcnt(11)
    v_lshlrev_b32 v152, 16, v36
    v_and_b32 v153, 0xffff0000, v36
    v_lshlrev_b32 v154, 16, v37
    v_and_b32 v155, 0xffff0000, v37
    v_lshlrev_b32 v156, 16, v38
    v_and_b32 v157, 0xffff0000, v38
    v_lshlrev_b32 v158, 16, v39
    v_and_b32 v159, 0xffff0000, v39
    s_waitcnt vmcnt(10)
    v_lshlrev_b32 v160, 16, v40
    v_and_b32 v161, 0xffff0000, v40
    v_lshlrev_b32 v162, 16, v41
    v_and_b32 v163, 0xffff0000, v41
    v_lshlrev_b32 v164, 16, v42
    v_and_b32 v165, 0xffff0000, v42
    v_lshlrev_b32 v166, 16, v43
    v_and_b32 v167, 0xffff0000, v43
    s_waitcnt vmcnt(5)
    v_lshlrev_b32 v80, 16, v60
    v_and_b32 v88, 0xffff0000, v60
    v_lshlrev_b32 v96, 16, v61
    v_and_b32 v104, 0xffff0000, v61
    v_lshlrev_b32 v81, 16, v62
    v_and_b32 v89, 0xffff0000, v62
    v_lshlrev_b32 v97, 16, v63
    v_and_b32 v105, 0xffff0000, v63
    s_waitcnt vmcnt(4)
    v_lshlrev_b32 v82, 16, v64
    v_and_b32 v90, 0xffff0000, v64
    v_lshlrev_b32 v98, 16, v65
    v_and_b32 v106, 0xffff0000, v65
    v_lshlrev_b32 v83, 16, v66
    v_and_b32 v91, 0xffff0000, v66
    v_lshlrev_b32 v99, 16, v67
    v_and_b32 v107, 0xffff0000, v67
    s_waitcnt vmcnt(3)
    v_lshlrev_b32 v84, 16, v68
    v_and_b32 v92, 0xffff0000, v68
    v_lshlrev_b32 v100, 16, v69
    v_and_b32 v108, 0xffff0000, v69
    v_lshlrev_b32 v85, 16, v70
    v_and_b32 v93, 0xffff0000, v70
    v_lshlrev_b32 v101, 16, v71
    v_and_b32 v109, 0xffff0000, v71
    s_waitcnt vmcnt(2)
    v_lshlrev_b32 v86, 16, v72
    v_and_b32 v94, 0xffff0000, v72
    v_lshlrev_b32 v102, 16, v73
    v_and_b32 v110, 0xffff0000, v73
    v_lshlrev_b32 v87, 16, v74
    v_and_b32 v95, 0xffff0000, v74
    v_lshlrev_b32 v103, 16, v75
    v_and_b32 v111, 0xffff0000, v75
    v_pk_mul_f32 v[168:169], v[136:137], v[80:81]
    v_pk_mul_f32 v[170:171], v[138:139], v[82:83]
    v_pk_mul_f32 v[172:173], v[140:141], v[84:85]
    v_pk_mul_f32 v[174:175], v[142:143], v[86:87]
    v_pk_mul_f32 v[176:177], v[144:145], v[80:81]
    v_pk_mul_f32 v[178:179], v[146:147], v[82:83]
    v_pk_mul_f32 v[180:181], v[148:149], v[84:85]
    v_pk_mul_f32 v[182:183], v[150:151], v[86:87]
    v_pk_mul_f32 v[184:185], v[152:153], v[80:81]
    v_pk_mul_f32 v[186:187], v[154:155], v[82:83]
    v_pk_mul_f32 v[188:189], v[156:157], v[84:85]
    v_pk_mul_f32 v[190:191], v[158:159], v[86:87]
    v_pk_mul_f32 v[192:193], v[160:161], v[80:81]
    v_pk_mul_f32 v[194:195], v[162:163], v[82:83]
    v_pk_mul_f32 v[196:197], v[164:165], v[84:85]
    v_pk_mul_f32 v[198:199], v[166:167], v[86:87]
    v_pk_fma_f32 v[168:169], v[128:129], v[88:89], v[168:169]
    v_pk_fma_f32 v[170:171], v[130:131], v[90:91], v[170:171]
    v_pk_fma_f32 v[172:173], v[132:133], v[92:93], v[172:173]
    v_pk_fma_f32 v[174:175], v[134:135], v[94:95], v[174:175]
    v_pk_fma_f32 v[176:177], v[136:137], v[88:89], v[176:177]
    v_pk_fma_f32 v[178:179], v[138:139], v[90:91], v[178:179]
    v_pk_fma_f32 v[180:181], v[140:141], v[92:93], v[180:181]
    v_pk_fma_f32 v[182:183], v[142:143], v[94:95], v[182:183]
    v_pk_fma_f32 v[184:185], v[144:145], v[88:89], v[184:185]
    v_pk_fma_f32 v[186:187], v[146:147], v[90:91], v[186:187]
    v_pk_fma_f32 v[188:189], v[148:149], v[92:93], v[188:189]
    v_pk_fma_f32 v[190:191], v[150:151], v[94:95], v[190:191]
    v_pk_fma_f32 v[192:193], v[152:153], v[88:89], v[192:193]
    v_pk_fma_f32 v[194:195], v[154:155], v[90:91], v[194:195]
    v_pk_fma_f32 v[196:197], v[156:157], v[92:93], v[196:197]
    v_pk_fma_f32 v[198:199], v[158:159], v[94:95], v[198:199]
    v_pk_fma_f32 v[168:169], v[120:121], v[96:97], v[168:169]
    v_pk_fma_f32 v[170:171], v[122:123], v[98:99], v[170:171]
    v_pk_fma_f32 v[172:173], v[124:125], v[100:101], v[172:173]
    v_pk_fma_f32 v[174:175], v[126:127], v[102:103], v[174:175]
    v_pk_fma_f32 v[176:177], v[128:129], v[96:97], v[176:177]
    v_pk_fma_f32 v[178:179], v[130:131], v[98:99], v[178:179]
    v_pk_fma_f32 v[180:181], v[132:133], v[100:101], v[180:181]
    v_pk_fma_f32 v[182:183], v[134:135], v[102:103], v[182:183]
    v_pk_fma_f32 v[184:185], v[136:137], v[96:97], v[184:185]
    v_pk_fma_f32 v[186:187], v[138:139], v[98:99], v[186:187]
    v_pk_fma_f32 v[188:189], v[140:141], v[100:101], v[188:189]
    v_pk_fma_f32 v[190:191], v[142:143], v[102:103], v[190:191]
    v_pk_fma_f32 v[192:193], v[144:145], v[96:97], v[192:193]
    v_pk_fma_f32 v[194:195], v[146:147], v[98:99], v[194:195]
    v_pk_fma_f32 v[196:197], v[148:149], v[100:101], v[196:197]
    v_pk_fma_f32 v[198:199], v[150:151], v[102:103], v[198:199]
    v_pk_fma_f32 v[168:169], v[112:113], v[104:105], v[168:169]
    v_pk_fma_f32 v[170:171], v[114:115], v[106:107], v[170:171]
    v_pk_fma_f32 v[172:173], v[116:117], v[108:109], v[172:173]
    v_pk_fma_f32 v[174:175], v[118:119], v[110:111], v[174:175]
    v_pk_fma_f32 v[176:177], v[120:121], v[104:105], v[176:177]
    v_pk_fma_f32 v[178:179], v[122:123], v[106:107], v[178:179]
    v_pk_fma_f32 v[180:181], v[124:125], v[108:109], v[180:181]
    v_pk_fma_f32 v[182:183], v[126:127], v[110:111], v[182:183]
    v_pk_fma_f32 v[184:185], v[128:129], v[104:105], v[184:185]
    v_pk_fma_f32 v[186:187], v[130:131], v[106:107], v[186:187]
    v_pk_fma_f32 v[188:189], v[132:133], v[108:109], v[188:189]
    v_pk_fma_f32 v[190:191], v[134:135], v[110:111], v[190:191]
    v_pk_fma_f32 v[192:193], v[136:137], v[104:105], v[192:193]
    v_pk_fma_f32 v[194:195], v[138:139], v[106:107], v[194:195]
    v_pk_fma_f32 v[196:197], v[140:141], v[108:109], v[196:197]
    v_pk_fma_f32 v[198:199], v[142:143], v[110:111], v[198:199]
    v_lshlrev_b32 v112, 16, v44
    v_and_b32 v113, 0xffff0000, v44
    v_lshlrev_b32 v114, 16, v45
    v_and_b32 v115, 0xffff0000, v45
    v_lshlrev_b32 v116, 16, v46
    v_and_b32 v117, 0xffff0000, v46
    v_lshlrev_b32 v118, 16, v47
    v_and_b32 v119, 0xffff0000, v47
    v_lshlrev_b32 v120, 16, v48
    v_and_b32 v121, 0xffff0000, v48
    v_lshlrev_b32 v122, 16, v49
    v_and_b32 v123, 0xffff0000, v49
    v_lshlrev_b32 v124, 16, v50
    v_and_b32 v125, 0xffff0000, v50
    v_lshlrev_b32 v126, 16, v51
    v_and_b32 v127, 0xffff0000, v51
    v_lshlrev_b32 v128, 16, v52
    v_and_b32 v129, 0xffff0000, v52
    v_lshlrev_b32 v130, 16, v53
    v_and_b32 v131, 0xffff0000, v53
    v_lshlrev_b32 v132, 16, v54
    v_and_b32 v133, 0xffff0000, v54
    v_lshlrev_b32 v134, 16, v55
    v_and_b32 v135, 0xffff0000, v55
    v_lshlrev_b32 v136, 16, v56
    v_and_b32 v137, 0xffff0000, v56
    v_lshlrev_b32 v138, 16, v57
    v_and_b32 v139, 0xffff0000, v57
    v_lshlrev_b32 v140, 16, v58
    v_and_b32 v141, 0xffff0000, v58
    v_lshlrev_b32 v142, 16, v59
    v_and_b32 v143, 0xffff0000, v59
    v_pk_mul_f32 v[168:169], v[168:169], v[112:113]
    v_pk_mul_f32 v[170:171], v[170:171], v[114:115]
    v_pk_mul_f32 v[172:173], v[172:173], v[116:117]
    v_pk_mul_f32 v[174:175], v[174:175], v[118:119]
    v_pk_mul_f32 v[176:177], v[176:177], v[120:121]
    v_pk_mul_f32 v[178:179], v[178:179], v[122:123]
    v_pk_mul_f32 v[180:181], v[180:181], v[124:125]
    v_pk_mul_f32 v[182:183], v[182:183], v[126:127]
    v_pk_mul_f32 v[184:185], v[184:185], v[128:129]
    v_pk_mul_f32 v[186:187], v[186:187], v[130:131]
    v_pk_mul_f32 v[188:189], v[188:189], v[132:133]
    v_pk_mul_f32 v[190:191], v[190:191], v[134:135]
    v_pk_mul_f32 v[192:193], v[192:193], v[136:137]
    v_pk_mul_f32 v[194:195], v[194:195], v[138:139]
    v_pk_mul_f32 v[196:197], v[196:197], v[140:141]
    v_pk_mul_f32 v[198:199], v[198:199], v[142:143]
    v_cvt_pk_bf16_f32 v16, v192, v184
    v_cvt_pk_bf16_f32 v17, v176, v168
    ds_write_b64 v12, v[16:17] offset:0
    v_cvt_pk_bf16_f32 v18, v193, v185
    v_cvt_pk_bf16_f32 v19, v177, v169
    ds_write_b64 v12, v[18:19] offset:128
    v_cvt_pk_bf16_f32 v20, v194, v186
    v_cvt_pk_bf16_f32 v21, v178, v170
    ds_write_b64 v12, v[20:21] offset:256
    v_cvt_pk_bf16_f32 v22, v195, v187
    v_cvt_pk_bf16_f32 v23, v179, v171
    ds_write_b64 v12, v[22:23] offset:384
    v_cvt_pk_bf16_f32 v24, v196, v188
    v_cvt_pk_bf16_f32 v25, v180, v172
    ds_write_b64 v12, v[24:25] offset:512
    v_cvt_pk_bf16_f32 v26, v197, v189
    v_cvt_pk_bf16_f32 v27, v181, v173
    ds_write_b64 v12, v[26:27] offset:640
    v_cvt_pk_bf16_f32 v28, v198, v190
    v_cvt_pk_bf16_f32 v29, v182, v174
    ds_write_b64 v12, v[28:29] offset:768
    v_cvt_pk_bf16_f32 v30, v199, v191
    v_cvt_pk_bf16_f32 v31, v183, v175
    ds_write_b64 v12, v[30:31] offset:896
    v_add_u32 v40, 0, v76
    v_bfe_u32 v44, v40, 3, 2
    v_lshlrev_b32 v44, 5, v44
    v_lshl_add_u32 v44, v13, 4, v44
    v_and_b32 v44, 127, v44
    v_lshl_add_u32 v44, v40, 7, v44
    v_lshlrev_b32 v40, 12, v40
    v_lshl_add_u32 v40, v13, 4, v40
    v_add_u32 v41, 40, v76
    v_bfe_u32 v45, v41, 3, 2
    v_lshlrev_b32 v45, 5, v45
    v_lshl_add_u32 v45, v13, 4, v45
    v_and_b32 v45, 127, v45
    v_lshl_add_u32 v45, v41, 7, v45
    v_lshlrev_b32 v41, 12, v41
    v_lshl_add_u32 v41, v13, 4, v41
    v_add_u32 v42, 80, v76
    v_bfe_u32 v46, v42, 3, 2
    v_lshlrev_b32 v46, 5, v46
    v_lshl_add_u32 v46, v13, 4, v46
    v_and_b32 v46, 127, v46
    v_lshl_add_u32 v46, v42, 7, v46
    v_lshlrev_b32 v42, 12, v42
    v_lshl_add_u32 v42, v13, 4, v42
    v_add_u32 v43, 120, v76
    v_bfe_u32 v47, v43, 3, 2
    v_lshlrev_b32 v47, 5, v47
    v_lshl_add_u32 v47, v13, 4, v47
    v_and_b32 v47, 127, v47
    v_lshl_add_u32 v47, v43, 7, v47
    v_lshlrev_b32 v43, 12, v43
    v_lshl_add_u32 v43, v13, 4, v43
    s_waitcnt lgkmcnt(0)
    s_barrier
    ds_read_b128 v[16:19], v44
    ds_read_b128 v[20:23], v45
    ds_read_b128 v[24:27], v46
    ds_read_b128 v[28:31], v47
    s_waitcnt lgkmcnt(3)
    buffer_store_dwordx4 v[16:19], v40, s[36:39], s23 offen sc1
    s_waitcnt lgkmcnt(2)
    buffer_store_dwordx4 v[20:23], v41, s[36:39], s23 offen sc1
    s_waitcnt lgkmcnt(1)
    buffer_store_dwordx4 v[24:27], v42, s[36:39], s23 offen sc1
    s_waitcnt lgkmcnt(0)
    buffer_store_dwordx4 v[28:31], v43, s[36:39], s23 offen sc1
    s_endpgm
L_pre_q:
    s_sub_u32 s20, s2, 128
    v_lshlrev_b32 v5, 1, v4
    v_add_u32 v6, -15, v5
    v_cmp_gt_u32 vcc, 8, v4
    s_nop 1
    v_cndmask_b32 v5, v6, v5, vcc
    s_lshl_b32 s21, s20, 4
    v_add_u32 v5, s21, v5
    s_movk_i32 s22, 1280
    v_mul_lo_u32 v7, v5, s22
    v_lshl_add_u32 v7, v2, 8, v7
    v_lshl_add_u32 v7, v3, 4, v7
    s_waitcnt vmcnt(0) lgkmcnt(0)
    s_mov_b32 s24, s4
    s_mov_b32 s25, s5
    s_mov_b32 s26, 2621440
    s_mov_b32 s27, 0x20000
    buffer_load_dwordx4 v[16:19], v7, s[24:27], 0 offen offset:0
    buffer_load_dwordx4 v[20:23], v7, s[24:27], 0 offen offset:64
    buffer_load_dwordx4 v[24:27], v7, s[24:27], 0 offen offset:128
    buffer_load_dwordx4 v[28:31], v7, s[24:27], 0 offen offset:192
    v_lshlrev_b32 v14, 7, v0
    s_getpc_b64 s[56:57]
AL_pc_2:
    s_sub_u32 s56, s56, AL_pc_2-pre_kernel
    s_subb_u32 s57, s57, 0
    s_mov_b32 s58, code_end-pre_kernel
    s_mov_b32 s59, 0x20000
    s_mov_b32 s43, 0
    buffer_load_dword v250, v14, s[56:59], s43 offen
    s_mov_b32 s43, 40960
    buffer_load_dword v251, v14, s[56:59], s43 offen
    s_add_u32 s28, s12, 2621440
    s_addc_u32 s29, s13, 0
    s_mov_b32 s30, 2621440
    s_mov_b32 s31, 0x20000
    s_add_u32 s32, s12, 5242880
    s_addc_u32 s33, s13, 0
    s_mov_b32 s34, 16384
    s_mov_b32 s35, 0x20000
    v_mov_b32 v40, 0
    v_mov_b32 v41, 0
    v_mov_b32 v42, 0
    v_mov_b32 v43, 0
    v_lshlrev_b32 v44, 4, v0
    s_cmp_ge_u32 s20, 8
    s_cbranch_scc1 L_pre_zx
    s_and_b32 s21, s20, 3
    s_mul_i32 s21, s21, 10240
    s_cmp_ge_u32 s20, 4
    s_cselect_b32 s22, 2662400, 0
    s_add_u32 s22, s22, 5259264
    s_add_u32 s21, s21, s22
    s_add_u32 s36, s12, s21
    s_addc_u32 s37, s13, 0
    s_mov_b32 s38, 10240
    s_mov_b32 s39, 0x20000
    buffer_store_dwordx4 v[40:43], v44, s[36:39], 0 offen
    s_movk_i32 s21, 5120
    buffer_store_dwordx4 v[40:43], v44, s[36:39], s21 offen
L_pre_zx:
    s_cmp_lt_u32 s20, 8
    s_cbranch_scc1 L_pre_zdone
    s_cmp_ge_u32 s20, 12
    s_cbranch_scc1 L_pre_zdone
    s_sub_u32 s21, s20, 8
    s_lshl_b32 s21, s21, 12
    s_add_u32 s21, s21, 14032896
    s_add_u32 s36, s12, s21
    s_addc_u32 s37, s13, 0
    s_mov_b32 s38, 4096
    s_mov_b32 s39, 0x20000
    buffer_store_dwordx4 v[40:43], v44, s[36:39], 0 offen
L_pre_zdone:
    s_sub_u32 s21, s20, 12
    s_cmp_ge_u32 s21, 2
    s_cbranch_scc1 L_pre_zcs
    s_lshl_b32 s21, s21, 12
    s_add_u32 s21, s21, 14024704
    s_add_u32 s36, s12, s21
    s_addc_u32 s37, s13, 0
    s_mov_b32 s38, 4096
    s_mov_b32 s39, 0x20000
    buffer_store_dwordx4 v[40:43], v44, s[36:39], 0 offen
L_pre_zcs:
    s_sub_u32 s21, s20, 16
    s_cmp_ge_u32 s21, 48
    s_cbranch_scc1 L_pre_zdone2
    s_mul_i32 s22, s21, 43691
    s_lshr_b32 s22, s22, 18
    s_mul_i32 s23, s22, 6
    s_sub_u32 s23, s21, s23
    s_mul_i32 s22, s22, 1138688
    s_add_u32 s22, s22, 15159296
    s_add_u32 s36, s12, s22
    s_addc_u32 s37, s13, 0
    s_mov_b32 s38, 28672
    s_mov_b32 s39, 0x20000
    s_mul_i32 s23, s23, 5120
    buffer_store_dwordx4 v[40:43], v44, s[36:39], s23 offen
L_pre_zdone2:
    v_lshlrev_b32 v8, 3, v4
    v_lshl_add_u32 v8, v3, 5, v8
    v_and_b32 v8, 127, v8
    v_lshl_add_u32 v9, v2, 4, v3
    v_lshl_add_u32 v8, v9, 8, v8
    s_waitcnt vmcnt(5)
    ds_write_b64 v8, v[16:17] offset:0
    ds_write_b64 v8, v[18:19] offset:128
    s_waitcnt vmcnt(4)
    ds_write_b64 v8, v[20:21] offset:1024
    ds_write_b64 v8, v[22:23] offset:1152
    s_waitcnt vmcnt(3)
    ds_write_b64 v8, v[24:25] offset:2048
    ds_write_b64 v8, v[26:27] offset:2176
    s_waitcnt vmcnt(2)
    ds_write_b64 v8, v[28:29] offset:3072
    ds_write_b64 v8, v[30:31] offset:3200
    v_lshlrev_b32 v48, 16, v16
    v_and_b32 v49, 0xffff0000, v16
    v_lshlrev_b32 v50, 16, v17
    v_and_b32 v51, 0xffff0000, v17
    v_lshlrev_b32 v52, 16, v18
    v_and_b32 v53, 0xffff0000, v18
    v_lshlrev_b32 v54, 16, v19
    v_and_b32 v55, 0xffff0000, v19
    v_lshlrev_b32 v56, 16, v20
    v_and_b32 v57, 0xffff0000, v20
    v_lshlrev_b32 v58, 16, v21
    v_and_b32 v59, 0xffff0000, v21
    v_lshlrev_b32 v60, 16, v22
    v_and_b32 v61, 0xffff0000, v22
    v_lshlrev_b32 v62, 16, v23
    v_and_b32 v63, 0xffff0000, v23
    v_lshlrev_b32 v64, 16, v24
    v_and_b32 v65, 0xffff0000, v24
    v_lshlrev_b32 v66, 16, v25
    v_and_b32 v67, 0xffff0000, v25
    v_lshlrev_b32 v68, 16, v26
    v_and_b32 v69, 0xffff0000, v26
    v_lshlrev_b32 v70, 16, v27
    v_and_b32 v71, 0xffff0000, v27
    v_lshlrev_b32 v72, 16, v28
    v_and_b32 v73, 0xffff0000, v28
    v_lshlrev_b32 v74, 16, v29
    v_and_b32 v75, 0xffff0000, v29
    v_lshlrev_b32 v76, 16, v30
    v_and_b32 v77, 0xffff0000, v30
    v_lshlrev_b32 v78, 16, v31
    v_and_b32 v79, 0xffff0000, v31
    v_pk_add_f32 v[80:81], v[48:49], v[50:51]
    v_pk_mul_f32 v[82:83], v[48:49], v[48:49]
    v_pk_fma_f32 v[82:83], v[50:51], v[50:51], v[82:83]
    v_pk_add_f32 v[80:81], v[80:81], v[52:53]
    v_pk_fma_f32 v[82:83], v[52:53], v[52:53], v[82:83]
    v_pk_add_f32 v[80:81], v[80:81], v[54:55]
    v_pk_fma_f32 v[82:83], v[54:55], v[54:55], v[82:83]
    v_pk_add_f32 v[80:81], v[80:81], v[56:57]
    v_pk_fma_f32 v[82:83], v[56:57], v[56:57], v[82:83]
    v_pk_add_f32 v[80:81], v[80:81], v[58:59]
    v_pk_fma_f32 v[82:83], v[58:59], v[58:59], v[82:83]
    v_pk_add_f32 v[80:81], v[80:81], v[60:61]
    v_pk_fma_f32 v[82:83], v[60:61], v[60:61], v[82:83]
    v_pk_add_f32 v[80:81], v[80:81], v[62:63]
    v_pk_fma_f32 v[82:83], v[62:63], v[62:63], v[82:83]
    v_pk_add_f32 v[80:81], v[80:81], v[64:65]
    v_pk_fma_f32 v[82:83], v[64:65], v[64:65], v[82:83]
    v_pk_add_f32 v[80:81], v[80:81], v[66:67]
    v_pk_fma_f32 v[82:83], v[66:67], v[66:67], v[82:83]
    v_pk_add_f32 v[80:81], v[80:81], v[68:69]
    v_pk_fma_f32 v[82:83], v[68:69], v[68:69], v[82:83]
    v_pk_add_f32 v[80:81], v[80:81], v[70:71]
    v_pk_fma_f32 v[82:83], v[70:71], v[70:71], v[82:83]
    v_pk_add_f32 v[80:81], v[80:81], v[72:73]
    v_pk_fma_f32 v[82:83], v[72:73], v[72:73], v[82:83]
    v_pk_add_f32 v[80:81], v[80:81], v[74:75]
    v_pk_fma_f32 v[82:83], v[74:75], v[74:75], v[82:83]
    v_pk_add_f32 v[80:81], v[80:81], v[76:77]
    v_pk_fma_f32 v[82:83], v[76:77], v[76:77], v[82:83]
    v_pk_add_f32 v[80:81], v[80:81], v[78:79]
    v_pk_fma_f32 v[82:83], v[78:79], v[78:79], v[82:83]
    v_add_f32 v80, v80, v81
    v_add_f32 v81, v82, v83
    s_nop 0
    v_add_f32_dpp v80, v80, v80 quad_perm:[1,0,3,2] row_mask:0xf bank_mask:0xf
    v_add_f32_dpp v81, v81, v81 quad_perm:[1,0,3,2] row_mask:0xf bank_mask:0xf
    s_nop 0
    v_add_f32_dpp v80, v80, v80 quad_perm:[2,3,0,1] row_mask:0xf bank_mask:0xf
    v_add_f32_dpp v81, v81, v81 quad_perm:[2,3,0,1] row_mask:0xf bank_mask:0xf
    v_lshlrev_b32 v10, 3, v4
    v_lshl_add_u32 v10, v2, 7, v10
    ds_write_b64 v10, v[80:81] offset:20480
    v_and_b32 v13, 7, v0
    v_lshrrev_b32 v11, 3, v0
    v_add_u32 v84, 0, v11
    v_bfe_u32 v88, v84, 1, 2
    v_lshlrev_b32 v88, 5, v88
    v_lshl_add_u32 v88, v13, 4, v88
    v_and_b32 v88, 127, v88
    v_lshl_add_u32 v88, v84, 7, v88
    v_lshlrev_b32 v84, 14, v84
    v_lshl_add_u32 v84, v13, 4, v84
    v_add_u32 v85, 40, v11
    v_bfe_u32 v89, v85, 1, 2
    v_lshlrev_b32 v89, 5, v89
    v_lshl_add_u32 v89, v13, 4, v89
    v_and_b32 v89, 127, v89
    v_lshl_add_u32 v89, v85, 7, v89
    v_lshlrev_b32 v85, 14, v85
    v_lshl_add_u32 v85, v13, 4, v85
    v_add_u32 v86, 80, v11
    v_bfe_u32 v90, v86, 1, 2
    v_lshlrev_b32 v90, 5, v90
    v_lshl_add_u32 v90, v13, 4, v90
    v_and_b32 v90, 127, v90
    v_lshl_add_u32 v90, v86, 7, v90
    v_lshlrev_b32 v86, 14, v86
    v_lshl_add_u32 v86, v13, 4, v86
    v_add_u32 v87, 120, v11
    v_bfe_u32 v91, v87, 1, 2
    v_lshlrev_b32 v91, 5, v91
    v_lshl_add_u32 v91, v13, 4, v91
    v_and_b32 v91, 127, v91
    v_lshl_add_u32 v91, v87, 7, v91
    v_lshlrev_b32 v87, 14, v87
    v_lshl_add_u32 v87, v13, 4, v87
    s_lshl_b32 s23, s20, 7
    s_waitcnt lgkmcnt(0)
    s_barrier
    ds_read_b128 v[16:19], v88
    ds_read_b128 v[20:23], v89
    ds_read_b128 v[24:27], v90
    ds_read_b128 v[28:31], v91
    v_and_b32 v10, 15, v0
    v_lshlrev_b32 v10, 3, v10
    ds_read_b64 v[48:49], v10 offset:20480
    ds_read_b64 v[50:51], v10 offset:20608
    ds_read_b64 v[52:53], v10 offset:20736
    ds_read_b64 v[54:55], v10 offset:20864
    ds_read_b64 v[56:57], v10 offset:20992
    s_waitcnt lgkmcnt(8)
    buffer_store_dwordx4 v[16:19], v84, s[28:31], s23 offen sc1
    s_waitcnt lgkmcnt(7)
    buffer_store_dwordx4 v[20:23], v85, s[28:31], s23 offen sc1
    s_waitcnt lgkmcnt(6)
    buffer_store_dwordx4 v[24:27], v86, s[28:31], s23 offen sc1
    s_waitcnt lgkmcnt(5)
    buffer_store_dwordx4 v[28:31], v87, s[28:31], s23 offen sc1
    s_waitcnt lgkmcnt(3)
    v_pk_add_f32 v[48:49], v[48:49], v[50:51]
    s_waitcnt lgkmcnt(1)
    v_pk_add_f32 v[52:53], v[52:53], v[54:55]
    s_waitcnt lgkmcnt(0)
    v_pk_add_f32 v[48:49], v[48:49], v[56:57]
    v_pk_add_f32 v[48:49], v[48:49], v[52:53]
    s_mov_b32 s22, 0x3acccccd
    v_mul_f32 v48, s22, v48
    v_mul_f32 v49, s22, v49
    v_fma_f32 v49, -v48, v48, v49
    v_max_f32 v49, 0, v49
    v_add_f32 v49, 0x3727c5ac, v49
    v_rsq_f32 v50, v49
    s_nop 0
    v_mul_f32 v51, v48, v50
    v_sub_f32 v51, 0, v51
    v_add_u32 v10, s23, v10
    v_cmp_gt_u32 vcc, 16, v0
    v_mov_b32 v11, 0x40000000
    s_nop 0
    v_cndmask_b32 v10, v11, v10, vcc
    buffer_store_dwordx2 v[50:51], v10, s[32:35], 0 offen
L_pre_end:
    s_endpgm
.globl conv_kernel
.p2align 8
.type conv_kernel,@function
conv_kernel:
    s_cmp_ge_u32 s2, 256
    s_cbranch_scc1 L_conv_end
    s_load_dwordx4 s[4:7], s[0:1], 32
    s_load_dwordx2 s[8:9], s[0:1], 88
    s_load_dwordx4 s[12:15], s[0:1], 56
    v_and_b32 v1, 63, v0
    v_lshrrev_b32 v2, 6, v0
    v_and_b32 v3, 15, v1
    v_lshrrev_b32 v4, 4, v1
    v_readfirstlane_b32 s3, v2
    s_cmp_ge_u32 s2, 160
    s_cbranch_scc1 L_repack
    s_lshr_b32 s52, s2, 4
    s_lshl_b32 s52, s52, 3
    s_and_b32 s53, s2, 7
    s_add_u32 s52, s52, s53
    s_lshr_b32 s53, s52, 2
    s_lshl_b32 s53, s53, 3
    s_and_b32 s52, s52, 3
    s_add_u32 s53, s53, s52
    s_bfe_u32 s52, s2, 0x10003
    s_lshl_b32 s52, s52, 2
    s_add_u32 s52, s53, s52
    s_lshl_b32 s44, s52, 2
    s_add_u32 s44, s44, s3
    s_lshl_b32 s45, s44, 12
    s_mul_i32 s46, s3, 21216
    v_lshlrev_b32 v5, 4, v1
    v_add_u32 v10, v3, v4
    v_subrev_u32 v11, 15, v10
    v_lshlrev_b32 v11, 1, v11
    v_cmp_le_u32 vcc, 15, v10
    v_mov_b32 v12, 0x40000000
    s_nop 0
    v_cndmask_b32 v11, v12, v11, vcc
    s_waitcnt vmcnt(0) lgkmcnt(0)
    s_mov_b32 s16, s4
    s_mov_b32 s17, s5
    s_mov_b32 s18, 2621440
    s_mov_b32 s19, 0x20000
    buffer_load_dwordx4 v[160:163], v5, s[16:19], s45 offen offset:0
    buffer_load_dwordx2 v[164:165], v5, s[16:19], s45 offen offset:16
    buffer_load_dwordx4 v[166:169], v5, s[16:19], s45 offen offset:1024
    buffer_load_dwordx2 v[170:171], v5, s[16:19], s45 offen offset:1040
    buffer_load_dwordx4 v[172:175], v5, s[16:19], s45 offen offset:2048
    buffer_load_dwordx2 v[176:177], v5, s[16:19], s45 offen offset:2064
    buffer_load_dwordx4 v[178:181], v5, s[16:19], s45 offen offset:3072
    buffer_load_dwordx2 v[182:183], v5, s[16:19], s45 offen offset:3088
    s_mov_b32 s20, s8
    s_mov_b32 s21, s9
    s_mov_b32 s22, 2621440
    s_mov_b32 s23, 0x20000
    s_mov_b32 s40, s6
    s_mov_b32 s41, s7
    s_mov_b32 s42, 1280
    s_mov_b32 s43, 0x20000
    s_add_u32 s47, s46, 16640
    s_mov_b32 m0, s47
    s_lshl_b32 s47, s44, 1
    buffer_load_dwordx4 v5, s[20:23], s45 offen offset:0 lds
    buffer_load_dwordx4 v5, s[20:23], s45 offen offset:1024 lds
    buffer_load_dwordx4 v5, s[20:23], s45 offen offset:2048 lds
    buffer_load_dwordx4 v5, s[20:23], s45 offen offset:3072 lds
    buffer_load_ushort v13, v11, s[16:19], s45 offen
    v_mov_b32 v14, 0
    buffer_load_ushort v15, v14, s[40:43], s47 offen
    v_mov_b32 v52, 0
    v_mov_b32 v53, 0
    v_mov_b32 v54, 0
    v_mov_b32 v55, 0
    v_add_u32 v56, s46, v5
    v_cmp_gt_u32 vcc, 30, v1
    s_nop 0
    s_and_saveexec_b64 s[50:51], vcc
    ds_write_b128 v56, v[52:55] offset:20736
    s_mov_b64 exec, s[50:51]
    v_and_b32 v57, 3, v3
    s_movk_i32 s48, 4160
    v_mul_lo_u32 v57, v57, s48
    v_lshl_add_u32 v57, v4, 4, v57
    v_lshrrev_b32 v58, 2, v3
    v_lshl_add_u32 v57, v58, 3, v57
    v_add_u32 v57, s46, v57
    v_lshlrev_b32 v58, 5, v3
    v_sub_u32 v58, 480, v58
    v_lshl_add_u32 v58, v4, 4, v58
    v_add_u32 v58, 16640, v58
    v_add_u32 v58, s46, v58
    v_mul_lo_u32 v59, v4, s48
    v_lshl_add_u32 v59, v3, 1, v59
    v_add_u32 v59, s46, v59
    s_add_u32 s24, s8, 2621440
    s_addc_u32 s25, s9, 0
    s_mov_b32 s26, 2621440
    s_mov_b32 s27, 0x20000
    s_add_u32 s28, s8, 5242880
    s_addc_u32 s29, s9, 0
    s_mov_b32 s30, 16384
    s_mov_b32 s31, 0x20000
    s_add_u32 s32, s8, 5259264
    s_addc_u32 s33, s9, 0
    s_mov_b32 s34, 2662400
    s_mov_b32 s35, 0x20000
    s_add_u32 s36, s8, 7921664
    s_addc_u32 s37, s9, 0
    s_mov_b32 s38, 2662400
    s_mov_b32 s39, 0x20000
    s_lshl_b32 s47, s52, 14
    v_lshlrev_b32 v16, 3, v0
    s_waitcnt vmcnt(13)
    v_alignbit_b32 v196, v161, v160, 16
    v_alignbit_b32 v197, v162, v161, 16
    v_alignbit_b32 v198, v163, v162, 16
    s_waitcnt vmcnt(12)
    v_alignbit_b32 v199, v164, v163, 16
    v_mov_b32 v200, v161
    v_mov_b32 v201, v162
    v_mov_b32 v202, v163
    v_mov_b32 v203, v164
    ds_write_b128 v56, v[196:199] offset:32
    v_alignbit_b32 v204, v162, v161, 16
    v_alignbit_b32 v205, v163, v162, 16
    v_alignbit_b32 v206, v164, v163, 16
    v_alignbit_b32 v207, v165, v164, 16
    ds_write_b128 v56, v[200:203] offset:4192
    ds_write_b128 v56, v[162:165] offset:12512
    ds_write_b128 v56, v[204:207] offset:8352
    s_waitcnt vmcnt(11)
    v_alignbit_b32 v196, v167, v166, 16
    v_alignbit_b32 v197, v168, v167, 16
    v_alignbit_b32 v198, v169, v168, 16
    s_waitcnt vmcnt(10)
    v_alignbit_b32 v199, v170, v169, 16
    v_mov_b32 v200, v167
    v_mov_b32 v201, v168
    v_mov_b32 v202, v169
    v_mov_b32 v203, v170
    ds_write_b128 v56, v[196:199] offset:1056
    v_alignbit_b32 v204, v168, v167, 16
    v_alignbit_b32 v205, v169, v168, 16
    v_alignbit_b32 v206, v170, v169, 16
    v_alignbit_b32 v207, v171, v170, 16
    ds_write_b128 v56, v[200:203] offset:5216
    ds_write_b128 v56, v[168:171] offset:13536
    ds_write_b128 v56, v[204:207] offset:9376
    s_waitcnt vmcnt(9)
    v_alignbit_b32 v196, v173, v172, 16
    v_alignbit_b32 v197, v174, v173, 16
    v_alignbit_b32 v198, v175, v174, 16
    s_waitcnt vmcnt(8)
    v_alignbit_b32 v199, v176, v175, 16
    v_mov_b32 v200, v173
    v_mov_b32 v201, v174
    v_mov_b32 v202, v175
    v_mov_b32 v203, v176
    ds_write_b128 v56, v[196:199] offset:2080
    v_alignbit_b32 v204, v174, v173, 16
    v_alignbit_b32 v205, v175, v174, 16
    v_alignbit_b32 v206, v176, v175, 16
    v_alignbit_b32 v207, v177, v176, 16
    ds_write_b128 v56, v[200:203] offset:6240
    ds_write_b128 v56, v[174:177] offset:14560
    ds_write_b128 v56, v[204:207] offset:10400
    s_waitcnt vmcnt(7)
    v_alignbit_b32 v196, v179, v178, 16
    v_alignbit_b32 v197, v180, v179, 16
    v_alignbit_b32 v198, v181, v180, 16
    s_waitcnt vmcnt(6)
    v_alignbit_b32 v199, v182, v181, 16
    v_mov_b32 v200, v179
    v_mov_b32 v201, v180
    v_mov_b32 v202, v181
    v_mov_b32 v203, v182
    ds_write_b128 v56, v[196:199] offset:3104
    v_alignbit_b32 v204, v180, v179, 16
    v_alignbit_b32 v205, v181, v180, 16
    v_alignbit_b32 v206, v182, v181, 16
    v_alignbit_b32 v207, v183, v182, 16
    ds_write_b128 v56, v[200:203] offset:7264
    ds_write_b128 v56, v[180:183] offset:15584
    ds_write_b128 v56, v[204:207] offset:11424
    s_waitcnt vmcnt(1)
    ds_write_b16 v59, v13
    v_sub_u32 v6, 15, v3
    v_lshrrev_b32 v7, 3, v6
    v_cmp_eq_u32 vcc, v7, v4
    v_and_b32 v7, 1, v6
    v_lshlrev_b32 v7, 4, v7
    s_waitcnt vmcnt(0)
    v_lshlrev_b32 v8, v7, v15
    v_cndmask_b32 v8, 0, v8, vcc
    v_bfe_u32 v7, v6, 1, 2
    v_cmp_eq_u32 vcc, 0, v7
    s_nop 1
    v_cndmask_b32 v60, 0, v8, vcc
    v_cmp_eq_u32 vcc, 1, v7
    s_nop 1
    v_cndmask_b32 v61, 0, v8, vcc
    v_cmp_eq_u32 vcc, 2, v7
    s_nop 1
    v_cndmask_b32 v62, 0, v8, vcc
    v_cmp_eq_u32 vcc, 3, v7
    s_nop 1
    v_cndmask_b32 v63, 0, v8, vcc
    ds_read_b128 v[96:99], v58 offset:3584
    ds_read_b128 v[100:103], v58 offset:3648
    ds_read_b128 v[104:107], v58 offset:3712
    ds_read_b128 v[108:111], v58 offset:3776
    ds_read_b128 v[112:115], v58 offset:3840
    ds_read_b128 v[116:119], v58 offset:3904
    ds_read_b128 v[120:123], v58 offset:3968
    ds_read_b128 v[124:127], v58 offset:4032
    ds_read_b64 a[0:1], v57 offset:0
    ds_read_b64 a[2:3], v57 offset:8
    ds_read_b64 a[4:5], v57 offset:64
    ds_read_b64 a[6:7], v57 offset:72
    ds_read_b128 v[128:131], v58 offset:3072
    ds_read_b128 v[132:135], v58 offset:3136
    ds_read_b128 v[136:139], v58 offset:3200
    ds_read_b128 v[140:143], v58 offset:3264
    ds_read_b128 v[144:147], v58 offset:3328
    ds_read_b128 v[148:151], v58 offset:3392
    ds_read_b128 v[152:155], v58 offset:3456
    ds_read_b128 v[156:159], v58 offset:3520
    ds_read_b64 a[8:9], v57 offset:128
    ds_read_b64 a[10:11], v57 offset:136
    ds_read_b64 a[12:13], v57 offset:192
    ds_read_b64 a[14:15], v57 offset:200
    ds_read_b64 a[16:17], v57 offset:256
    ds_read_b64 a[18:19], v57 offset:264
    ds_read_b64 a[20:21], v57 offset:320
    ds_read_b64 a[22:23], v57 offset:328
    s_waitcnt lgkmcnt(15)
    v_mfma_f32_16x16x32_bf16 v[64:67], a[0:3], v[96:99], 0
    ds_read_b64 a[24:25], v57 offset:384
    ds_read_b64 a[26:27], v57 offset:392
    v_mfma_f32_16x16x32_bf16 v[68:71], a[0:3], v[128:131], 0
    v_mfma_f32_16x16x32_bf16 v[64:67], a[4:7], v[100:103], v[64:67]
    ds_read_b64 a[28:29], v57 offset:448
    ds_read_b64 a[30:31], v57 offset:456
    s_waitcnt lgkmcnt(15)
    v_mfma_f32_16x16x32_bf16 v[68:71], a[4:7], v[132:135], v[68:71]
    s_waitcnt lgkmcnt(10)
    v_mfma_f32_16x16x32_bf16 v[64:67], a[8:11], v[104:107], v[64:67]
    ds_read_b64 a[32:33], v57 offset:512
    ds_read_b64 a[34:35], v57 offset:520
    v_mfma_f32_16x16x32_bf16 v[68:71], a[8:11], v[136:139], v[68:71]
    s_waitcnt lgkmcnt(10)
    v_mfma_f32_16x16x32_bf16 v[64:67], a[12:15], v[108:111], v[64:67]
    ds_read_b64 a[36:37], v57 offset:576
    ds_read_b64 a[38:39], v57 offset:584
    v_mfma_f32_16x16x32_bf16 v[68:71], a[12:15], v[140:143], v[68:71]
    s_waitcnt lgkmcnt(10)
    v_mfma_f32_16x16x32_bf16 v[64:67], a[16:19], v[112:115], v[64:67]
    ds_read_b64 a[40:41], v57 offset:640
    ds_read_b64 a[42:43], v57 offset:648
    v_mfma_f32_16x16x32_bf16 v[68:71], a[16:19], v[144:147], v[68:71]
    s_waitcnt lgkmcnt(10)
    v_mfma_f32_16x16x32_bf16 v[64:67], a[20:23], v[116:119], v[64:67]
    ds_read_b64 a[44:45], v57 offset:704
    ds_read_b64 a[46:47], v57 offset:712
    v_mfma_f32_16x16x32_bf16 v[68:71], a[20:23], v[148:151], v[68:71]
    s_waitcnt lgkmcnt(10)
    v_mfma_f32_16x16x32_bf16 v[64:67], a[24:27], v[120:123], v[64:67]
    ds_read_b64 a[48:49], v57 offset:768
    ds_read_b64 a[50:51], v57 offset:776
    v_mfma_f32_16x16x32_bf16 v[68:71], a[24:27], v[152:155], v[68:71]
    s_waitcnt lgkmcnt(10)
    v_mfma_f32_16x16x32_bf16 v[64:67], a[28:31], v[124:127], v[64:67]
    ds_read_b64 a[52:53], v57 offset:832
    ds_read_b64 a[54:55], v57 offset:840
    v_mfma_f32_16x16x32_bf16 v[68:71], a[28:31], v[156:159], v[68:71]
    s_waitcnt lgkmcnt(10)
    v_mfma_f32_16x16x32_bf16 v[68:71], a[32:35], v[96:99], v[68:71]
    ds_read_b64 a[56:57], v57 offset:896
    ds_read_b64 a[58:59], v57 offset:904
    v_mfma_f32_16x16x32_bf16 v[72:75], a[32:35], v[128:131], 0
    s_waitcnt lgkmcnt(10)
    v_mfma_f32_16x16x32_bf16 v[68:71], a[36:39], v[100:103], v[68:71]
    ds_read_b64 a[60:61], v57 offset:960
    ds_read_b64 a[62:63], v57 offset:968
    v_mfma_f32_16x16x32_bf16 v[72:75], a[36:39], v[132:135], v[72:75]
    s_waitcnt lgkmcnt(10)
    v_mfma_f32_16x16x32_bf16 v[68:71], a[40:43], v[104:107], v[68:71]
    ds_read_b64 a[64:65], v57 offset:1024
    ds_read_b64 a[66:67], v57 offset:1032
    v_mfma_f32_16x16x32_bf16 v[72:75], a[40:43], v[136:139], v[72:75]
    s_waitcnt lgkmcnt(10)
    v_mfma_f32_16x16x32_bf16 v[68:71], a[44:47], v[108:111], v[68:71]
    ds_read_b64 a[68:69], v57 offset:1088
    ds_read_b64 a[70:71], v57 offset:1096
    v_mfma_f32_16x16x32_bf16 v[72:75], a[44:47], v[140:143], v[72:75]
    s_waitcnt lgkmcnt(10)
    v_mfma_f32_16x16x32_bf16 v[68:71], a[48:51], v[112:115], v[68:71]
    ds_read_b64 a[72:73], v57 offset:1152
    ds_read_b64 a[74:75], v57 offset:1160
    v_mfma_f32_16x16x32_bf16 v[72:75], a[48:51], v[144:147], v[72:75]
    s_waitcnt lgkmcnt(10)
    v_mfma_f32_16x16x32_bf16 v[68:71], a[52:55], v[116:119], v[68:71]
    ds_read_b64 a[76:77], v57 offset:1216
    ds_read_b64 a[78:79], v57 offset:1224
    v_mfma_f32_16x16x32_bf16 v[72:75], a[52:55], v[148:151], v[72:75]
    s_waitcnt lgkmcnt(10)
    v_mfma_f32_16x16x32_bf16 v[68:71], a[56:59], v[120:123], v[68:71]
    ds_read_b64 a[80:81], v57 offset:1280
    ds_read_b64 a[82:83], v57 offset:1288
    v_mfma_f32_16x16x32_bf16 v[72:75], a[56:59], v[152:155], v[72:75]
    s_waitcnt lgkmcnt(10)
    v_mfma_f32_16x16x32_bf16 v[68:71], a[60:63], v[124:127], v[68:71]
    ds_read_b64 a[84:85], v57 offset:1344
    ds_read_b64 a[86:87], v57 offset:1352
    v_mfma_f32_16x16x32_bf16 v[72:75], a[60:63], v[156:159], v[72:75]
    s_waitcnt lgkmcnt(10)
    v_mfma_f32_16x16x32_bf16 v[72:75], a[64:67], v[96:99], v[72:75]
    ds_read_b64 a[88:89], v57 offset:1408
    ds_read_b64 a[90:91], v57 offset:1416
    v_mfma_f32_16x16x32_bf16 v[76:79], a[64:67], v[128:131], 0
    s_waitcnt lgkmcnt(10)
    v_mfma_f32_16x16x32_bf16 v[72:75], a[68:71], v[100:103], v[72:75]
    ds_read_b64 a[92:93], v57 offset:1472
    ds_read_b64 a[94:95], v57 offset:1480
    v_mfma_f32_16x16x32_bf16 v[76:79], a[68:71], v[132:135], v[76:79]
    s_waitcnt lgkmcnt(10)
    v_mfma_f32_16x16x32_bf16 v[72:75], a[72:75], v[104:107], v[72:75]
    ds_read_b64 a[96:97], v57 offset:1536
    ds_read_b64 a[98:99], v57 offset:1544
    v_mfma_f32_16x16x32_bf16 v[76:79], a[72:75], v[136:139], v[76:79]
    s_waitcnt lgkmcnt(10)
    v_mfma_f32_16x16x32_bf16 v[72:75], a[76:79], v[108:111], v[72:75]
    ds_read_b64 a[100:101], v57 offset:1600
    ds_read_b64 a[102:103], v57 offset:1608
    v_mfma_f32_16x16x32_bf16 v[76:79], a[76:79], v[140:143], v[76:79]
    s_waitcnt lgkmcnt(10)
    v_mfma_f32_16x16x32_bf16 v[72:75], a[80:83], v[112:115], v[72:75]
    ds_read_b64 a[104:105], v57 offset:1664
    ds_read_b64 a[106:107], v57 offset:1672
    v_mfma_f32_16x16x32_bf16 v[76:79], a[80:83], v[144:147], v[76:79]
    s_waitcnt lgkmcnt(10)
    v_mfma_f32_16x16x32_bf16 v[72:75], a[84:87], v[116:119], v[72:75]
    ds_read_b64 a[108:109], v57 offset:1728
    ds_read_b64 a[110:111], v57 offset:1736
    v_mfma_f32_16x16x32_bf16 v[76:79], a[84:87], v[148:151], v[76:79]
    s_waitcnt lgkmcnt(10)
    v_mfma_f32_16x16x32_bf16 v[72:75], a[88:91], v[120:123], v[72:75]
    ds_read_b64 a[112:113], v57 offset:1792
    ds_read_b64 a[114:115], v57 offset:1800
    v_mfma_f32_16x16x32_bf16 v[76:79], a[88:91], v[152:155], v[76:79]
    s_waitcnt lgkmcnt(10)
    v_mfma_f32_16x16x32_bf16 v[72:75], a[92:95], v[124:127], v[72:75]
    ds_read_b64 a[116:117], v57 offset:1856
    ds_read_b64 a[118:119], v57 offset:1864
    v_mfma_f32_16x16x32_bf16 v[76:79], a[92:95], v[156:159], v[76:79]
    s_waitcnt lgkmcnt(10)
    v_mfma_f32_16x16x32_bf16 v[76:79], a[96:99], v[96:99], v[76:79]
    ds_read_b64 a[120:121], v57 offset:1920
    ds_read_b64 a[122:123], v57 offset:1928
    v_mfma_f32_16x16x32_bf16 v[80:83], a[96:99], v[128:131], 0
    s_waitcnt lgkmcnt(10)
    v_mfma_f32_16x16x32_bf16 v[76:79], a[100:103], v[100:103], v[76:79]
    ds_read_b64 a[124:125], v57 offset:1984
    ds_read_b64 a[126:127], v57 offset:1992
    v_mfma_f32_16x16x32_bf16 v[80:83], a[100:103], v[132:135], v[80:83]
    s_waitcnt lgkmcnt(10)
    v_mfma_f32_16x16x32_bf16 v[76:79], a[104:107], v[104:107], v[76:79]
    ds_read_b64 a[128:129], v57 offset:2048
    ds_read_b64 a[130:131], v57 offset:2056
    v_mfma_f32_16x16x32_bf16 v[80:83], a[104:107], v[136:139], v[80:83]
    s_waitcnt lgkmcnt(10)
    v_mfma_f32_16x16x32_bf16 v[76:79], a[108:111], v[108:111], v[76:79]
    ds_read_b64 a[132:133], v57 offset:2112
    ds_read_b64 a[134:135], v57 offset:2120
    v_mfma_f32_16x16x32_bf16 v[80:83], a[108:111], v[140:143], v[80:83]
    s_waitcnt lgkmcnt(10)
    v_mfma_f32_16x16x32_bf16 v[76:79], a[112:115], v[112:115], v[76:79]
    ds_read_b64 a[136:137], v57 offset:2176
    ds_read_b64 a[138:139], v57 offset:2184
    v_mfma_f32_16x16x32_bf16 v[80:83], a[112:115], v[144:147], v[80:83]
    s_waitcnt lgkmcnt(10)
    v_mfma_f32_16x16x32_bf16 v[76:79], a[116:119], v[116:119], v[76:79]
    ds_read_b64 a[140:141], v57 offset:2240
    ds_read_b64 a[142:143], v57 offset:2248
    v_mfma_f32_16x16x32_bf16 v[80:83], a[116:119], v[148:151], v[80:83]
    s_waitcnt lgkmcnt(10)
    v_mfma_f32_16x16x32_bf16 v[76:79], a[120:123], v[120:123], v[76:79]
    ds_read_b64 a[144:145], v57 offset:2304
    ds_read_b64 a[146:147], v57 offset:2312
    v_mfma_f32_16x16x32_bf16 v[80:83], a[120:123], v[152:155], v[80:83]
    s_waitcnt lgkmcnt(10)
    v_mfma_f32_16x16x32_bf16 v[76:79], a[124:127], v[124:127], v[76:79]
    ds_read_b64 a[148:149], v57 offset:2368
    ds_read_b64 a[150:151], v57 offset:2376
    v_mfma_f32_16x16x32_bf16 v[80:83], a[124:127], v[156:159], v[80:83]
    s_waitcnt lgkmcnt(10)
    v_mfma_f32_16x16x32_bf16 v[80:83], a[128:131], v[96:99], v[80:83]
    ds_read_b64 a[152:153], v57 offset:2432
    ds_read_b64 a[154:155], v57 offset:2440
    v_mfma_f32_16x16x32_bf16 v[84:87], a[128:131], v[128:131], 0
    s_waitcnt lgkmcnt(10)
    v_mfma_f32_16x16x32_bf16 v[80:83], a[132:135], v[100:103], v[80:83]
    ds_read_b64 a[156:157], v57 offset:2496
    ds_read_b64 a[158:159], v57 offset:2504
    v_mfma_f32_16x16x32_bf16 v[84:87], a[132:135], v[132:135], v[84:87]
    s_waitcnt lgkmcnt(10)
    v_mfma_f32_16x16x32_bf16 v[80:83], a[136:139], v[104:107], v[80:83]
    ds_read_b64 a[160:161], v57 offset:2560
    ds_read_b64 a[162:163], v57 offset:2568
    v_mfma_f32_16x16x32_bf16 v[84:87], a[136:139], v[136:139], v[84:87]
    s_waitcnt lgkmcnt(10)
    v_mfma_f32_16x16x32_bf16 v[80:83], a[140:143], v[108:111], v[80:83]
    ds_read_b64 a[164:165], v57 offset:2624
    ds_read_b64 a[166:167], v57 offset:2632
    v_mfma_f32_16x16x32_bf16 v[84:87], a[140:143], v[140:143], v[84:87]
    s_waitcnt lgkmcnt(10)
    v_mfma_f32_16x16x32_bf16 v[80:83], a[144:147], v[112:115], v[80:83]
    ds_read_b64 a[168:169], v57 offset:2688
    ds_read_b64 a[170:171], v57 offset:2696
    v_mfma_f32_16x16x32_bf16 v[84:87], a[144:147], v[144:147], v[84:87]
    s_waitcnt lgkmcnt(10)
    v_mfma_f32_16x16x32_bf16 v[80:83], a[148:151], v[116:119], v[80:83]
    ds_read_b64 a[172:173], v57 offset:2752
    ds_read_b64 a[174:175], v57 offset:2760
    v_mfma_f32_16x16x32_bf16 v[84:87], a[148:151], v[148:151], v[84:87]
    s_waitcnt lgkmcnt(10)
    v_mfma_f32_16x16x32_bf16 v[80:83], a[152:155], v[120:123], v[80:83]
    ds_read_b64 a[176:177], v57 offset:2816
    ds_read_b64 a[178:179], v57 offset:2824
    v_mfma_f32_16x16x32_bf16 v[84:87], a[152:155], v[152:155], v[84:87]
    s_waitcnt lgkmcnt(10)
    v_mfma_f32_16x16x32_bf16 v[80:83], a[156:159], v[124:127], v[80:83]
    ds_read_b64 a[180:181], v57 offset:2880
    ds_read_b64 a[182:183], v57 offset:2888
    v_mfma_f32_16x16x32_bf16 v[84:87], a[156:159], v[156:159], v[84:87]
    s_waitcnt lgkmcnt(10)
    v_mfma_f32_16x16x32_bf16 v[84:87], a[160:163], v[96:99], v[84:87]
    ds_read_b64 a[184:185], v57 offset:2944
    ds_read_b64 a[186:187], v57 offset:2952
    v_mfma_f32_16x16x32_bf16 v[88:91], a[160:163], v[128:131], 0
    s_waitcnt lgkmcnt(10)
    v_mfma_f32_16x16x32_bf16 v[84:87], a[164:167], v[100:103], v[84:87]
    ds_read_b64 a[188:189], v57 offset:3008
    ds_read_b64 a[190:191], v57 offset:3016
    v_mfma_f32_16x16x32_bf16 v[88:91], a[164:167], v[132:135], v[88:91]
    s_waitcnt lgkmcnt(10)
    v_mfma_f32_16x16x32_bf16 v[84:87], a[168:171], v[104:107], v[84:87]
    ds_read_b64 a[192:193], v57 offset:3072
    ds_read_b64 a[194:195], v57 offset:3080
    v_mfma_f32_16x16x32_bf16 v[88:91], a[168:171], v[136:139], v[88:91]
    s_waitcnt lgkmcnt(10)
    v_mfma_f32_16x16x32_bf16 v[84:87], a[172:175], v[108:111], v[84:87]
    ds_read_b64 a[196:197], v57 offset:3136
    ds_read_b64 a[198:199], v57 offset:3144
    v_mfma_f32_16x16x32_bf16 v[88:91], a[172:175], v[140:143], v[88:91]
    s_waitcnt lgkmcnt(10)
    v_mfma_f32_16x16x32_bf16 v[84:87], a[176:179], v[112:115], v[84:87]
    ds_read_b64 a[200:201], v57 offset:3200
    ds_read_b64 a[202:203], v57 offset:3208
    v_mfma_f32_16x16x32_bf16 v[88:91], a[176:179], v[144:147], v[88:91]
    s_waitcnt lgkmcnt(10)
    v_mfma_f32_16x16x32_bf16 v[84:87], a[180:183], v[116:119], v[84:87]
    ds_read_b64 a[204:205], v57 offset:3264
    ds_read_b64 a[206:207], v57 offset:3272
    v_mfma_f32_16x16x32_bf16 v[88:91], a[180:183], v[148:151], v[88:91]
    s_waitcnt lgkmcnt(10)
    v_mfma_f32_16x16x32_bf16 v[84:87], a[184:187], v[120:123], v[84:87]
    ds_read_b64 a[208:209], v57 offset:3328
    ds_read_b64 a[210:211], v57 offset:3336
    v_mfma_f32_16x16x32_bf16 v[88:91], a[184:187], v[152:155], v[88:91]
    s_waitcnt lgkmcnt(10)
    v_mfma_f32_16x16x32_bf16 v[84:87], a[188:191], v[124:127], v[84:87]
    ds_read_b64 a[212:213], v57 offset:3392
    ds_read_b64 a[214:215], v57 offset:3400
    v_mfma_f32_16x16x32_bf16 v[88:91], a[188:191], v[156:159], v[88:91]
    s_waitcnt lgkmcnt(10)
    v_mfma_f32_16x16x32_bf16 v[88:91], a[192:195], v[96:99], v[88:91]
    ds_read_b64 a[216:217], v57 offset:3456
    ds_read_b64 a[218:219], v57 offset:3464
    v_mfma_f32_16x16x32_bf16 v[92:95], a[192:195], v[128:131], 0
    s_waitcnt lgkmcnt(10)
    v_mfma_f32_16x16x32_bf16 v[88:91], a[196:199], v[100:103], v[88:91]
    ds_read_b64 a[220:221], v57 offset:3520
    ds_read_b64 a[222:223], v57 offset:3528
    v_mfma_f32_16x16x32_bf16 v[92:95], a[196:199], v[132:135], v[92:95]
    s_waitcnt lgkmcnt(10)
    v_mfma_f32_16x16x32_bf16 v[88:91], a[200:203], v[104:107], v[88:91]
    ds_read_b64 a[224:225], v57 offset:3584
    ds_read_b64 a[226:227], v57 offset:3592
    v_mfma_f32_16x16x32_bf16 v[92:95], a[200:203], v[136:139], v[92:95]
    s_waitcnt lgkmcnt(10)
    v_mfma_f32_16x16x32_bf16 v[88:91], a[204:207], v[108:111], v[88:91]
    ds_read_b64 a[228:229], v57 offset:3648
    ds_read_b64 a[230:231], v57 offset:3656
    v_mfma_f32_16x16x32_bf16 v[92:95], a[204:207], v[140:143], v[92:95]
    s_waitcnt lgkmcnt(10)
    v_mfma_f32_16x16x32_bf16 v[88:91], a[208:211], v[112:115], v[88:91]
    ds_read_b64 a[232:233], v57 offset:3712
    ds_read_b64 a[234:235], v57 offset:3720
    v_mfma_f32_16x16x32_bf16 v[92:95], a[208:211], v[144:147], v[92:95]
    s_waitcnt lgkmcnt(10)
    v_mfma_f32_16x16x32_bf16 v[88:91], a[212:215], v[116:119], v[88:91]
    ds_read_b64 a[236:237], v57 offset:3776
    ds_read_b64 a[238:239], v57 offset:3784
    v_mfma_f32_16x16x32_bf16 v[92:95], a[212:215], v[148:151], v[92:95]
    s_waitcnt lgkmcnt(10)
    v_mfma_f32_16x16x32_bf16 v[88:91], a[216:219], v[120:123], v[88:91]
    ds_read_b64 a[240:241], v57 offset:3840
    ds_read_b64 a[242:243], v57 offset:3848
    v_mfma_f32_16x16x32_bf16 v[92:95], a[216:219], v[152:155], v[92:95]
    s_waitcnt lgkmcnt(10)
    v_mfma_f32_16x16x32_bf16 v[88:91], a[220:223], v[124:127], v[88:91]
    ds_read_b64 a[244:245], v57 offset:3904
    ds_read_b64 a[246:247], v57 offset:3912
    v_mfma_f32_16x16x32_bf16 v[92:95], a[220:223], v[156:159], v[92:95]
    s_waitcnt lgkmcnt(10)
    v_mfma_f32_16x16x32_bf16 v[92:95], a[224:227], v[96:99], v[92:95]
    ds_read_b64 a[248:249], v57 offset:3968
    ds_read_b64 a[250:251], v57 offset:3976
    ds_read_b128 v[160:163], v58 offset:2560
    s_waitcnt lgkmcnt(11)
    v_mfma_f32_16x16x32_bf16 v[92:95], a[228:231], v[100:103], v[92:95]
    ds_read_b64 a[252:253], v57 offset:4032
    ds_read_b64 a[254:255], v57 offset:4040
    ds_read_b128 v[164:167], v58 offset:2624
    s_waitcnt lgkmcnt(12)
    v_mfma_f32_16x16x32_bf16 v[92:95], a[232:235], v[104:107], v[92:95]
    ds_read_b128 v[168:171], v58 offset:2688
    s_waitcnt lgkmcnt(11)
    v_mfma_f32_16x16x32_bf16 v[92:95], a[236:239], v[108:111], v[92:95]
    ds_read_b128 v[172:175], v58 offset:2752
    s_waitcnt lgkmcnt(10)
    v_mfma_f32_16x16x32_bf16 v[92:95], a[240:243], v[112:115], v[92:95]
    ds_read_b128 v[176:179], v58 offset:2816
    s_waitcnt lgkmcnt(9)
    v_mfma_f32_16x16x32_bf16 v[92:95], a[244:247], v[116:119], v[92:95]
    ds_read_b128 v[180:183], v58 offset:2880
    s_waitcnt lgkmcnt(8)
    v_mfma_f32_16x16x32_bf16 v[92:95], a[248:251], v[120:123], v[92:95]
    ds_read_b128 v[184:187], v58 offset:2944
    s_waitcnt lgkmcnt(6)
    v_mfma_f32_16x16x32_bf16 v[92:95], a[252:255], v[124:127], v[92:95]
    ds_read_b128 v[188:191], v58 offset:3008
    v_mfma_f32_16x16x32_bf16 v[64:67], v[60:63], v[96:99], v[64:67]
    v_mfma_f32_16x16x32_bf16 v[68:71], v[60:63], v[128:131], v[68:71]
    s_add_u32 s48, s47, 0
    v_mfma_f32_16x16x32_bf16 v[72:75], a[0:3], v[160:163], v[72:75]
    buffer_load_dwordx2 v[20:21], v16, s[24:27], s48 offen
    s_waitcnt lgkmcnt(6)
    v_mfma_f32_16x16x32_bf16 v[72:75], a[4:7], v[164:167], v[72:75]
    ds_read_b128 v[96:99], v58 offset:2048
    s_waitcnt lgkmcnt(6)
    v_mfma_f32_16x16x32_bf16 v[72:75], a[8:11], v[168:171], v[72:75]
    ds_read_b128 v[100:103], v58 offset:2112
    s_waitcnt lgkmcnt(6)
    v_mfma_f32_16x16x32_bf16 v[72:75], a[12:15], v[172:175], v[72:75]
    ds_read_b128 v[104:107], v58 offset:2176
    s_waitcnt lgkmcnt(6)
    v_mfma_f32_16x16x32_bf16 v[72:75], a[16:19], v[176:179], v[72:75]
    ds_read_b128 v[108:111], v58 offset:2240
    s_movk_i32 s49, 0
    s_waitcnt lgkmcnt(6)
    v_mfma_f32_16x16x32_bf16 v[72:75], a[20:23], v[180:183], v[72:75]
    buffer_load_dwordx2 v[36:37], v16, s[28:31], s49 offen
    s_waitcnt lgkmcnt(5)
    v_mfma_f32_16x16x32_bf16 v[72:75], a[24:27], v[184:187], v[72:75]
    ds_read_b128 v[112:115], v58 offset:2304
    s_waitcnt lgkmcnt(5)
    v_mfma_f32_16x16x32_bf16 v[72:75], a[28:31], v[188:191], v[72:75]
    ds_read_b128 v[116:119], v58 offset:2368
    v_mfma_f32_16x16x32_bf16 v[76:79], a[32:35], v[160:163], v[76:79]
    ds_read_b128 v[120:123], v58 offset:2432
    v_mfma_f32_16x16x32_bf16 v[76:79], a[36:39], v[164:167], v[76:79]
    ds_read_b128 v[124:127], v58 offset:2496
    s_add_u32 s48, s47, 2048
    v_mfma_f32_16x16x32_bf16 v[76:79], a[40:43], v[168:171], v[76:79]
    buffer_load_dwordx2 v[22:23], v16, s[24:27], s48 offen
    v_mfma_f32_16x16x32_bf16 v[76:79], a[44:47], v[172:175], v[76:79]
    v_mfma_f32_16x16x32_bf16 v[76:79], a[48:51], v[176:179], v[76:79]
    v_mfma_f32_16x16x32_bf16 v[76:79], a[52:55], v[180:183], v[76:79]
    v_mfma_f32_16x16x32_bf16 v[76:79], a[56:59], v[184:187], v[76:79]
    s_movk_i32 s49, 2048
    v_mfma_f32_16x16x32_bf16 v[76:79], a[60:63], v[188:191], v[76:79]
    buffer_load_dwordx2 v[38:39], v16, s[28:31], s49 offen
    v_mfma_f32_16x16x32_bf16 v[80:83], a[64:67], v[160:163], v[80:83]
    v_mfma_f32_16x16x32_bf16 v[80:83], a[68:71], v[164:167], v[80:83]
    v_mfma_f32_16x16x32_bf16 v[80:83], a[72:75], v[168:171], v[80:83]
    v_mfma_f32_16x16x32_bf16 v[80:83], a[76:79], v[172:175], v[80:83]
    s_add_u32 s48, s47, 4096
    v_mfma_f32_16x16x32_bf16 v[80:83], a[80:83], v[176:179], v[80:83]
    buffer_load_dwordx2 v[24:25], v16, s[24:27], s48 offen
    v_mfma_f32_16x16x32_bf16 v[80:83], a[84:87], v[180:183], v[80:83]
    v_mfma_f32_16x16x32_bf16 v[80:83], a[88:91], v[184:187], v[80:83]
    v_mfma_f32_16x16x32_bf16 v[80:83], a[92:95], v[188:191], v[80:83]
    v_mfma_f32_16x16x32_bf16 v[84:87], a[96:99], v[160:163], v[84:87]
    s_movk_i32 s49, 4096
    v_mfma_f32_16x16x32_bf16 v[84:87], a[100:103], v[164:167], v[84:87]
    buffer_load_dwordx2 v[40:41], v16, s[28:31], s49 offen
    v_mfma_f32_16x16x32_bf16 v[84:87], a[104:107], v[168:171], v[84:87]
    v_mfma_f32_16x16x32_bf16 v[84:87], a[108:111], v[172:175], v[84:87]
    v_mfma_f32_16x16x32_bf16 v[84:87], a[112:115], v[176:179], v[84:87]
    v_mfma_f32_16x16x32_bf16 v[84:87], a[116:119], v[180:183], v[84:87]
    s_add_u32 s48, s47, 6144
    v_mfma_f32_16x16x32_bf16 v[84:87], a[120:123], v[184:187], v[84:87]
    buffer_load_dwordx2 v[26:27], v16, s[24:27], s48 offen
    v_mfma_f32_16x16x32_bf16 v[84:87], a[124:127], v[188:191], v[84:87]
    v_mfma_f32_16x16x32_bf16 v[88:91], a[128:131], v[160:163], v[88:91]
    v_mfma_f32_16x16x32_bf16 v[88:91], a[132:135], v[164:167], v[88:91]
    v_mfma_f32_16x16x32_bf16 v[88:91], a[136:139], v[168:171], v[88:91]
    s_movk_i32 s49, 6144
    v_mfma_f32_16x16x32_bf16 v[88:91], a[140:143], v[172:175], v[88:91]
    buffer_load_dwordx2 v[42:43], v16, s[28:31], s49 offen
    v_mfma_f32_16x16x32_bf16 v[88:91], a[144:147], v[176:179], v[88:91]
    v_mfma_f32_16x16x32_bf16 v[88:91], a[148:151], v[180:183], v[88:91]
    v_mfma_f32_16x16x32_bf16 v[88:91], a[152:155], v[184:187], v[88:91]
    v_mfma_f32_16x16x32_bf16 v[88:91], a[156:159], v[188:191], v[88:91]
    s_add_u32 s48, s47, 8192
    v_mfma_f32_16x16x32_bf16 v[92:95], a[160:163], v[160:163], v[92:95]
    buffer_load_dwordx2 v[28:29], v16, s[24:27], s48 offen
    v_mfma_f32_16x16x32_bf16 v[92:95], a[164:167], v[164:167], v[92:95]
    v_mfma_f32_16x16x32_bf16 v[92:95], a[168:171], v[168:171], v[92:95]
    v_mfma_f32_16x16x32_bf16 v[92:95], a[172:175], v[172:175], v[92:95]
    v_mfma_f32_16x16x32_bf16 v[92:95], a[176:179], v[176:179], v[92:95]
    s_movk_i32 s49, 8192
    v_mfma_f32_16x16x32_bf16 v[92:95], a[180:183], v[180:183], v[92:95]
    buffer_load_dwordx2 v[44:45], v16, s[28:31], s49 offen
    v_mfma_f32_16x16x32_bf16 v[92:95], a[184:187], v[184:187], v[92:95]
    v_mfma_f32_16x16x32_bf16 v[92:95], a[188:191], v[188:191], v[92:95]
    v_mfma_f32_16x16x32_bf16 v[72:75], v[60:63], v[160:163], v[72:75]
    s_waitcnt lgkmcnt(7)
    v_mfma_f32_16x16x32_bf16 v[76:79], a[0:3], v[96:99], v[76:79]
    ds_read_b128 v[128:131], v58 offset:1536
    s_waitcnt lgkmcnt(7)
    v_mfma_f32_16x16x32_bf16 v[76:79], a[4:7], v[100:103], v[76:79]
    ds_read_b128 v[132:135], v58 offset:1600
    s_add_u32 s48, s47, 10240
    s_waitcnt lgkmcnt(7)
    v_mfma_f32_16x16x32_bf16 v[76:79], a[8:11], v[104:107], v[76:79]
    buffer_load_dwordx2 v[30:31], v16, s[24:27], s48 offen
    s_waitcnt lgkmcnt(6)
    v_mfma_f32_16x16x32_bf16 v[76:79], a[12:15], v[108:111], v[76:79]
    ds_read_b128 v[136:139], v58 offset:1664
    s_waitcnt lgkmcnt(6)
    v_mfma_f32_16x16x32_bf16 v[76:79], a[16:19], v[112:115], v[76:79]
    ds_read_b128 v[140:143], v58 offset:1728
    s_waitcnt lgkmcnt(6)
    v_mfma_f32_16x16x32_bf16 v[76:79], a[20:23], v[116:119], v[76:79]
    ds_read_b128 v[144:147], v58 offset:1792
    s_waitcnt lgkmcnt(6)
    v_mfma_f32_16x16x32_bf16 v[76:79], a[24:27], v[120:123], v[76:79]
    ds_read_b128 v[148:151], v58 offset:1856
    s_movk_i32 s49, 10240
    s_waitcnt lgkmcnt(6)
    v_mfma_f32_16x16x32_bf16 v[76:79], a[28:31], v[124:127], v[76:79]
    buffer_load_dwordx2 v[46:47], v16, s[28:31], s49 offen
    v_mfma_f32_16x16x32_bf16 v[80:83], a[32:35], v[96:99], v[80:83]
    ds_read_b128 v[152:155], v58 offset:1920
    v_mfma_f32_16x16x32_bf16 v[80:83], a[36:39], v[100:103], v[80:83]
    ds_read_b128 v[156:159], v58 offset:1984
    v_mfma_f32_16x16x32_bf16 v[80:83], a[40:43], v[104:107], v[80:83]
    v_mfma_f32_16x16x32_bf16 v[80:83], a[44:47], v[108:111], v[80:83]
    s_add_u32 s48, s47, 12288
    v_mfma_f32_16x16x32_bf16 v[80:83], a[48:51], v[112:115], v[80:83]
    buffer_load_dwordx2 v[32:33], v16, s[24:27], s48 offen
    v_mfma_f32_16x16x32_bf16 v[80:83], a[52:55], v[116:119], v[80:83]
    v_mfma_f32_16x16x32_bf16 v[80:83], a[56:59], v[120:123], v[80:83]
    v_mfma_f32_16x16x32_bf16 v[80:83], a[60:63], v[124:127], v[80:83]
    v_mfma_f32_16x16x32_bf16 v[84:87], a[64:67], v[96:99], v[84:87]
    s_movk_i32 s49, 12288
    v_mfma_f32_16x16x32_bf16 v[84:87], a[68:71], v[100:103], v[84:87]
    buffer_load_dwordx2 v[48:49], v16, s[28:31], s49 offen
    v_mfma_f32_16x16x32_bf16 v[84:87], a[72:75], v[104:107], v[84:87]
    v_mfma_f32_16x16x32_bf16 v[84:87], a[76:79], v[108:111], v[84:87]
    v_mfma_f32_16x16x32_bf16 v[84:87], a[80:83], v[112:115], v[84:87]
    v_mfma_f32_16x16x32_bf16 v[84:87], a[84:87], v[116:119], v[84:87]
    s_add_u32 s48, s47, 14336
    v_mfma_f32_16x16x32_bf16 v[84:87], a[88:91], v[120:123], v[84:87]
    buffer_load_dwordx2 v[34:35], v16, s[24:27], s48 offen
    v_mfma_f32_16x16x32_bf16 v[84:87], a[92:95], v[124:127], v[84:87]
    v_mfma_f32_16x16x32_bf16 v[88:91], a[96:99], v[96:99], v[88:91]
    v_mfma_f32_16x16x32_bf16 v[88:91], a[100:103], v[100:103], v[88:91]
    v_mfma_f32_16x16x32_bf16 v[88:91], a[104:107], v[104:107], v[88:91]
    s_movk_i32 s49, 14336
    v_mfma_f32_16x16x32_bf16 v[88:91], a[108:111], v[108:111], v[88:91]
    buffer_load_dwordx2 v[50:51], v16, s[28:31], s49 offen
    v_mfma_f32_16x16x32_bf16 v[88:91], a[112:115], v[112:115], v[88:91]
    v_mfma_f32_16x16x32_bf16 v[88:91], a[116:119], v[116:119], v[88:91]
    v_mfma_f32_16x16x32_bf16 v[88:91], a[120:123], v[120:123], v[88:91]
    v_mfma_f32_16x16x32_bf16 v[88:91], a[124:127], v[124:127], v[88:91]
    v_mfma_f32_16x16x32_bf16 v[92:95], a[128:131], v[96:99], v[92:95]
    v_mfma_f32_16x16x32_bf16 v[92:95], a[132:135], v[100:103], v[92:95]
    v_mfma_f32_16x16x32_bf16 v[92:95], a[136:139], v[104:107], v[92:95]
    v_mfma_f32_16x16x32_bf16 v[92:95], a[140:143], v[108:111], v[92:95]
    v_mfma_f32_16x16x32_bf16 v[92:95], a[144:147], v[112:115], v[92:95]
    v_mfma_f32_16x16x32_bf16 v[92:95], a[148:151], v[116:119], v[92:95]
    v_mfma_f32_16x16x32_bf16 v[92:95], a[152:155], v[120:123], v[92:95]
    v_mfma_f32_16x16x32_bf16 v[92:95], a[156:159], v[124:127], v[92:95]
    v_mfma_f32_16x16x32_bf16 v[76:79], v[60:63], v[96:99], v[76:79]
    s_waitcnt lgkmcnt(7)
    v_mfma_f32_16x16x32_bf16 v[80:83], a[0:3], v[128:131], v[80:83]
    ds_read_b128 v[160:163], v58 offset:1024
    s_waitcnt lgkmcnt(7)
    v_mfma_f32_16x16x32_bf16 v[80:83], a[4:7], v[132:135], v[80:83]
    ds_read_b128 v[164:167], v58 offset:1088
    s_waitcnt lgkmcnt(7)
    v_mfma_f32_16x16x32_bf16 v[80:83], a[8:11], v[136:139], v[80:83]
    ds_read_b128 v[168:171], v58 offset:1152
    s_waitcnt lgkmcnt(7)
    v_mfma_f32_16x16x32_bf16 v[80:83], a[12:15], v[140:143], v[80:83]
    ds_read_b128 v[172:175], v58 offset:1216
    s_waitcnt lgkmcnt(7)
    v_mfma_f32_16x16x32_bf16 v[80:83], a[16:19], v[144:147], v[80:83]
    ds_read_b128 v[176:179], v58 offset:1280
    s_waitcnt lgkmcnt(7)
    v_mfma_f32_16x16x32_bf16 v[80:83], a[20:23], v[148:151], v[80:83]
    ds_read_b128 v[180:183], v58 offset:1344
    s_waitcnt lgkmcnt(7)
    v_mfma_f32_16x16x32_bf16 v[80:83], a[24:27], v[152:155], v[80:83]
    ds_read_b128 v[184:187], v58 offset:1408
    s_waitcnt lgkmcnt(7)
    v_mfma_f32_16x16x32_bf16 v[80:83], a[28:31], v[156:159], v[80:83]
    ds_read_b128 v[188:191], v58 offset:1472
    v_mfma_f32_16x16x32_bf16 v[84:87], a[32:35], v[128:131], v[84:87]
    s_waitcnt vmcnt(15)
    v_lshlrev_b32 v192, 16, v20
    v_and_b32 v193, 0xffff0000, v20
    v_mfma_f32_16x16x32_bf16 v[84:87], a[36:39], v[132:135], v[84:87]
    v_lshlrev_b32 v194, 16, v21
    v_and_b32 v195, 0xffff0000, v21
    v_mfma_f32_16x16x32_bf16 v[84:87], a[40:43], v[136:139], v[84:87]
    s_waitcnt vmcnt(14)
    v_fma_f32 v196, v192, v36, v37
    v_fma_f32 v197, v193, v36, v37
    v_mfma_f32_16x16x32_bf16 v[84:87], a[44:47], v[140:143], v[84:87]
    v_fma_f32 v198, v194, v36, v37
    v_fma_f32 v199, v195, v36, v37
    v_mfma_f32_16x16x32_bf16 v[84:87], a[48:51], v[144:147], v[84:87]
    s_waitcnt vmcnt(13)
    v_lshlrev_b32 v200, 16, v22
    v_and_b32 v201, 0xffff0000, v22
    v_mfma_f32_16x16x32_bf16 v[84:87], a[52:55], v[148:151], v[84:87]
    v_lshlrev_b32 v202, 16, v23
    v_and_b32 v203, 0xffff0000, v23
    v_mfma_f32_16x16x32_bf16 v[84:87], a[56:59], v[152:155], v[84:87]
    s_waitcnt vmcnt(12)
    v_fma_f32 v204, v200, v38, v39
    v_fma_f32 v205, v201, v38, v39
    v_mfma_f32_16x16x32_bf16 v[84:87], a[60:63], v[156:159], v[84:87]
    v_fma_f32 v206, v202, v38, v39
    v_fma_f32 v207, v203, v38, v39
    v_mfma_f32_16x16x32_bf16 v[88:91], a[64:67], v[128:131], v[88:91]
    s_waitcnt vmcnt(11)
    v_lshlrev_b32 v208, 16, v24
    v_and_b32 v209, 0xffff0000, v24
    v_mfma_f32_16x16x32_bf16 v[88:91], a[68:71], v[132:135], v[88:91]
    v_lshlrev_b32 v210, 16, v25
    v_and_b32 v211, 0xffff0000, v25
    v_mfma_f32_16x16x32_bf16 v[88:91], a[72:75], v[136:139], v[88:91]
    s_waitcnt vmcnt(10)
    v_fma_f32 v212, v208, v40, v41
    v_fma_f32 v213, v209, v40, v41
    v_mfma_f32_16x16x32_bf16 v[88:91], a[76:79], v[140:143], v[88:91]
    v_fma_f32 v214, v210, v40, v41
    v_fma_f32 v215, v211, v40, v41
    v_mfma_f32_16x16x32_bf16 v[88:91], a[80:83], v[144:147], v[88:91]
    s_waitcnt vmcnt(9)
    v_lshlrev_b32 v216, 16, v26
    v_and_b32 v217, 0xffff0000, v26
    v_mfma_f32_16x16x32_bf16 v[88:91], a[84:87], v[148:151], v[88:91]
    v_lshlrev_b32 v218, 16, v27
    v_and_b32 v219, 0xffff0000, v27
    v_mfma_f32_16x16x32_bf16 v[88:91], a[88:91], v[152:155], v[88:91]
    s_waitcnt vmcnt(8)
    v_fma_f32 v220, v216, v42, v43
    v_fma_f32 v221, v217, v42, v43
    v_mfma_f32_16x16x32_bf16 v[88:91], a[92:95], v[156:159], v[88:91]
    v_fma_f32 v222, v218, v42, v43
    v_fma_f32 v223, v219, v42, v43
    v_mfma_f32_16x16x32_bf16 v[92:95], a[96:99], v[128:131], v[92:95]
    s_waitcnt vmcnt(7)
    v_lshlrev_b32 v224, 16, v28
    v_and_b32 v225, 0xffff0000, v28
    v_mfma_f32_16x16x32_bf16 v[92:95], a[100:103], v[132:135], v[92:95]
    v_lshlrev_b32 v226, 16, v29
    v_and_b32 v227, 0xffff0000, v29
    v_mfma_f32_16x16x32_bf16 v[92:95], a[104:107], v[136:139], v[92:95]
    s_waitcnt vmcnt(6)
    v_fma_f32 v228, v224, v44, v45
    v_fma_f32 v229, v225, v44, v45
    v_mfma_f32_16x16x32_bf16 v[92:95], a[108:111], v[140:143], v[92:95]
    v_fma_f32 v230, v226, v44, v45
    v_fma_f32 v231, v227, v44, v45
    v_mfma_f32_16x16x32_bf16 v[92:95], a[112:115], v[144:147], v[92:95]
    s_waitcnt vmcnt(5)
    v_lshlrev_b32 v232, 16, v30
    v_and_b32 v233, 0xffff0000, v30
    v_mfma_f32_16x16x32_bf16 v[92:95], a[116:119], v[148:151], v[92:95]
    v_lshlrev_b32 v234, 16, v31
    v_and_b32 v235, 0xffff0000, v31
    v_mfma_f32_16x16x32_bf16 v[92:95], a[120:123], v[152:155], v[92:95]
    s_waitcnt vmcnt(4)
    v_fma_f32 v236, v232, v46, v47
    v_fma_f32 v237, v233, v46, v47
    v_mfma_f32_16x16x32_bf16 v[92:95], a[124:127], v[156:159], v[92:95]
    v_fma_f32 v238, v234, v46, v47
    v_fma_f32 v239, v235, v46, v47
    v_mfma_f32_16x16x32_bf16 v[80:83], v[60:63], v[128:131], v[80:83]
    s_waitcnt lgkmcnt(7)
    v_mfma_f32_16x16x32_bf16 v[84:87], a[0:3], v[160:163], v[84:87]
    ds_read_b128 v[96:99], v58 offset:512
    s_waitcnt lgkmcnt(7)
    v_mfma_f32_16x16x32_bf16 v[84:87], a[4:7], v[164:167], v[84:87]
    ds_read_b128 v[100:103], v58 offset:576
    s_waitcnt lgkmcnt(7)
    v_mfma_f32_16x16x32_bf16 v[84:87], a[8:11], v[168:171], v[84:87]
    ds_read_b128 v[104:107], v58 offset:640
    s_waitcnt lgkmcnt(7)
    v_mfma_f32_16x16x32_bf16 v[84:87], a[12:15], v[172:175], v[84:87]
    ds_read_b128 v[108:111], v58 offset:704
    s_waitcnt lgkmcnt(7)
    v_mfma_f32_16x16x32_bf16 v[84:87], a[16:19], v[176:179], v[84:87]
    ds_read_b128 v[112:115], v58 offset:768
    s_waitcnt lgkmcnt(7)
    v_mfma_f32_16x16x32_bf16 v[84:87], a[20:23], v[180:183], v[84:87]
    ds_read_b128 v[116:119], v58 offset:832
    s_waitcnt lgkmcnt(7)
    v_mfma_f32_16x16x32_bf16 v[84:87], a[24:27], v[184:187], v[84:87]
    ds_read_b128 v[120:123], v58 offset:896
    s_waitcnt lgkmcnt(7)
    v_mfma_f32_16x16x32_bf16 v[84:87], a[28:31], v[188:191], v[84:87]
    ds_read_b128 v[124:127], v58 offset:960
    v_mfma_f32_16x16x32_bf16 v[88:91], a[32:35], v[160:163], v[88:91]
    s_waitcnt vmcnt(3)
    v_lshlrev_b32 v240, 16, v32
    v_and_b32 v241, 0xffff0000, v32
    v_mfma_f32_16x16x32_bf16 v[88:91], a[36:39], v[164:167], v[88:91]
    v_lshlrev_b32 v242, 16, v33
    v_and_b32 v243, 0xffff0000, v33
    v_mfma_f32_16x16x32_bf16 v[88:91], a[40:43], v[168:171], v[88:91]
    s_waitcnt vmcnt(2)
    v_fma_f32 v244, v240, v48, v49
    v_fma_f32 v245, v241, v48, v49
    v_mfma_f32_16x16x32_bf16 v[88:91], a[44:47], v[172:175], v[88:91]
    v_fma_f32 v246, v242, v48, v49
    v_fma_f32 v247, v243, v48, v49
    v_mfma_f32_16x16x32_bf16 v[88:91], a[48:51], v[176:179], v[88:91]
    s_waitcnt vmcnt(1)
    v_lshlrev_b32 v248, 16, v34
    v_and_b32 v249, 0xffff0000, v34
    v_mfma_f32_16x16x32_bf16 v[88:91], a[52:55], v[180:183], v[88:91]
    v_lshlrev_b32 v250, 16, v35
    v_and_b32 v251, 0xffff0000, v35
    v_mfma_f32_16x16x32_bf16 v[88:91], a[56:59], v[184:187], v[88:91]
    s_waitcnt vmcnt(0)
    v_fma_f32 v252, v248, v50, v51
    v_fma_f32 v253, v249, v50, v51
    v_mfma_f32_16x16x32_bf16 v[88:91], a[60:63], v[188:191], v[88:91]
    v_fma_f32 v254, v250, v50, v51
    v_fma_f32 v255, v251, v50, v51
    v_mfma_f32_16x16x32_bf16 v[92:95], a[64:67], v[160:163], v[92:95]
    v_lshlrev_b32 v12, 5, v3
    v_lshl_add_u32 v12, v4, 2, v12
    v_mfma_f32_16x16x32_bf16 v[92:95], a[68:71], v[164:167], v[92:95]
    s_mul_i32 s48, s3, 4160
    s_add_u32 s48, s48, 84864
    v_mfma_f32_16x16x32_bf16 v[92:95], a[72:75], v[168:171], v[92:95]
    v_add_u32 v12, s48, v12
    v_add_u32 v6, 1024, v12
    v_mfma_f32_16x16x32_bf16 v[92:95], a[76:79], v[172:175], v[92:95]
    v_add_u32 v7, 2048, v12
    v_add_u32 v8, 3072, v12
    v_mfma_f32_16x16x32_bf16 v[92:95], a[80:83], v[176:179], v[92:95]
    v_lshrrev_b32 v9, 4, v0
    v_add_u32 v9, 2, v9
    v_mfma_f32_16x16x32_bf16 v[92:95], a[84:87], v[180:183], v[92:95]
    s_movk_i32 s50, 20480
    v_mul_lo_u32 v9, v9, s50
    v_mfma_f32_16x16x32_bf16 v[92:95], a[88:91], v[184:187], v[92:95]
    v_lshl_add_u32 v9, v3, 3, v9
    v_lshrrev_b32 v10, 2, v3
    v_mfma_f32_16x16x32_bf16 v[92:95], a[92:95], v[188:191], v[92:95]
    v_mul_u32_u24 v10, 4160, v10
    v_and_b32 v11, 3, v3
    v_mfma_f32_16x16x32_bf16 v[84:87], v[60:63], v[160:163], v[84:87]
    s_waitcnt lgkmcnt(7)
    v_mfma_f32_16x16x32_bf16 v[88:91], a[0:3], v[96:99], v[88:91]
    ds_read_b128 v[128:131], v58 offset:0
    s_waitcnt lgkmcnt(7)
    v_mfma_f32_16x16x32_bf16 v[88:91], a[4:7], v[100:103], v[88:91]
    ds_read_b128 v[132:135], v58 offset:64
    s_waitcnt lgkmcnt(7)
    v_mfma_f32_16x16x32_bf16 v[88:91], a[8:11], v[104:107], v[88:91]
    ds_read_b128 v[136:139], v58 offset:128
    s_waitcnt lgkmcnt(7)
    v_mfma_f32_16x16x32_bf16 v[88:91], a[12:15], v[108:111], v[88:91]
    ds_read_b128 v[140:143], v58 offset:192
    s_waitcnt lgkmcnt(7)
    v_mfma_f32_16x16x32_bf16 v[88:91], a[16:19], v[112:115], v[88:91]
    ds_read_b128 v[144:147], v58 offset:256
    s_waitcnt lgkmcnt(7)
    v_mfma_f32_16x16x32_bf16 v[88:91], a[20:23], v[116:119], v[88:91]
    ds_read_b128 v[148:151], v58 offset:320
    s_waitcnt lgkmcnt(7)
    v_mfma_f32_16x16x32_bf16 v[88:91], a[24:27], v[120:123], v[88:91]
    ds_read_b128 v[152:155], v58 offset:384
    s_waitcnt lgkmcnt(7)
    v_mfma_f32_16x16x32_bf16 v[88:91], a[28:31], v[124:127], v[88:91]
    ds_read_b128 v[156:159], v58 offset:448
    v_mfma_f32_16x16x32_bf16 v[92:95], a[32:35], v[96:99], v[92:95]
    v_lshl_add_u32 v10, v11, 3, v10
    v_lshrrev_b32 v11, 4, v0
    v_mfma_f32_16x16x32_bf16 v[92:95], a[36:39], v[100:103], v[92:95]
    v_lshl_add_u32 v10, v11, 5, v10
    v_add_u32 v10, 84864, v10
    v_mfma_f32_16x16x32_bf16 v[92:95], a[40:43], v[104:107], v[92:95]
    s_lshl_b32 s51, s52, 7
    v_mfma_f32_16x16x32_bf16 v[92:95], a[44:47], v[108:111], v[92:95]
    v_mfma_f32_16x16x32_bf16 v[92:95], a[48:51], v[112:115], v[92:95]
    v_mfma_f32_16x16x32_bf16 v[92:95], a[52:55], v[116:119], v[92:95]
    v_mfma_f32_16x16x32_bf16 v[92:95], a[56:59], v[120:123], v[92:95]
    v_mfma_f32_16x16x32_bf16 v[92:95], a[60:63], v[124:127], v[92:95]
    v_mfma_f32_16x16x32_bf16 v[88:91], v[60:63], v[96:99], v[88:91]
    s_waitcnt lgkmcnt(7)
    v_mfma_f32_16x16x32_bf16 v[92:95], a[0:3], v[128:131], v[92:95]
    s_waitcnt lgkmcnt(6)
    v_mfma_f32_16x16x32_bf16 v[92:95], a[4:7], v[132:135], v[92:95]
    s_waitcnt lgkmcnt(5)
    v_mfma_f32_16x16x32_bf16 v[92:95], a[8:11], v[136:139], v[92:95]
    s_waitcnt lgkmcnt(4)
    v_mfma_f32_16x16x32_bf16 v[92:95], a[12:15], v[140:143], v[92:95]
    s_waitcnt lgkmcnt(3)
    v_mfma_f32_16x16x32_bf16 v[92:95], a[16:19], v[144:147], v[92:95]
    s_waitcnt lgkmcnt(2)
    v_mfma_f32_16x16x32_bf16 v[92:95], a[20:23], v[148:151], v[92:95]
    s_waitcnt lgkmcnt(1)
    v_mfma_f32_16x16x32_bf16 v[92:95], a[24:27], v[152:155], v[92:95]
    s_waitcnt lgkmcnt(0)
    v_mfma_f32_16x16x32_bf16 v[92:95], a[28:31], v[156:159], v[92:95]
    v_mfma_f32_16x16x32_bf16 v[92:95], v[60:63], v[128:131], v[92:95]
    v_cvt_pk_bf16_f32 v96, v64, v66
    v_cvt_pk_bf16_f32 v97, v65, v67
    ds_write2_b32 v12, v96, v97 offset0:0 offset1:4
    v_cvt_pk_bf16_f32 v98, v68, v70
    v_cvt_pk_bf16_f32 v99, v69, v71
    ds_write2_b32 v12, v98, v99 offset0:128 offset1:132
    v_cvt_pk_bf16_f32 v100, v72, v74
    v_cvt_pk_bf16_f32 v101, v73, v75
    ds_write2_b32 v6, v100, v101 offset0:0 offset1:4
    v_cvt_pk_bf16_f32 v102, v76, v78
    v_cvt_pk_bf16_f32 v103, v77, v79
    ds_write2_b32 v6, v102, v103 offset0:128 offset1:132
    v_cvt_pk_bf16_f32 v104, v80, v82
    v_cvt_pk_bf16_f32 v105, v81, v83
    ds_write2_b32 v7, v104, v105 offset0:0 offset1:4
    v_cvt_pk_bf16_f32 v106, v84, v86
    v_cvt_pk_bf16_f32 v107, v85, v87
    ds_write2_b32 v7, v106, v107 offset0:128 offset1:132
    v_cvt_pk_bf16_f32 v108, v88, v90
    v_cvt_pk_bf16_f32 v109, v89, v91
    ds_write2_b32 v8, v108, v109 offset0:0 offset1:4
    v_cvt_pk_bf16_f32 v110, v92, v94
    v_cvt_pk_bf16_f32 v111, v93, v95
    ds_write2_b32 v8, v110, v111 offset0:128 offset1:132
    s_waitcnt lgkmcnt(0)
    s_barrier
    ds_read_b64_tr_b16 v[64:65], v10 offset:0
    ds_read_b64_tr_b16 v[66:67], v10 offset:512
    ds_read_b64_tr_b16 v[68:69], v10 offset:1024
    ds_read_b64_tr_b16 v[70:71], v10 offset:1536
    ds_read_b64_tr_b16 v[72:73], v10 offset:2048
    ds_read_b64_tr_b16 v[74:75], v10 offset:2560
    ds_read_b64_tr_b16 v[76:77], v10 offset:3072
    ds_read_b64_tr_b16 v[78:79], v10 offset:3584
    s_waitcnt lgkmcnt(7)
    v_lshlrev_b32 v96, 16, v64
    v_and_b32 v97, 0xffff0000, v64
    v_lshlrev_b32 v98, 16, v65
    v_and_b32 v99, 0xffff0000, v65
    s_waitcnt lgkmcnt(6)
    v_lshlrev_b32 v100, 16, v66
    v_and_b32 v101, 0xffff0000, v66
    v_lshlrev_b32 v102, 16, v67
    v_and_b32 v103, 0xffff0000, v67
    v_pk_fma_f32 v[192:193], v[196:197], v[96:97], v[192:193]
    v_pk_fma_f32 v[200:201], v[204:205], v[100:101], v[200:201]
    v_pk_fma_f32 v[194:195], v[198:199], v[98:99], v[194:195]
    v_pk_fma_f32 v[202:203], v[206:207], v[102:103], v[202:203]
    v_cvt_pk_bf16_f32 v140, v192, v193
    v_cvt_pk_bf16_f32 v141, v194, v195
    v_cvt_pk_bf16_f32 v142, v200, v201
    v_cvt_pk_bf16_f32 v143, v202, v203
    s_add_u32 s49, s51, 0
    buffer_store_dwordx2 v[140:141], v9, s[32:35], s49 offen sc1
    buffer_store_dwordx2 v[64:65], v9, s[36:39], s49 offen sc1
    s_add_u32 s49, s51, 327680
    buffer_store_dwordx2 v[142:143], v9, s[32:35], s49 offen sc1
    buffer_store_dwordx2 v[66:67], v9, s[36:39], s49 offen sc1
    s_waitcnt lgkmcnt(5)
    v_lshlrev_b32 v104, 16, v68
    v_and_b32 v105, 0xffff0000, v68
    v_lshlrev_b32 v106, 16, v69
    v_and_b32 v107, 0xffff0000, v69
    s_waitcnt lgkmcnt(4)
    v_lshlrev_b32 v108, 16, v70
    v_and_b32 v109, 0xffff0000, v70
    v_lshlrev_b32 v110, 16, v71
    v_and_b32 v111, 0xffff0000, v71
    v_pk_fma_f32 v[208:209], v[212:213], v[104:105], v[208:209]
    v_pk_fma_f32 v[216:217], v[220:221], v[108:109], v[216:217]
    v_pk_fma_f32 v[210:211], v[214:215], v[106:107], v[210:211]
    v_pk_fma_f32 v[218:219], v[222:223], v[110:111], v[218:219]
    v_cvt_pk_bf16_f32 v144, v208, v209
    v_cvt_pk_bf16_f32 v145, v210, v211
    v_cvt_pk_bf16_f32 v146, v216, v217
    v_cvt_pk_bf16_f32 v147, v218, v219
    s_add_u32 s49, s51, 655360
    buffer_store_dwordx2 v[144:145], v9, s[32:35], s49 offen sc1
    buffer_store_dwordx2 v[68:69], v9, s[36:39], s49 offen sc1
    s_add_u32 s49, s51, 983040
    buffer_store_dwordx2 v[146:147], v9, s[32:35], s49 offen sc1
    buffer_store_dwordx2 v[70:71], v9, s[36:39], s49 offen sc1
    s_waitcnt lgkmcnt(3)
    v_lshlrev_b32 v96, 16, v72
    v_and_b32 v97, 0xffff0000, v72
    v_lshlrev_b32 v98, 16, v73
    v_and_b32 v99, 0xffff0000, v73
    s_waitcnt lgkmcnt(2)
    v_lshlrev_b32 v100, 16, v74
    v_and_b32 v101, 0xffff0000, v74
    v_lshlrev_b32 v102, 16, v75
    v_and_b32 v103, 0xffff0000, v75
    v_pk_fma_f32 v[224:225], v[228:229], v[96:97], v[224:225]
    v_pk_fma_f32 v[232:233], v[236:237], v[100:101], v[232:233]
    v_pk_fma_f32 v[226:227], v[230:231], v[98:99], v[226:227]
    v_pk_fma_f32 v[234:235], v[238:239], v[102:103], v[234:235]
    v_cvt_pk_bf16_f32 v140, v224, v225
    v_cvt_pk_bf16_f32 v141, v226, v227
    v_cvt_pk_bf16_f32 v142, v232, v233
    v_cvt_pk_bf16_f32 v143, v234, v235
    s_add_u32 s49, s51, 1310720
    buffer_store_dwordx2 v[140:141], v9, s[32:35], s49 offen sc1
    buffer_store_dwordx2 v[72:73], v9, s[36:39], s49 offen sc1
    s_add_u32 s49, s51, 1638400
    buffer_store_dwordx2 v[142:143], v9, s[32:35], s49 offen sc1
    buffer_store_dwordx2 v[74:75], v9, s[36:39], s49 offen sc1
    s_waitcnt lgkmcnt(1)
    v_lshlrev_b32 v104, 16, v76
    v_and_b32 v105, 0xffff0000, v76
    v_lshlrev_b32 v106, 16, v77
    v_and_b32 v107, 0xffff0000, v77
    s_waitcnt lgkmcnt(0)
    v_lshlrev_b32 v108, 16, v78
    v_and_b32 v109, 0xffff0000, v78
    v_lshlrev_b32 v110, 16, v79
    v_and_b32 v111, 0xffff0000, v79
    v_pk_fma_f32 v[240:241], v[244:245], v[104:105], v[240:241]
    v_pk_fma_f32 v[248:249], v[252:253], v[108:109], v[248:249]
    v_pk_fma_f32 v[242:243], v[246:247], v[106:107], v[242:243]
    v_pk_fma_f32 v[250:251], v[254:255], v[110:111], v[250:251]
    v_cvt_pk_bf16_f32 v144, v240, v241
    v_cvt_pk_bf16_f32 v145, v242, v243
    v_cvt_pk_bf16_f32 v146, v248, v249
    v_cvt_pk_bf16_f32 v147, v250, v251
    s_add_u32 s49, s51, 1966080
    buffer_store_dwordx2 v[144:145], v9, s[32:35], s49 offen sc1
    buffer_store_dwordx2 v[76:77], v9, s[36:39], s49 offen sc1
    s_add_u32 s49, s51, 2293760
    buffer_store_dwordx2 v[146:147], v9, s[32:35], s49 offen sc1
    buffer_store_dwordx2 v[78:79], v9, s[36:39], s49 offen sc1
    s_endpgm
L_repack:
    s_sub_u32 s44, s2, 160
    s_cmp_ge_u32 s44, 80
    s_cbranch_scc1 L_conv_end
    s_mul_i32 s45, s44, 52429
    s_lshr_b32 s45, s45, 20
    s_mul_i32 s46, s45, 20
    s_sub_u32 s46, s44, s46
    s_cmp_lt_u32 s45, 3
    s_cselect_b32 s47, 2560, 0
    s_cselect_b32 s48, s45, 0
    s_add_u32 s47, s47, 1280
    s_mul_i32 s48, s48, 1280
    s_mul_i32 s49, s46, 32
    s_mul_i32 s49, s49, s47
    s_add_u32 s48, s48, s49
    v_lshl_add_u32 v5, v2, 6, v1
    s_waitcnt vmcnt(0) lgkmcnt(0)
    s_cmp_lt_u32 s45, 3
    s_cselect_b32 s16, s12, s14
    s_cselect_b32 s17, s13, s15
    s_cselect_b32 s18, 2457600, 0
    s_cmp_ge_u32 s45, 3
    s_cselect_b32 s18, 819200, s18
    s_mov_b32 s19, 0x20000
    s_lshl_b32 s50, s3, 10
    v_add_u32 v6, 0, v5
    v_mul_u32_u24 v7, 52429, v6
    v_lshrrev_b32 v7, 22, v7
    v_mul_u32_u24 v8, 80, v7
    v_sub_u32 v8, v6, v8
    v_mul_lo_u32 v7, v7, s47
    v_lshl_add_u32 v10, v8, 4, v7
    s_add_u32 m0, s50, 0
    s_nop 0
    buffer_load_dwordx4 v10, s[16:19], s48 offen lds
    v_add_u32 v6, 256, v5
    v_mul_u32_u24 v7, 52429, v6
    v_lshrrev_b32 v7, 22, v7
    v_mul_u32_u24 v8, 80, v7
    v_sub_u32 v8, v6, v8
    v_mul_lo_u32 v7, v7, s47
    v_lshl_add_u32 v11, v8, 4, v7
    s_add_u32 m0, s50, 4096
    s_nop 0
    buffer_load_dwordx4 v11, s[16:19], s48 offen lds
    v_add_u32 v6, 512, v5
    v_mul_u32_u24 v7, 52429, v6
    v_lshrrev_b32 v7, 22, v7
    v_mul_u32_u24 v8, 80, v7
    v_sub_u32 v8, v6, v8
    v_mul_lo_u32 v7, v7, s47
    v_lshl_add_u32 v12, v8, 4, v7
    s_add_u32 m0, s50, 8192
    s_nop 0
    buffer_load_dwordx4 v12, s[16:19], s48 offen lds
    v_add_u32 v6, 768, v5
    v_mul_u32_u24 v7, 52429, v6
    v_lshrrev_b32 v7, 22, v7
    v_mul_u32_u24 v8, 80, v7
    v_sub_u32 v8, v6, v8
    v_mul_lo_u32 v7, v7, s47
    v_lshl_add_u32 v13, v8, 4, v7
    s_add_u32 m0, s50, 12288
    s_nop 0
    buffer_load_dwordx4 v13, s[16:19], s48 offen lds
    v_add_u32 v6, 1024, v5
    v_mul_u32_u24 v7, 52429, v6
    v_lshrrev_b32 v7, 22, v7
    v_mul_u32_u24 v8, 80, v7
    v_sub_u32 v8, v6, v8
    v_mul_lo_u32 v7, v7, s47
    v_lshl_add_u32 v14, v8, 4, v7
    s_add_u32 m0, s50, 16384
    s_nop 0
    buffer_load_dwordx4 v14, s[16:19], s48 offen lds
    v_add_u32 v6, 1280, v5
    v_mul_u32_u24 v7, 52429, v6
    v_lshrrev_b32 v7, 22, v7
    v_mul_u32_u24 v8, 80, v7
    v_sub_u32 v8, v6, v8
    v_mul_lo_u32 v7, v7, s47
    v_lshl_add_u32 v15, v8, 4, v7
    s_add_u32 m0, s50, 20480
    s_nop 0
    buffer_load_dwordx4 v15, s[16:19], s48 offen lds
    v_add_u32 v6, 1536, v5
    v_mul_u32_u24 v7, 52429, v6
    v_lshrrev_b32 v7, 22, v7
    v_mul_u32_u24 v8, 80, v7
    v_sub_u32 v8, v6, v8
    v_mul_lo_u32 v7, v7, s47
    v_lshl_add_u32 v16, v8, 4, v7
    s_add_u32 m0, s50, 24576
    s_nop 0
    buffer_load_dwordx4 v16, s[16:19], s48 offen lds
    v_add_u32 v6, 1792, v5
    v_mul_u32_u24 v7, 52429, v6
    v_lshrrev_b32 v7, 22, v7
    v_mul_u32_u24 v8, 80, v7
    v_sub_u32 v8, v6, v8
    v_mul_lo_u32 v7, v7, s47
    v_lshl_add_u32 v17, v8, 4, v7
    s_add_u32 m0, s50, 28672
    s_nop 0
    buffer_load_dwordx4 v17, s[16:19], s48 offen lds
    v_add_u32 v6, 2048, v5
    v_mul_u32_u24 v7, 52429, v6
    v_lshrrev_b32 v7, 22, v7
    v_mul_u32_u24 v8, 80, v7
    v_sub_u32 v8, v6, v8
    v_mul_lo_u32 v7, v7, s47
    v_lshl_add_u32 v18, v8, 4, v7
    s_add_u32 m0, s50, 32768
    s_nop 0
    buffer_load_dwordx4 v18, s[16:19], s48 offen lds
    v_add_u32 v6, 2304, v5
    v_mul_u32_u24 v7, 52429, v6
    v_lshrrev_b32 v7, 22, v7
    v_mul_u32_u24 v8, 80, v7
    v_sub_u32 v8, v6, v8
    v_mul_lo_u32 v7, v7, s47
    v_lshl_add_u32 v19, v8, 4, v7
    s_add_u32 m0, s50, 36864
    s_nop 0
    buffer_load_dwordx4 v19, s[16:19], s48 offen lds
    s_cmp_lt_u32 s45, 3
    s_cselect_b32 s51, 10584064, 0
    s_cselect_b32 s22, 2621440, 0
    s_cmp_ge_u32 s45, 3
    s_cselect_b32 s51, 13205504, s51
    s_cselect_b32 s22, 819200, s22
    s_add_u32 s20, s8, s51
    s_addc_u32 s21, s9, 0
    s_mov_b32 s23, 0x20000
    s_add_u32 s24, s8, 14024704
    s_addc_u32 s25, s9, 0
    s_mov_b32 s26, 8192
    s_mov_b32 s27, 0x20000
    v_lshrrev_b32 v20, 2, v3
    v_lshl_add_u32 v20, v4, 2, v20
    v_mul_u32_u24 v20, 1280, v20
    v_and_b32 v21, 3, v3
    v_lshl_add_u32 v20, v21, 3, v20
    v_lshl_add_u32 v20, v2, 5, v20
    s_mov_b32 s52, 0x3f803f80
    v_mov_b32 v24, s52
    v_mov_b32 v25, s52
    v_mov_b32 v26, s52
    v_mov_b32 v27, s52
    s_mul_i32 s53, s45, 40
    s_lshl_b32 s54, s46, 11
    v_mov_b32 v28, 0x40000000
    s_waitcnt vmcnt(0)
    s_barrier
    ds_read_b64_tr_b16 v[32:33], v20 offset:0
    ds_read_b64_tr_b16 v[34:35], v20 offset:20480
    ds_read_b64_tr_b16 v[36:37], v20 offset:128
    ds_read_b64_tr_b16 v[38:39], v20 offset:20608
    ds_read_b64_tr_b16 v[40:41], v20 offset:256
    ds_read_b64_tr_b16 v[42:43], v20 offset:20736
    ds_read_b64_tr_b16 v[44:45], v20 offset:384
    ds_read_b64_tr_b16 v[46:47], v20 offset:20864
    ds_read_b64_tr_b16 v[48:49], v20 offset:512
    ds_read_b64_tr_b16 v[50:51], v20 offset:20992
    ds_read_b64_tr_b16 v[52:53], v20 offset:640
    ds_read_b64_tr_b16 v[54:55], v20 offset:21120
    ds_read_b64_tr_b16 v[56:57], v20 offset:768
    ds_read_b64_tr_b16 v[58:59], v20 offset:21248
    ds_read_b64_tr_b16 v[60:61], v20 offset:896
    ds_read_b64_tr_b16 v[62:63], v20 offset:21376
    ds_read_b64_tr_b16 v[64:65], v20 offset:1024
    ds_read_b64_tr_b16 v[66:67], v20 offset:21504
    ds_read_b64_tr_b16 v[68:69], v20 offset:1152
    ds_read_b64_tr_b16 v[70:71], v20 offset:21632
    s_cmp_ge_u32 s45, 3
    s_cbranch_scc1 BL_rp2_wo_1
    v_lshl_add_u32 v21, v2, 4, v3
    v_add_u32 v21, 0, v21
    v_mul_u32_u24 v22, 52429, v21
    v_lshrrev_b32 v22, 21, v22
    v_mul_u32_u24 v23, 40, v22
    v_sub_u32 v23, v21, v23
    v_add_u32 v23, s53, v23
    v_lshl_add_u32 v90, v22, 7, v23
    v_lshlrev_b32 v90, 2, v90
    v_lshrrev_b32 v29, 5, v23
    v_lshl_add_u32 v22, v22, 2, v29
    v_mul_u32_u24 v22, 40960, v22
    v_bfe_u32 v29, v23, 4, 1
    v_lshl_add_u32 v22, v29, 10, v22
    v_and_b32 v29, 15, v23
    v_lshl_add_u32 v29, v4, 4, v29
    v_lshl_add_u32 v80, v29, 4, v22
    v_lshl_add_u32 v21, v2, 4, v3
    v_add_u32 v21, 64, v21
    v_mul_u32_u24 v22, 52429, v21
    v_lshrrev_b32 v22, 21, v22
    v_mul_u32_u24 v23, 40, v22
    v_sub_u32 v23, v21, v23
    v_add_u32 v23, s53, v23
    v_lshl_add_u32 v91, v22, 7, v23
    v_lshlrev_b32 v91, 2, v91
    v_lshrrev_b32 v29, 5, v23
    v_lshl_add_u32 v22, v22, 2, v29
    v_mul_u32_u24 v22, 40960, v22
    v_bfe_u32 v29, v23, 4, 1
    v_lshl_add_u32 v22, v29, 10, v22
    v_and_b32 v29, 15, v23
    v_lshl_add_u32 v29, v4, 4, v29
    v_lshl_add_u32 v81, v29, 4, v22
    v_lshl_add_u32 v21, v2, 4, v3
    v_add_u32 v21, 128, v21
    v_mul_u32_u24 v22, 52429, v21
    v_lshrrev_b32 v22, 21, v22
    v_mul_u32_u24 v23, 40, v22
    v_sub_u32 v23, v21, v23
    v_add_u32 v23, s53, v23
    v_lshl_add_u32 v92, v22, 7, v23
    v_lshlrev_b32 v92, 2, v92
    v_lshrrev_b32 v29, 5, v23
    v_lshl_add_u32 v22, v22, 2, v29
    v_mul_u32_u24 v22, 40960, v22
    v_bfe_u32 v29, v23, 4, 1
    v_lshl_add_u32 v22, v29, 10, v22
    v_and_b32 v29, 15, v23
    v_lshl_add_u32 v29, v4, 4, v29
    v_lshl_add_u32 v82, v29, 4, v22
    v_lshl_add_u32 v21, v2, 4, v3
    v_add_u32 v21, 192, v21
    v_mul_u32_u24 v22, 52429, v21
    v_lshrrev_b32 v22, 21, v22
    v_mul_u32_u24 v23, 40, v22
    v_sub_u32 v23, v21, v23
    v_add_u32 v23, s53, v23
    v_lshl_add_u32 v93, v22, 7, v23
    v_lshlrev_b32 v93, 2, v93
    v_lshrrev_b32 v29, 5, v23
    v_lshl_add_u32 v22, v22, 2, v29
    v_mul_u32_u24 v22, 40960, v22
    v_bfe_u32 v29, v23, 4, 1
    v_lshl_add_u32 v22, v29, 10, v22
    v_and_b32 v29, 15, v23
    v_lshl_add_u32 v29, v4, 4, v29
    v_lshl_add_u32 v83, v29, 4, v22
    v_lshl_add_u32 v21, v2, 4, v3
    v_add_u32 v21, 256, v21
    v_mul_u32_u24 v22, 52429, v21
    v_lshrrev_b32 v22, 21, v22
    v_mul_u32_u24 v23, 40, v22
    v_sub_u32 v23, v21, v23
    v_add_u32 v23, s53, v23
    v_lshl_add_u32 v94, v22, 7, v23
    v_lshlrev_b32 v94, 2, v94
    v_lshrrev_b32 v29, 5, v23
    v_lshl_add_u32 v22, v22, 2, v29
    v_mul_u32_u24 v22, 40960, v22
    v_bfe_u32 v29, v23, 4, 1
    v_lshl_add_u32 v22, v29, 10, v22
    v_and_b32 v29, 15, v23
    v_lshl_add_u32 v29, v4, 4, v29
    v_lshl_add_u32 v84, v29, 4, v22
    v_lshl_add_u32 v21, v2, 4, v3
    v_add_u32 v21, 320, v21
    v_mul_u32_u24 v22, 52429, v21
    v_lshrrev_b32 v22, 21, v22
    v_mul_u32_u24 v23, 40, v22
    v_sub_u32 v23, v21, v23
    v_add_u32 v23, s53, v23
    v_lshl_add_u32 v95, v22, 7, v23
    v_lshlrev_b32 v95, 2, v95
    v_lshrrev_b32 v29, 5, v23
    v_lshl_add_u32 v22, v22, 2, v29
    v_mul_u32_u24 v22, 40960, v22
    v_bfe_u32 v29, v23, 4, 1
    v_lshl_add_u32 v22, v29, 10, v22
    v_and_b32 v29, 15, v23
    v_lshl_add_u32 v29, v4, 4, v29
    v_lshl_add_u32 v85, v29, 4, v22
    v_lshl_add_u32 v21, v2, 4, v3
    v_add_u32 v21, 384, v21
    v_mul_u32_u24 v22, 52429, v21
    v_lshrrev_b32 v22, 21, v22
    v_mul_u32_u24 v23, 40, v22
    v_sub_u32 v23, v21, v23
    v_add_u32 v23, s53, v23
    v_lshl_add_u32 v96, v22, 7, v23
    v_lshlrev_b32 v96, 2, v96
    v_lshrrev_b32 v29, 5, v23
    v_lshl_add_u32 v22, v22, 2, v29
    v_mul_u32_u24 v22, 40960, v22
    v_bfe_u32 v29, v23, 4, 1
    v_lshl_add_u32 v22, v29, 10, v22
    v_and_b32 v29, 15, v23
    v_lshl_add_u32 v29, v4, 4, v29
    v_lshl_add_u32 v86, v29, 4, v22
    v_lshl_add_u32 v21, v2, 4, v3
    v_add_u32 v21, 448, v21
    v_mul_u32_u24 v22, 52429, v21
    v_lshrrev_b32 v22, 21, v22
    v_mul_u32_u24 v23, 40, v22
    v_sub_u32 v23, v21, v23
    v_add_u32 v23, s53, v23
    v_lshl_add_u32 v97, v22, 7, v23
    v_lshlrev_b32 v97, 2, v97
    v_lshrrev_b32 v29, 5, v23
    v_lshl_add_u32 v22, v22, 2, v29
    v_mul_u32_u24 v22, 40960, v22
    v_bfe_u32 v29, v23, 4, 1
    v_lshl_add_u32 v22, v29, 10, v22
    v_and_b32 v29, 15, v23
    v_lshl_add_u32 v29, v4, 4, v29
    v_lshl_add_u32 v87, v29, 4, v22
    v_lshl_add_u32 v21, v2, 4, v3
    v_add_u32 v21, 512, v21
    v_mul_u32_u24 v22, 52429, v21
    v_lshrrev_b32 v22, 21, v22
    v_mul_u32_u24 v23, 40, v22
    v_sub_u32 v23, v21, v23
    v_add_u32 v23, s53, v23
    v_lshl_add_u32 v98, v22, 7, v23
    v_lshlrev_b32 v98, 2, v98
    v_lshrrev_b32 v29, 5, v23
    v_lshl_add_u32 v22, v22, 2, v29
    v_mul_u32_u24 v22, 40960, v22
    v_bfe_u32 v29, v23, 4, 1
    v_lshl_add_u32 v22, v29, 10, v22
    v_and_b32 v29, 15, v23
    v_lshl_add_u32 v29, v4, 4, v29
    v_lshl_add_u32 v88, v29, 4, v22
    v_lshl_add_u32 v21, v2, 4, v3
    v_add_u32 v21, 576, v21
    v_mul_u32_u24 v22, 52429, v21
    v_lshrrev_b32 v22, 21, v22
    v_mul_u32_u24 v23, 40, v22
    v_sub_u32 v23, v21, v23
    v_add_u32 v23, s53, v23
    v_lshl_add_u32 v99, v22, 7, v23
    v_lshlrev_b32 v99, 2, v99
    v_lshrrev_b32 v29, 5, v23
    v_lshl_add_u32 v22, v22, 2, v29
    v_mul_u32_u24 v22, 40960, v22
    v_bfe_u32 v29, v23, 4, 1
    v_lshl_add_u32 v22, v29, 10, v22
    v_and_b32 v29, 15, v23
    v_lshl_add_u32 v29, v4, 4, v29
    v_lshl_add_u32 v89, v29, 4, v22
    s_branch BL_rp2_go_2
BL_rp2_wo_1:
    v_lshl_add_u32 v21, v2, 4, v3
    v_add_u32 v21, 0, v21
    v_lshrrev_b32 v22, 5, v21
    v_mul_u32_u24 v22, 40960, v22
    v_bfe_u32 v29, v21, 4, 1
    v_lshl_add_u32 v22, v29, 10, v22
    v_and_b32 v29, 15, v21
    v_lshl_add_u32 v29, v4, 4, v29
    v_lshl_add_u32 v80, v29, 4, v22
    v_mov_b32 v90, v28
    v_lshl_add_u32 v21, v2, 4, v3
    v_add_u32 v21, 64, v21
    v_lshrrev_b32 v22, 5, v21
    v_mul_u32_u24 v22, 40960, v22
    v_bfe_u32 v29, v21, 4, 1
    v_lshl_add_u32 v22, v29, 10, v22
    v_and_b32 v29, 15, v21
    v_lshl_add_u32 v29, v4, 4, v29
    v_lshl_add_u32 v81, v29, 4, v22
    v_mov_b32 v91, v28
    v_lshl_add_u32 v21, v2, 4, v3
    v_add_u32 v21, 128, v21
    v_lshrrev_b32 v22, 5, v21
    v_mul_u32_u24 v22, 40960, v22
    v_bfe_u32 v29, v21, 4, 1
    v_lshl_add_u32 v22, v29, 10, v22
    v_and_b32 v29, 15, v21
    v_lshl_add_u32 v29, v4, 4, v29
    v_lshl_add_u32 v82, v29, 4, v22
    v_mov_b32 v92, v28
    v_lshl_add_u32 v21, v2, 4, v3
    v_add_u32 v21, 192, v21
    v_lshrrev_b32 v22, 5, v21
    v_mul_u32_u24 v22, 40960, v22
    v_bfe_u32 v29, v21, 4, 1
    v_lshl_add_u32 v22, v29, 10, v22
    v_and_b32 v29, 15, v21
    v_lshl_add_u32 v29, v4, 4, v29
    v_lshl_add_u32 v83, v29, 4, v22
    v_mov_b32 v93, v28
    v_lshl_add_u32 v21, v2, 4, v3
    v_add_u32 v21, 256, v21
    v_lshrrev_b32 v22, 5, v21
    v_mul_u32_u24 v22, 40960, v22
    v_bfe_u32 v29, v21, 4, 1
    v_lshl_add_u32 v22, v29, 10, v22
    v_and_b32 v29, 15, v21
    v_lshl_add_u32 v29, v4, 4, v29
    v_lshl_add_u32 v84, v29, 4, v22
    v_mov_b32 v94, v28
    v_lshl_add_u32 v21, v2, 4, v3
    v_add_u32 v21, 320, v21
    v_lshrrev_b32 v22, 5, v21
    v_mul_u32_u24 v22, 40960, v22
    v_bfe_u32 v29, v21, 4, 1
    v_lshl_add_u32 v22, v29, 10, v22
    v_and_b32 v29, 15, v21
    v_lshl_add_u32 v29, v4, 4, v29
    v_lshl_add_u32 v85, v29, 4, v22
    v_mov_b32 v95, v28
    v_lshl_add_u32 v21, v2, 4, v3
    v_add_u32 v21, 384, v21
    v_lshrrev_b32 v22, 5, v21
    v_mul_u32_u24 v22, 40960, v22
    v_bfe_u32 v29, v21, 4, 1
    v_lshl_add_u32 v22, v29, 10, v22
    v_and_b32 v29, 15, v21
    v_lshl_add_u32 v29, v4, 4, v29
    v_lshl_add_u32 v86, v29, 4, v22
    v_mov_b32 v96, v28
    v_lshl_add_u32 v21, v2, 4, v3
    v_add_u32 v21, 448, v21
    v_lshrrev_b32 v22, 5, v21
    v_mul_u32_u24 v22, 40960, v22
    v_bfe_u32 v29, v21, 4, 1
    v_lshl_add_u32 v22, v29, 10, v22
    v_and_b32 v29, 15, v21
    v_lshl_add_u32 v29, v4, 4, v29
    v_lshl_add_u32 v87, v29, 4, v22
    v_mov_b32 v97, v28
    v_lshl_add_u32 v21, v2, 4, v3
    v_add_u32 v21, 512, v21
    v_lshrrev_b32 v22, 5, v21
    v_mul_u32_u24 v22, 40960, v22
    v_bfe_u32 v29, v21, 4, 1
    v_lshl_add_u32 v22, v29, 10, v22
    v_and_b32 v29, 15, v21
    v_lshl_add_u32 v29, v4, 4, v29
    v_lshl_add_u32 v88, v29, 4, v22
    v_mov_b32 v98, v28
    v_lshl_add_u32 v21, v2, 4, v3
    v_add_u32 v21, 576, v21
    v_lshrrev_b32 v22, 5, v21
    v_mul_u32_u24 v22, 40960, v22
    v_bfe_u32 v29, v21, 4, 1
    v_lshl_add_u32 v22, v29, 10, v22
    v_and_b32 v29, 15, v21
    v_lshl_add_u32 v29, v4, 4, v29
    v_lshl_add_u32 v89, v29, 4, v22
    v_mov_b32 v99, v28
BL_rp2_go_2:
    s_waitcnt lgkmcnt(15)
    buffer_store_dwordx4 v[32:35], v80, s[20:23], s54 offen sc1
    buffer_store_dwordx4 v[36:39], v81, s[20:23], s54 offen sc1
    s_waitcnt lgkmcnt(14)
    buffer_store_dwordx4 v[40:43], v82, s[20:23], s54 offen sc1
    s_waitcnt lgkmcnt(12)
    buffer_store_dwordx4 v[44:47], v83, s[20:23], s54 offen sc1
    s_waitcnt lgkmcnt(10)
    buffer_store_dwordx4 v[48:51], v84, s[20:23], s54 offen sc1
    s_waitcnt lgkmcnt(8)
    buffer_store_dwordx4 v[52:55], v85, s[20:23], s54 offen sc1
    s_waitcnt lgkmcnt(6)
    buffer_store_dwordx4 v[56:59], v86, s[20:23], s54 offen sc1
    s_waitcnt lgkmcnt(4)
    buffer_store_dwordx4 v[60:63], v87, s[20:23], s54 offen sc1
    s_waitcnt lgkmcnt(2)
    buffer_store_dwordx4 v[64:67], v88, s[20:23], s54 offen sc1
    s_waitcnt lgkmcnt(0)
    buffer_store_dwordx4 v[68:71], v89, s[20:23], s54 offen sc1
    v_cmp_gt_u32 vcc, 16, v1
    s_nop 1
    v_cndmask_b32 v90, v28, v90, vcc
    v_cndmask_b32 v91, v28, v91, vcc
    v_cndmask_b32 v92, v28, v92, vcc
    v_cndmask_b32 v93, v28, v93, vcc
    v_cndmask_b32 v94, v28, v94, vcc
    v_cndmask_b32 v95, v28, v95, vcc
    v_cndmask_b32 v96, v28, v96, vcc
    v_cndmask_b32 v97, v28, v97, vcc
    v_cndmask_b32 v98, v28, v98, vcc
    v_cndmask_b32 v99, v28, v99, vcc
    v_mfma_f32_16x16x32_bf16 v[100:103], v[24:27], v[32:35], 0
    v_mfma_f32_16x16x32_bf16 v[104:107], v[24:27], v[36:39], 0
    v_mfma_f32_16x16x32_bf16 v[108:111], v[24:27], v[40:43], 0
    v_mfma_f32_16x16x32_bf16 v[112:115], v[24:27], v[44:47], 0
    v_mfma_f32_16x16x32_bf16 v[116:119], v[24:27], v[48:51], 0
    v_mfma_f32_16x16x32_bf16 v[120:123], v[24:27], v[52:55], 0
    v_mfma_f32_16x16x32_bf16 v[124:127], v[24:27], v[56:59], 0
    v_mfma_f32_16x16x32_bf16 v[128:131], v[24:27], v[60:63], 0
    v_mfma_f32_16x16x32_bf16 v[132:135], v[24:27], v[64:67], 0
    v_mfma_f32_16x16x32_bf16 v[136:139], v[24:27], v[68:71], 0
    buffer_atomic_add_f32 v100, v90, s[24:27], 0 offen
    buffer_atomic_add_f32 v104, v91, s[24:27], 0 offen
    buffer_atomic_add_f32 v108, v92, s[24:27], 0 offen
    buffer_atomic_add_f32 v112, v93, s[24:27], 0 offen
    buffer_atomic_add_f32 v116, v94, s[24:27], 0 offen
    buffer_atomic_add_f32 v120, v95, s[24:27], 0 offen
    buffer_atomic_add_f32 v124, v96, s[24:27], 0 offen
    buffer_atomic_add_f32 v128, v97, s[24:27], 0 offen
    buffer_atomic_add_f32 v132, v98, s[24:27], 0 offen
    buffer_atomic_add_f32 v136, v99, s[24:27], 0 offen
    s_cmp_lg_u32 s45, 2
    s_cbranch_scc1 BL_rp2_end_3
    v_mov_b32 v140, 0
    v_mov_b32 v141, 0
    v_mov_b32 v142, 0
    v_mov_b32 v143, 0
    v_add_u32 v21, 0, v0
    v_lshrrev_b32 v22, 5, v21
    v_lshl_add_u32 v22, v22, 2, 3
    v_mul_u32_u24 v22, 40960, v22
    v_bfe_u32 v29, v21, 3, 2
    v_lshlrev_b32 v29, 4, v29
    v_and_b32 v23, 7, v21
    v_add_u32 v29, v29, v23
    v_add_u32 v29, 8, v29
    v_lshl_add_u32 v22, v29, 4, v22
    v_add_u32 v22, 1024, v22
    buffer_store_dwordx4 v[140:143], v22, s[20:23], s54 offen sc1
    v_add_u32 v21, 256, v0
    v_lshrrev_b32 v22, 5, v21
    v_lshl_add_u32 v22, v22, 2, 3
    v_mul_u32_u24 v22, 40960, v22
    v_bfe_u32 v29, v21, 3, 2
    v_lshlrev_b32 v29, 4, v29
    v_and_b32 v23, 7, v21
    v_add_u32 v29, v29, v23
    v_add_u32 v29, 8, v29
    v_lshl_add_u32 v22, v29, 4, v22
    v_add_u32 v22, 1024, v22
    buffer_store_dwordx4 v[140:143], v22, s[20:23], s54 offen sc1
BL_rp2_end_3:
    s_waitcnt vmcnt(0)
    buffer_load_dword v144, v80, s[20:23], s54 offen sc1
    buffer_load_dword v145, v81, s[20:23], s54 offen sc1
    buffer_load_dword v146, v82, s[20:23], s54 offen sc1
    buffer_load_dword v147, v83, s[20:23], s54 offen sc1
    buffer_load_dword v148, v84, s[20:23], s54 offen sc1
    buffer_load_dword v149, v85, s[20:23], s54 offen sc1
    buffer_load_dword v150, v86, s[20:23], s54 offen sc1
    buffer_load_dword v151, v87, s[20:23], s54 offen sc1
    buffer_load_dword v152, v88, s[20:23], s54 offen sc1
    buffer_load_dword v153, v89, s[20:23], s54 offen sc1
    s_endpgm
L_conv_end:
    s_endpgm
.globl interleave_layers__ssm_conv_h3__sliding_local_dilated__prompt_kernel
.p2align 8
.type interleave_layers__ssm_conv_h3__sliding_local_dilated__prompt_kernel,@function
interleave_layers__ssm_conv_h3__sliding_local_dilated__prompt_kernel:
    s_cmp_ge_u32 s2, 256
    s_cbranch_scc1 L_k2_end
    s_load_dwordx2 s[4:5], s[0:1], 88
    s_load_dwordx2 s[6:7], s[0:1], 72
    s_getreg_b32 s8, hwreg(HW_REG_XCC_ID, 0, 4)
    s_getreg_b32 s88, hwreg(HW_REG_HW_ID, 8, 8)
    v_and_b32 v1, 63, v0
    v_lshrrev_b32 v22, 6, v0
    v_and_b32 v2, 15, v1
    v_lshrrev_b32 v3, 4, v1
    v_readfirstlane_b32 s3, v22
    v_lshlrev_b32 v5, 4, v1
    s_and_b32 s8, s8, 7
    v_lshlrev_b32 v4, 1, v2
    v_add_u32 v22, -15, v4
    v_cmp_gt_u32 vcc, 8, v2
    s_nop 1
    v_cndmask_b32 v4, v22, v4, vcc
    s_waitcnt vmcnt(0) lgkmcnt(0)
    s_mov_b32 s85, s88
    s_lshr_b32 s9, s2, 3
    s_and_b32 s9, s9, 31
    s_mov_b32 s101, 0
    s_lshl_b32 s89, s8, 10
    s_add_u32 s89, s89, 14032896
    s_add_u32 s48, s4, s89
    s_addc_u32 s49, s5, 0
    s_mov_b32 s50, 1024
    s_mov_b32 s51, 0x20000
    s_cmp_lg_u32 s3, 0
    s_cbranch_scc1 CL_mark_1
    s_add_u32 s89, s9, 1
    v_mov_b32 v22, s89
    v_mov_b32 v23, 0
    s_lshl_b32 s89, s85, 2
    v_cmp_eq_u32 vcc, 0, v0
    s_nop 0
    s_and_saveexec_b64 s[86:87], vcc
    buffer_store_dword v22, v23, s[48:51], s89 offen
    s_mov_b64 exec, s[86:87]
CL_mark_1:
    s_mul_i32 s89, s8, 327680
    s_add_u32 s14, s4, s89
    s_addc_u32 s15, s5, 0
    s_add_u32 s44, s14, 5259264
    s_addc_u32 s45, s15, 0
    s_mov_b32 s46, 368640
    s_mov_b32 s47, 0x20000
    s_add_u32 s20, s4, 10584064
    s_addc_u32 s21, s5, 0
    s_mov_b32 s22, 2621440
    s_mov_b32 s23, 0x20000
    s_lshl_b32 s92, s3, 10
    s_lshr_b32 s88, s3, 1
    s_mul_i32 s88, s88, 20480
    s_and_b32 s89, s3, 1
    s_lshl_b32 s89, s89, 10
    s_add_u32 s88, s88, s89
    v_add_u32 v9, s88, v5
    v_add_u32 v10, 40960, v9
    v_add_u32 v11, 81920, v9
    v_add_u32 v12, 122880, v9
    v_add_u32 v13, 163840, v9
L_k2_pro:
    s_lshr_b32 s10, s9, 4
    s_and_b32 s11, s9, 15
    s_lshl_b32 s88, s11, 2
    s_add_u32 s88, s88, s3
    s_mul_i32 s93, s88, 40960
    s_mul_i32 s88, s9, 20480
    s_mul_i32 s89, s3, 5120
    s_add_u32 s88, s88, s89
    s_lshl_b32 s14, s10, 3
    s_mul_i32 s14, s14, 20480
    s_add_u32 s95, s14, 0
    s_add_u32 m0, s92, 4096
    s_nop 0
    buffer_load_dwordx4 v9, s[44:47], s95 offen lds
    s_add_u32 s52, s4, 14041088
    s_addc_u32 s53, s5, 0
    s_lshl_b32 s89, s8, 10
    s_add_u32 s52, s52, s89
    s_addc_u32 s53, s53, 0
    s_mov_b32 s54, 1024
    s_mov_b32 s55, 0x20000
    s_add_u32 s24, s4, 13205504
    s_addc_u32 s25, s5, 0
    s_mov_b32 s26, 819200
    s_mov_b32 s27, 0x20000
    s_add_u32 s56, s4, 14024704
    s_addc_u32 s57, s5, 0
    s_mov_b32 s58, 8192
    s_add_u32 m0, s92, 8192
    s_nop 0
    buffer_load_dwordx4 v10, s[44:47], s95 offen lds
    s_mov_b32 s59, 0x20000
    s_mul_i32 s89, s8, 1138688
    s_add_u32 s89, s89, 14049280
    s_add_u32 s28, s4, s89
    s_addc_u32 s29, s5, 0
    s_mov_b32 s30, 368640
    s_mov_b32 s31, 0x20000
    s_add_u32 s32, s28, 368640
    s_addc_u32 s33, s29, 0
    s_mov_b32 s34, 368640
    s_mov_b32 s35, 0x20000
    s_add_u32 s36, s28, 0
    s_addc_u32 s37, s29, 0
    s_mov_b32 s38, 368640
    s_add_u32 m0, s92, 12288
    s_nop 0
    buffer_load_dwordx4 v11, s[44:47], s95 offen lds
    s_mov_b32 s39, 0x20000
    s_add_u32 s40, s28, 1105920
    s_addc_u32 s41, s29, 0
    s_mov_b32 s42, 32768
    s_mov_b32 s43, 0x20000
    v_add_u32 v6, 4096, v5
    v_add_u32 v7, 65536, v5
    v_add_u32 v8, 126976, v5
    v_lshlrev_b32 v36, 3, v1
    v_add_u32 v37, 65536, v36
    s_add_u32 m0, s92, 16384
    s_nop 0
    buffer_load_dwordx4 v12, s[44:47], s95 offen lds
    v_add_u32 v38, 126976, v36
    v_add_u32 v36, 4096, v36
    s_mul_i32 s12, s9, 52429
    s_lshr_b32 s12, s12, 18
    s_mul_i32 s13, s12, 5
    s_sub_u32 s13, s9, s13
    s_lshl_b32 s99, s13, 2
    s_add_u32 s99, s99, s3
    s_mul_i32 s94, s99, 40960
    s_add_u32 m0, s92, 20480
    s_nop 0
    buffer_load_dwordx4 v13, s[44:47], s95 offen lds
    s_lshl_b32 s99, s99, 10
    s_mul_i32 s100, s12, 3
    s_add_u32 s100, s100, 1
    s_mul_i32 s98, s100, 20480
    s_mul_i32 s100, s100, 640
    s_lshl_b32 s88, s3, 3
    s_add_u32 s88, s88, 0
    v_add_u32 v224, s88, v3
    v_mul_u32_u24 v225, 52, v224
    s_add_u32 s91, s93, 0
    buffer_load_dwordx4 a[0:3], v5, s[20:23], s91 offen
    v_lshrrev_b32 v225, 8, v225
    v_mul_u32_u24 v226, 5, v225
    v_sub_u32 v226, v224, v226
    v_cmp_le_u32 vcc, 30, v224
    v_subrev_u32 v224, 30, v224
    s_nop 0
    v_cndmask_b32 v225, v225, v224, vcc
    v_mov_b32 v224, 5
    v_cndmask_b32 v226, v226, v224, vcc
    v_mul_u32_u24 v225, 12800, v225
    buffer_load_dwordx4 a[4:7], v5, s[20:23], s91 offen offset:1024
    v_lshl_add_u32 v225, v226, 3, v225
    v_mul_u32_u24 v226, 80, v4
    v_add_u32 v225, 4096, v225
    v_add_u32 v14, v225, v226
    s_lshl_b32 s88, s3, 3
    s_add_u32 s88, s88, 4
    v_add_u32 v224, s88, v3
    v_mul_u32_u24 v225, 52, v224
    v_lshrrev_b32 v225, 8, v225
    s_add_u32 s91, s93, 2048
    buffer_load_dwordx4 a[8:11], v5, s[20:23], s91 offen
    v_mul_u32_u24 v226, 5, v225
    v_sub_u32 v226, v224, v226
    v_cmp_le_u32 vcc, 30, v224
    v_subrev_u32 v224, 30, v224
    s_nop 0
    v_cndmask_b32 v225, v225, v224, vcc
    v_mov_b32 v224, 5
    v_cndmask_b32 v226, v226, v224, vcc
    v_mul_u32_u24 v225, 12800, v225
    v_lshl_add_u32 v225, v226, 3, v225
    buffer_load_dwordx4 a[12:15], v5, s[20:23], s91 offen offset:1024
    v_mul_u32_u24 v226, 80, v4
    v_add_u32 v225, 4096, v225
    v_add_u32 v15, v225, v226
    s_and_b32 s88, s3, 1
    s_mul_i32 s88, s88, 12800
    s_lshr_b32 s89, s3, 1
    s_mul_i32 s89, s89, 1280
    s_add_u32 s88, s88, s89
    v_mul_u32_u24 v224, 160, v2
    s_cmp_lg_u32 s3, 0
    s_cbranch_scc1 CL_vi_2
    s_cmp_lg_u32 s101, 0
    s_cbranch_scc1 CL_vi_2
    buffer_load_dwordx4 v[228:231], v5, s[48:51], 0 offen sc1
CL_vi_2:
    s_add_u32 s95, s14, 2048
    s_add_u32 m0, s92, 24576
    s_nop 0
    buffer_load_dwordx4 v9, s[44:47], s95 offen lds
    v_lshl_add_u32 v224, v3, 4, v224
    v_add_u32 v224, 29696, v224
    v_add_u32 v16, s88, v224
    v_mul_u32_u24 v224, 80, v4
    v_add_u32 v224, 5376, v224
    v_add_u32 v224, s88, v224
    v_lshlrev_b32 v225, 4, v3
    v_cmp_gt_u32 vcc, 8, v2
    v_mov_b32 v22, 48
    s_add_u32 m0, s92, 28672
    s_nop 0
    buffer_load_dwordx4 v10, s[44:47], s95 offen lds
    v_cndmask_b32 v17, v22, v225, vcc
    v_cndmask_b32 v18, v225, v22, vcc
    v_add_u32 v17, v17, v224
    v_add_u32 v18, v18, v224
    v_lshrrev_b32 v224, 2, v2
    v_lshlrev_b32 v224, 1, v224
    v_lshl_add_u32 v224, v3, 3, v224
    v_mul_u32_u24 v224, 80, v224
    v_and_b32 v225, 3, v2
    s_add_u32 m0, s92, 32768
    s_nop 0
    buffer_load_dwordx4 v11, s[44:47], s95 offen lds
    v_lshl_add_u32 v224, v225, 3, v224
    v_add_u32 v224, 55296, v224
    v_add_u32 v19, s88, v224
    v_and_b32 v224, 7, v2
    v_mov_b32 v22, 0xf149f2ca
    v_lshlrev_b32 v225, 2, v3
    v_add_u32 v225, 0, v225
    v_sub_u32 v225, v225, v224
    v_add_u32 v225, -1, v225
    s_add_u32 m0, s92, 36864
    s_nop 0
    buffer_load_dwordx4 v12, s[44:47], s95 offen lds
    v_cmp_gt_u32 vcc, 8, v225
    s_nop 1
    v_cndmask_b32 v24, v22, 0, vcc
    v_lshlrev_b32 v225, 2, v3
    v_add_u32 v225, 1, v225
    v_sub_u32 v225, v225, v224
    v_add_u32 v225, -1, v225
    v_cmp_gt_u32 vcc, 8, v225
    s_nop 1
    v_cndmask_b32 v25, v22, 0, vcc
    v_lshlrev_b32 v225, 2, v3
    s_add_u32 m0, s92, 40960
    s_nop 0
    buffer_load_dwordx4 v13, s[44:47], s95 offen lds
    v_add_u32 v225, 2, v225
    v_sub_u32 v225, v225, v224
    v_add_u32 v225, -1, v225
    v_cmp_gt_u32 vcc, 8, v225
    s_nop 1
    v_cndmask_b32 v26, v22, 0, vcc
    v_lshlrev_b32 v225, 2, v3
    v_add_u32 v225, 3, v225
    v_sub_u32 v225, v225, v224
    v_add_u32 v225, -1, v225
    s_add_u32 s91, s93, 4096
    buffer_load_dwordx4 a[16:19], v5, s[20:23], s91 offen
    v_cmp_gt_u32 vcc, 8, v225
    s_nop 1
    v_cndmask_b32 v27, v22, 0, vcc
    s_mul_i32 s88, s11, 10
    s_and_b32 s89, s3, 1
    s_mul_i32 s89, s89, 5
    s_add_u32 s88, s88, s89
    v_add_u32 v226, s88, v3
    v_lshrrev_b32 v224, 3, v226
    v_lshlrev_b32 v224, 10, v224
    buffer_load_dwordx4 a[20:23], v5, s[20:23], s91 offen offset:1024
    v_and_b32 v225, 3, v226
    v_lshl_add_u32 v224, v225, 8, v224
    v_bfe_u32 v225, v226, 2, 1
    v_lshl_add_u32 v224, v225, 3, v224
    v_lshl_add_u32 v20, v2, 4, v224
    s_add_u32 s89, s88, 4
    v_mov_b32 v226, s89
    v_lshrrev_b32 v224, 3, v226
    v_lshlrev_b32 v224, 10, v224
    s_add_u32 s91, s93, 6144
    buffer_load_dwordx4 a[24:27], v5, s[20:23], s91 offen
    v_and_b32 v225, 3, v226
    v_lshl_add_u32 v224, v225, 8, v224
    v_bfe_u32 v225, v226, 2, 1
    v_lshl_add_u32 v224, v225, 3, v224
    v_lshl_add_u32 v21, v2, 4, v224
    v_cmp_eq_u32 vcc, 0, v3
    v_mov_b32 v224, 0x40000000
    s_nop 0
    v_cndmask_b32 v21, v224, v21, vcc
    s_lshl_b32 s88, s11, 7
    buffer_load_dwordx4 a[28:31], v5, s[20:23], s91 offen offset:1024
    s_lshl_b32 s89, s3, 5
    s_add_u32 s88, s88, s89
    s_lshl_b32 s88, s88, 2
    v_lshlrev_b32 v224, 4, v3
    buffer_load_dwordx4 v[28:31], v224, s[56:59], s88 offen
    buffer_load_dwordx4 v[32:35], v224, s[56:59], s88 offen offset:64
    s_mul_i32 s83, s9, 20480
    s_mul_i32 s89, s3, 5120
    s_add_u32 s83, s83, s89
    s_add_u32 s90, s89, 126976
    v_add_u32 v22, 4096, v5
    s_mov_b32 m0, s90
    s_nop 0
    buffer_load_dwordx4 v5, s[44:47], s83 offen offset:0 lds
    buffer_load_dwordx4 v5, s[44:47], s83 offen offset:1024 lds
    buffer_load_dwordx4 v5, s[44:47], s83 offen offset:2048 lds
    buffer_load_dwordx4 v5, s[44:47], s83 offen offset:3072 lds
    s_add_u32 m0, s90, 4096
    s_nop 0
    buffer_load_dwordx4 v22, s[44:47], s83 offen lds
    s_cmp_lg_u32 s3, 0
    s_cbranch_scc1 CL_nover_3
    s_cmp_lg_u32 s101, 0
    s_cbranch_scc1 CL_nover_3
    s_mov_b32 s72, s88
    s_mov_b32 s73, s89
    s_mov_b32 s90, 1048576
    s_waitcnt vmcnt(16)
    s_branch CL_pr_first_7
CL_pr_loop_4:
    s_waitcnt vmcnt(16)
    buffer_load_dwordx4 v[228:231], v5, s[48:51], 0 offen sc1
    s_waitcnt vmcnt(0)
CL_pr_first_7:
    v_cmp_ne_u32 s[74:75], 0, v228
    v_cmp_ne_u32 s[76:77], 0, v229
    v_cmp_ne_u32 s[78:79], 0, v230
    v_cmp_ne_u32 s[80:81], 0, v231
    s_nop 0
    s_bcnt1_i32_b64 s89, s[74:75]
    s_bcnt1_i32_b64 s88, s[76:77]
    s_add_u32 s89, s89, s88
    s_bcnt1_i32_b64 s88, s[78:79]
    s_add_u32 s89, s89, s88
    s_bcnt1_i32_b64 s88, s[80:81]
    s_add_u32 s89, s89, s88
    s_cmp_ge_u32 s89, 32
    s_cbranch_scc1 CL_pr_done_5
    s_sub_u32 s90, s90, 1
    s_cmp_lg_u32 s90, 0
    s_cbranch_scc1 CL_pr_loop_4
    s_mov_b32 s90, 255
    s_branch CL_pr_fail_6
CL_pr_done_5:
    v_add_u32 v232, -1, v228
    v_add_u32 v233, -1, v229
    v_add_u32 v234, -1, v230
    v_add_u32 v235, -1, v231
    v_mov_b32 v236, 1
    v_lshlrev_b32 v232, v232, v236
    v_cndmask_b32 v232, 0, v232, s[74:75]
    v_lshlrev_b32 v233, v233, v236
    v_cndmask_b32 v233, 0, v233, s[76:77]
    v_lshlrev_b32 v234, v234, v236
    v_cndmask_b32 v234, 0, v234, s[78:79]
    v_lshlrev_b32 v235, v235, v236
    v_cndmask_b32 v235, 0, v235, s[80:81]
    v_or_b32 v232, v232, v233
    v_or_b32 v234, v234, v235
    v_or_b32 v232, v232, v234
    s_nop 1
    v_or_b32_dpp v232, v232, v232 row_shr:1 row_mask:0xf bank_mask:0xf
    s_nop 1
    v_or_b32_dpp v232, v232, v232 row_shr:2 row_mask:0xf bank_mask:0xf
    s_nop 1
    v_or_b32_dpp v232, v232, v232 row_shr:4 row_mask:0xf bank_mask:0xf
    s_nop 1
    v_or_b32_dpp v232, v232, v232 row_shr:8 row_mask:0xf bank_mask:0xf
    s_nop 1
    v_or_b32_dpp v232, v232, v232 row_bcast:15 row_mask:0xa bank_mask:0xf
    s_nop 1
    v_or_b32_dpp v232, v232, v232 row_bcast:31 row_mask:0xc bank_mask:0xf
    s_nop 0
    v_readlane_b32 s88, v232, 63
    s_mov_b32 s90, s9
    s_cmp_eq_u32 s88, -1
    s_cbranch_scc1 CL_pr_fail_6
    s_lshr_b32 s88, s85, 2
    s_and_b32 s15, s85, 3
    s_mov_b32 s90, 0
    s_cmp_gt_u32 s15, 0
    s_cselect_b32 s89, 1, 0
    s_add_u32 s89, s89, s88
    s_bfm_b64 s[82:83], s89, 0
    s_and_b64 s[82:83], s[82:83], s[74:75]
    s_bcnt1_i32_b64 s89, s[82:83]
    s_add_u32 s90, s90, s89
    s_cmp_gt_u32 s15, 1
    s_cselect_b32 s89, 1, 0
    s_add_u32 s89, s89, s88
    s_bfm_b64 s[82:83], s89, 0
    s_and_b64 s[82:83], s[82:83], s[76:77]
    s_bcnt1_i32_b64 s89, s[82:83]
    s_add_u32 s90, s90, s89
    s_cmp_gt_u32 s15, 2
    s_cselect_b32 s89, 1, 0
    s_add_u32 s89, s89, s88
    s_bfm_b64 s[82:83], s89, 0
    s_and_b64 s[82:83], s[82:83], s[78:79]
    s_bcnt1_i32_b64 s89, s[82:83]
    s_add_u32 s90, s90, s89
    s_cmp_gt_u32 s15, 3
    s_cselect_b32 s89, 1, 0
    s_add_u32 s89, s89, s88
    s_bfm_b64 s[82:83], s89, 0
    s_and_b64 s[82:83], s[82:83], s[80:81]
    s_bcnt1_i32_b64 s89, s[82:83]
    s_add_u32 s90, s90, s89
CL_pr_fail_6:
    v_mov_b32 v232, s90
    v_mov_b32 v233, 0
    ds_write_b32 v233, v232 offset:1920
    s_mov_b32 s88, s72
    s_mov_b32 s89, s73
CL_nover_3:
    s_getpc_b64 s[76:77]
CL_pc_8:
    s_sub_u32 s76, s76, CL_pc_8-interleave_layers__ssm_conv_h3__sliding_local_dilated__prompt_kernel
    s_subb_u32 s77, s77, 0
    s_mov_b32 s78, code_end-interleave_layers__ssm_conv_h3__sliding_local_dilated__prompt_kernel
    s_mov_b32 s79, 0x20000
    v_lshlrev_b32 v246, 7, v0
    s_mov_b32 s89, 0
    buffer_load_dword v247, v246, s[76:79], s89 offen
    s_waitcnt vmcnt(21)
    s_barrier
    v_mov_b32 v23, 0
    ds_read_b32 v22, v23 offset:1920
    s_cmp_lg_u32 s101, 0
    s_cbranch_scc1 CL_guess_ok_9
    s_waitcnt lgkmcnt(0)
    v_readfirstlane_b32 s88, v22
    s_mov_b32 s101, 1
    s_cmp_eq_u32 s88, s9
    s_cbranch_scc1 CL_guess_ok_9
    s_cmp_ge_u32 s88, 32
    s_cbranch_scc1 L_k2_end
    s_mov_b32 s9, s88
    s_waitcnt vmcnt(0) lgkmcnt(0)
    s_barrier
    s_branch L_k2_pro
CL_guess_ok_9:
    s_add_u32 s48, s44, 2662400
    s_addc_u32 s49, s45, 0
    s_mov_b32 s50, 368640
    s_mov_b32 s51, 0x20000
    ds_read_b64 v[72:73], v36 offset:0
    ds_read_b64 v[74:75], v36 offset:512
    ds_read_b64 v[76:77], v36 offset:2048
    ds_read_b64 v[78:79], v36 offset:2560
    ds_read_b64 v[80:81], v36 offset:4096
    ds_read_b64 v[82:83], v36 offset:4608
    ds_read_b64 v[84:85], v36 offset:6144
    ds_read_b64 v[86:87], v36 offset:6656
    ds_read_b64 v[88:89], v36 offset:8192
    ds_read_b64 v[90:91], v36 offset:8704
    s_add_u32 s95, s14, 4096
    s_add_u32 m0, s92, 45056
    s_waitcnt lgkmcnt(6)
    s_waitcnt vmcnt(20)
    v_mfma_f32_16x16x32_bf16 v[96:99], a[0:3], v[72:75], 0
    ds_read_b64 v[92:93], v36 offset:10240
    ds_read_b64 v[94:95], v36 offset:10752
    s_waitcnt vmcnt(19)
    v_mfma_f32_16x16x32_bf16 v[100:103], a[4:7], v[72:75], 0
    buffer_load_dwordx4 v9, s[44:47], s95 offen lds
    v_mfma_f32_16x16x32_bf16 v[104:107], a[0:3], v[76:79], 0
    ds_read_b64 v[72:73], v36 offset:12288
    ds_read_b64 v[74:75], v36 offset:12800
    v_mfma_f32_16x16x32_bf16 v[108:111], a[4:7], v[76:79], 0
    s_add_u32 m0, s92, 49152
    s_waitcnt lgkmcnt(6)
    v_mfma_f32_16x16x32_bf16 v[112:115], a[0:3], v[80:83], 0
    ds_read_b64 v[76:77], v36 offset:14336
    ds_read_b64 v[78:79], v36 offset:14848
    v_mfma_f32_16x16x32_bf16 v[116:119], a[4:7], v[80:83], 0
    buffer_load_dwordx4 v10, s[44:47], s95 offen lds
    v_mfma_f32_16x16x32_bf16 v[120:123], a[0:3], v[84:87], 0
    ds_read_b64 v[80:81], v36 offset:16384
    ds_read_b64 v[82:83], v36 offset:16896
    v_mfma_f32_16x16x32_bf16 v[124:127], a[4:7], v[84:87], 0
    s_add_u32 m0, s92, 53248
    s_waitcnt lgkmcnt(6)
    v_mfma_f32_16x16x32_bf16 v[128:131], a[0:3], v[88:91], 0
    ds_read_b64 v[84:85], v36 offset:18432
    ds_read_b64 v[86:87], v36 offset:18944
    v_mfma_f32_16x16x32_bf16 v[132:135], a[4:7], v[88:91], 0
    buffer_load_dwordx4 v11, s[44:47], s95 offen lds
    v_mfma_f32_16x16x32_bf16 v[136:139], a[0:3], v[92:95], 0
    ds_read_b64 v[88:89], v36 offset:1024
    ds_read_b64 v[90:91], v36 offset:1536
    v_mfma_f32_16x16x32_bf16 v[140:143], a[4:7], v[92:95], 0
    s_add_u32 m0, s92, 57344
    s_waitcnt lgkmcnt(6)
    v_mfma_f32_16x16x32_bf16 v[144:147], a[0:3], v[72:75], 0
    ds_read_b64 v[92:93], v36 offset:3072
    ds_read_b64 v[94:95], v36 offset:3584
    v_mfma_f32_16x16x32_bf16 v[148:151], a[4:7], v[72:75], 0
    buffer_load_dwordx4 v12, s[44:47], s95 offen lds
    v_mfma_f32_16x16x32_bf16 v[152:155], a[0:3], v[76:79], 0
    ds_read_b64 v[72:73], v36 offset:5120
    ds_read_b64 v[74:75], v36 offset:5632
    v_mfma_f32_16x16x32_bf16 v[156:159], a[4:7], v[76:79], 0
    s_add_u32 m0, s92, 61440
    s_waitcnt lgkmcnt(6)
    v_mfma_f32_16x16x32_bf16 v[160:163], a[0:3], v[80:83], 0
    ds_read_b64 v[76:77], v36 offset:7168
    ds_read_b64 v[78:79], v36 offset:7680
    v_mfma_f32_16x16x32_bf16 v[164:167], a[4:7], v[80:83], 0
    buffer_load_dwordx4 v13, s[44:47], s95 offen lds
    v_mfma_f32_16x16x32_bf16 v[168:171], a[0:3], v[84:87], 0
    ds_read_b64 v[80:81], v36 offset:9216
    ds_read_b64 v[82:83], v36 offset:9728
    v_mfma_f32_16x16x32_bf16 v[172:175], a[4:7], v[84:87], 0
    s_add_u32 s91, s93, 8192
    s_waitcnt lgkmcnt(6)
    s_waitcnt vmcnt(23)
    v_mfma_f32_16x16x32_bf16 v[96:99], a[8:11], v[88:91], v[96:99]
    ds_read_b64 v[84:85], v36 offset:11264
    ds_read_b64 v[86:87], v36 offset:11776
    s_waitcnt vmcnt(22)
    v_mfma_f32_16x16x32_bf16 v[100:103], a[12:15], v[88:91], v[100:103]
    buffer_load_dwordx4 a[32:35], v5, s[20:23], s91 offen
    v_mfma_f32_16x16x32_bf16 v[104:107], a[8:11], v[92:95], v[104:107]
    ds_read_b64 v[88:89], v36 offset:13312
    ds_read_b64 v[90:91], v36 offset:13824
    v_mfma_f32_16x16x32_bf16 v[108:111], a[12:15], v[92:95], v[108:111]
    s_waitcnt lgkmcnt(6)
    v_mfma_f32_16x16x32_bf16 v[112:115], a[8:11], v[72:75], v[112:115]
    ds_read_b64 v[92:93], v36 offset:15360
    ds_read_b64 v[94:95], v36 offset:15872
    v_mfma_f32_16x16x32_bf16 v[116:119], a[12:15], v[72:75], v[116:119]
    buffer_load_dwordx4 a[36:39], v5, s[20:23], s91 offen offset:1024
    v_mfma_f32_16x16x32_bf16 v[120:123], a[8:11], v[76:79], v[120:123]
    ds_read_b64 v[72:73], v36 offset:17408
    ds_read_b64 v[74:75], v36 offset:17920
    v_mfma_f32_16x16x32_bf16 v[124:127], a[12:15], v[76:79], v[124:127]
    s_add_u32 s91, s93, 10240
    s_waitcnt lgkmcnt(6)
    v_mfma_f32_16x16x32_bf16 v[128:131], a[8:11], v[80:83], v[128:131]
    ds_read_b64 v[76:77], v36 offset:19456
    ds_read_b64 v[78:79], v36 offset:19968
    v_mfma_f32_16x16x32_bf16 v[132:135], a[12:15], v[80:83], v[132:135]
    buffer_load_dwordx4 a[40:43], v5, s[20:23], s91 offen
    v_mfma_f32_16x16x32_bf16 v[136:139], a[8:11], v[84:87], v[136:139]
    s_waitcnt vmcnt(20)
    s_barrier
    ds_read_b64 v[80:81], v36 offset:20480
    ds_read_b64 v[82:83], v36 offset:20992
    v_mfma_f32_16x16x32_bf16 v[140:143], a[12:15], v[84:87], v[140:143]
    s_waitcnt lgkmcnt(6)
    v_mfma_f32_16x16x32_bf16 v[144:147], a[8:11], v[88:91], v[144:147]
    ds_read_b64 v[84:85], v36 offset:22528
    ds_read_b64 v[86:87], v36 offset:23040
    v_mfma_f32_16x16x32_bf16 v[148:151], a[12:15], v[88:91], v[148:151]
    buffer_load_dwordx4 a[44:47], v5, s[20:23], s91 offen offset:1024
    v_mfma_f32_16x16x32_bf16 v[152:155], a[8:11], v[92:95], v[152:155]
    ds_read_b64 v[88:89], v36 offset:24576
    ds_read_b64 v[90:91], v36 offset:25088
    v_mfma_f32_16x16x32_bf16 v[156:159], a[12:15], v[92:95], v[156:159]
    s_add_u32 s95, s14, 6144
    s_add_u32 m0, s92, 65536
    s_waitcnt lgkmcnt(6)
    v_mfma_f32_16x16x32_bf16 v[160:163], a[8:11], v[72:75], v[160:163]
    ds_read_b64 v[92:93], v36 offset:26624
    ds_read_b64 v[94:95], v36 offset:27136
    v_mfma_f32_16x16x32_bf16 v[164:167], a[12:15], v[72:75], v[164:167]
    buffer_load_dwordx4 v9, s[44:47], s95 offen lds
    v_mfma_f32_16x16x32_bf16 v[168:171], a[8:11], v[76:79], v[168:171]
    ds_read_b64 v[72:73], v36 offset:28672
    ds_read_b64 v[74:75], v36 offset:29184
    v_mfma_f32_16x16x32_bf16 v[172:175], a[12:15], v[76:79], v[172:175]
    s_add_u32 m0, s92, 69632
    s_waitcnt lgkmcnt(6)
    s_waitcnt vmcnt(21)
    v_mfma_f32_16x16x32_bf16 v[96:99], a[16:19], v[80:83], v[96:99]
    ds_read_b64 v[76:77], v36 offset:30720
    ds_read_b64 v[78:79], v36 offset:31232
    s_waitcnt vmcnt(20)
    v_mfma_f32_16x16x32_bf16 v[100:103], a[20:23], v[80:83], v[100:103]
    buffer_load_dwordx4 v10, s[44:47], s95 offen lds
    v_mfma_f32_16x16x32_bf16 v[104:107], a[16:19], v[84:87], v[104:107]
    ds_read_b64 v[80:81], v36 offset:32768
    ds_read_b64 v[82:83], v36 offset:33280
    v_mfma_f32_16x16x32_bf16 v[108:111], a[20:23], v[84:87], v[108:111]
    s_add_u32 m0, s92, 73728
    s_waitcnt lgkmcnt(6)
    v_mfma_f32_16x16x32_bf16 v[112:115], a[16:19], v[88:91], v[112:115]
    ds_read_b64 v[84:85], v36 offset:34816
    ds_read_b64 v[86:87], v36 offset:35328
    v_mfma_f32_16x16x32_bf16 v[116:119], a[20:23], v[88:91], v[116:119]
    buffer_load_dwordx4 v11, s[44:47], s95 offen lds
    v_mfma_f32_16x16x32_bf16 v[120:123], a[16:19], v[92:95], v[120:123]
    ds_read_b64 v[88:89], v36 offset:36864
    ds_read_b64 v[90:91], v36 offset:37376
    v_mfma_f32_16x16x32_bf16 v[124:127], a[20:23], v[92:95], v[124:127]
    s_add_u32 m0, s92, 77824
    s_waitcnt lgkmcnt(6)
    v_mfma_f32_16x16x32_bf16 v[128:131], a[16:19], v[72:75], v[128:131]
    ds_read_b64 v[92:93], v36 offset:38912
    ds_read_b64 v[94:95], v36 offset:39424
    v_mfma_f32_16x16x32_bf16 v[132:135], a[20:23], v[72:75], v[132:135]
    buffer_load_dwordx4 v12, s[44:47], s95 offen lds
    v_mfma_f32_16x16x32_bf16 v[136:139], a[16:19], v[76:79], v[136:139]
    ds_read_b64 v[72:73], v36 offset:21504
    ds_read_b64 v[74:75], v36 offset:22016
    v_mfma_f32_16x16x32_bf16 v[140:143], a[20:23], v[76:79], v[140:143]
    s_add_u32 m0, s92, 81920
    s_waitcnt lgkmcnt(6)
    v_mfma_f32_16x16x32_bf16 v[144:147], a[16:19], v[80:83], v[144:147]
    ds_read_b64 v[76:77], v36 offset:23552
    ds_read_b64 v[78:79], v36 offset:24064
    v_mfma_f32_16x16x32_bf16 v[148:151], a[20:23], v[80:83], v[148:151]
    buffer_load_dwordx4 v13, s[44:47], s95 offen lds
    v_mfma_f32_16x16x32_bf16 v[152:155], a[16:19], v[84:87], v[152:155]
    ds_read_b64 v[80:81], v36 offset:25600
    ds_read_b64 v[82:83], v36 offset:26112
    v_mfma_f32_16x16x32_bf16 v[156:159], a[20:23], v[84:87], v[156:159]
    s_add_u32 s91, s93, 12288
    s_waitcnt lgkmcnt(6)
    v_mfma_f32_16x16x32_bf16 v[160:163], a[16:19], v[88:91], v[160:163]
    ds_read_b64 v[84:85], v36 offset:27648
    ds_read_b64 v[86:87], v36 offset:28160
    v_mfma_f32_16x16x32_bf16 v[164:167], a[20:23], v[88:91], v[164:167]
    buffer_load_dwordx4 a[48:51], v5, s[20:23], s91 offen
    v_mfma_f32_16x16x32_bf16 v[168:171], a[16:19], v[92:95], v[168:171]
    ds_read_b64 v[88:89], v36 offset:29696
    ds_read_b64 v[90:91], v36 offset:30208
    v_mfma_f32_16x16x32_bf16 v[172:175], a[20:23], v[92:95], v[172:175]
    s_waitcnt lgkmcnt(6)
    s_waitcnt vmcnt(24)
    v_mfma_f32_16x16x32_bf16 v[96:99], a[24:27], v[72:75], v[96:99]
    ds_read_b64 v[92:93], v36 offset:31744
    ds_read_b64 v[94:95], v36 offset:32256
    s_waitcnt vmcnt(23)
    v_mfma_f32_16x16x32_bf16 v[100:103], a[28:31], v[72:75], v[100:103]
    buffer_load_dwordx4 a[52:55], v5, s[20:23], s91 offen offset:1024
    v_mfma_f32_16x16x32_bf16 v[104:107], a[24:27], v[76:79], v[104:107]
    ds_read_b64 v[72:73], v36 offset:33792
    ds_read_b64 v[74:75], v36 offset:34304
    v_mfma_f32_16x16x32_bf16 v[108:111], a[28:31], v[76:79], v[108:111]
    s_add_u32 s91, s93, 14336
    s_waitcnt lgkmcnt(6)
    v_mfma_f32_16x16x32_bf16 v[112:115], a[24:27], v[80:83], v[112:115]
    ds_read_b64 v[76:77], v36 offset:35840
    ds_read_b64 v[78:79], v36 offset:36352
    v_mfma_f32_16x16x32_bf16 v[116:119], a[28:31], v[80:83], v[116:119]
    buffer_load_dwordx4 a[56:59], v5, s[20:23], s91 offen
    v_mfma_f32_16x16x32_bf16 v[120:123], a[24:27], v[84:87], v[120:123]
    ds_read_b64 v[80:81], v36 offset:37888
    ds_read_b64 v[82:83], v36 offset:38400
    v_mfma_f32_16x16x32_bf16 v[124:127], a[28:31], v[84:87], v[124:127]
    s_waitcnt lgkmcnt(6)
    v_mfma_f32_16x16x32_bf16 v[128:131], a[24:27], v[88:91], v[128:131]
    ds_read_b64 v[84:85], v36 offset:39936
    ds_read_b64 v[86:87], v36 offset:40448
    v_mfma_f32_16x16x32_bf16 v[132:135], a[28:31], v[88:91], v[132:135]
    buffer_load_dwordx4 a[60:63], v5, s[20:23], s91 offen offset:1024
    v_mfma_f32_16x16x32_bf16 v[136:139], a[24:27], v[92:95], v[136:139]
    s_waitcnt vmcnt(13)
    s_barrier
    ds_read_b64 v[88:89], v36 offset:40960
    ds_read_b64 v[90:91], v36 offset:41472
    v_mfma_f32_16x16x32_bf16 v[140:143], a[28:31], v[92:95], v[140:143]
    s_add_u32 s95, s14, 8192
    s_add_u32 m0, s92, 86016
    s_waitcnt lgkmcnt(6)
    v_mfma_f32_16x16x32_bf16 v[144:147], a[24:27], v[72:75], v[144:147]
    ds_read_b64 v[92:93], v36 offset:43008
    ds_read_b64 v[94:95], v36 offset:43520
    v_mfma_f32_16x16x32_bf16 v[148:151], a[28:31], v[72:75], v[148:151]
    buffer_load_dwordx4 v9, s[44:47], s95 offen lds
    v_mfma_f32_16x16x32_bf16 v[152:155], a[24:27], v[76:79], v[152:155]
    ds_read_b64 v[72:73], v36 offset:45056
    ds_read_b64 v[74:75], v36 offset:45568
    v_mfma_f32_16x16x32_bf16 v[156:159], a[28:31], v[76:79], v[156:159]
    s_add_u32 m0, s92, 90112
    s_waitcnt lgkmcnt(6)
    v_mfma_f32_16x16x32_bf16 v[160:163], a[24:27], v[80:83], v[160:163]
    ds_read_b64 v[76:77], v36 offset:47104
    ds_read_b64 v[78:79], v36 offset:47616
    v_mfma_f32_16x16x32_bf16 v[164:167], a[28:31], v[80:83], v[164:167]
    buffer_load_dwordx4 v10, s[44:47], s95 offen lds
    v_mfma_f32_16x16x32_bf16 v[168:171], a[24:27], v[84:87], v[168:171]
    ds_read_b64 v[80:81], v36 offset:49152
    ds_read_b64 v[82:83], v36 offset:49664
    v_mfma_f32_16x16x32_bf16 v[172:175], a[28:31], v[84:87], v[172:175]
    s_add_u32 m0, s92, 94208
    s_waitcnt lgkmcnt(6)
    s_waitcnt vmcnt(14)
    v_mfma_f32_16x16x32_bf16 v[96:99], a[32:35], v[88:91], v[96:99]
    ds_read_b64 v[84:85], v36 offset:51200
    ds_read_b64 v[86:87], v36 offset:51712
    s_waitcnt vmcnt(13)
    v_mfma_f32_16x16x32_bf16 v[100:103], a[36:39], v[88:91], v[100:103]
    buffer_load_dwordx4 v11, s[44:47], s95 offen lds
    v_mfma_f32_16x16x32_bf16 v[104:107], a[32:35], v[92:95], v[104:107]
    ds_read_b64 v[88:89], v36 offset:53248
    ds_read_b64 v[90:91], v36 offset:53760
    v_mfma_f32_16x16x32_bf16 v[108:111], a[36:39], v[92:95], v[108:111]
    s_add_u32 m0, s92, 98304
    s_waitcnt lgkmcnt(6)
    v_mfma_f32_16x16x32_bf16 v[112:115], a[32:35], v[72:75], v[112:115]
    ds_read_b64 v[92:93], v36 offset:55296
    ds_read_b64 v[94:95], v36 offset:55808
    v_mfma_f32_16x16x32_bf16 v[116:119], a[36:39], v[72:75], v[116:119]
    buffer_load_dwordx4 v12, s[44:47], s95 offen lds
    s_mul_i32 s89, s3, 5120
    s_add_u32 s89, s89, 126976
    v_lshlrev_b32 v242, 3, v1
    v_add_u32 v242, s89, v242
    ds_read_b64 v[184:185], v242 offset:0
    ds_read_b64 v[186:187], v242 offset:512
    ds_read_b64 v[188:189], v242 offset:1024
    ds_read_b64 v[190:191], v242 offset:1536
    ds_read_b64 v[192:193], v242 offset:2048
    ds_read_b64 v[194:195], v242 offset:2560
    ds_read_b64 v[196:197], v242 offset:3072
    ds_read_b64 v[198:199], v242 offset:3584
    ds_read_b64 v[200:201], v242 offset:4096
    ds_read_b64 v[202:203], v242 offset:4608
    s_mov_b32 s88, 0x3f803f80
    v_mov_b32 v248, s88
    v_mov_b32 v249, s88
    v_mov_b32 v250, s88
    v_mov_b32 v251, s88
    v_and_b32 v252, 3, v2
    v_cmp_eq_u32 s[56:57], 1, v252
    v_cmp_eq_u32 s[58:59], 2, v252
    v_cmp_eq_u32 s[60:61], 3, v252
    v_lshrrev_b32 v252, 2, v2
    v_cmp_eq_u32 vcc, v252, v3
    s_mul_i32 s88, s3, 384
    v_lshlrev_b32 v252, 3, v2
    v_add_u32 v252, s88, v252
    v_mov_b32 v255, 1536
    v_cndmask_b32 v255, v255, v252, vcc
    s_waitcnt lgkmcnt(8)
    v_mfma_f32_16x16x32_bf16 v[208:211], v[248:251], v[184:187], 0
    v_mfma_f32_16x16x32_bf16 v[212:215], v[184:187], v[184:187], 0
    s_waitcnt lgkmcnt(6)
    v_mfma_f32_16x16x32_bf16 v[208:211], v[248:251], v[188:191], v[208:211]
    v_mfma_f32_16x16x32_bf16 v[212:215], v[188:191], v[188:191], v[212:215]
    s_waitcnt lgkmcnt(4)
    v_mfma_f32_16x16x32_bf16 v[208:211], v[248:251], v[192:195], v[208:211]
    v_mfma_f32_16x16x32_bf16 v[212:215], v[192:195], v[192:195], v[212:215]
    s_waitcnt lgkmcnt(2)
    v_mfma_f32_16x16x32_bf16 v[208:211], v[248:251], v[196:199], v[208:211]
    v_mfma_f32_16x16x32_bf16 v[212:215], v[196:199], v[196:199], v[212:215]
    s_waitcnt lgkmcnt(0)
    v_mfma_f32_16x16x32_bf16 v[208:211], v[248:251], v[200:203], v[208:211]
    v_mfma_f32_16x16x32_bf16 v[212:215], v[200:203], v[200:203], v[212:215]
    s_nop 7
    v_cndmask_b32 v212, v212, v213, s[56:57]
    v_cndmask_b32 v212, v212, v214, s[58:59]
    v_cndmask_b32 v209, v212, v215, s[60:61]
    ds_write_b64 v255, v[208:209] offset:2048
    v_mfma_f32_16x16x32_bf16 v[120:123], a[32:35], v[76:79], v[120:123]
    ds_read_b64 v[72:73], v36 offset:57344
    ds_read_b64 v[74:75], v36 offset:57856
    v_mfma_f32_16x16x32_bf16 v[124:127], a[36:39], v[76:79], v[124:127]
    s_add_u32 m0, s92, 102400
    v_mfma_f32_16x16x32_bf16 v[128:131], a[32:35], v[80:83], v[128:131]
    ds_read_b64 v[76:77], v36 offset:59392
    ds_read_b64 v[78:79], v36 offset:59904
    v_mfma_f32_16x16x32_bf16 v[132:135], a[36:39], v[80:83], v[132:135]
    buffer_load_dwordx4 v13, s[44:47], s95 offen lds
    v_mfma_f32_16x16x32_bf16 v[136:139], a[32:35], v[84:87], v[136:139]
    ds_read_b64 v[80:81], v36 offset:41984
    ds_read_b64 v[82:83], v36 offset:42496
    v_mfma_f32_16x16x32_bf16 v[140:143], a[36:39], v[84:87], v[140:143]
    s_add_u32 s91, s93, 16384
    v_mfma_f32_16x16x32_bf16 v[144:147], a[32:35], v[88:91], v[144:147]
    ds_read_b64 v[84:85], v36 offset:44032
    ds_read_b64 v[86:87], v36 offset:44544
    v_mfma_f32_16x16x32_bf16 v[148:151], a[36:39], v[88:91], v[148:151]
    buffer_load_dwordx4 a[64:67], v5, s[20:23], s91 offen
    v_mfma_f32_16x16x32_bf16 v[152:155], a[32:35], v[92:95], v[152:155]
    ds_read_b64 v[88:89], v36 offset:46080
    ds_read_b64 v[90:91], v36 offset:46592
    v_mfma_f32_16x16x32_bf16 v[156:159], a[36:39], v[92:95], v[156:159]
    s_waitcnt lgkmcnt(6)
    v_mfma_f32_16x16x32_bf16 v[160:163], a[32:35], v[72:75], v[160:163]
    ds_read_b64 v[92:93], v36 offset:48128
    ds_read_b64 v[94:95], v36 offset:48640
    v_mfma_f32_16x16x32_bf16 v[164:167], a[36:39], v[72:75], v[164:167]
    buffer_load_dwordx4 a[68:71], v5, s[20:23], s91 offen offset:1024
    v_mfma_f32_16x16x32_bf16 v[168:171], a[32:35], v[76:79], v[168:171]
    ds_read_b64 v[72:73], v36 offset:50176
    ds_read_b64 v[74:75], v36 offset:50688
    v_mfma_f32_16x16x32_bf16 v[172:175], a[36:39], v[76:79], v[172:175]
    s_add_u32 s91, s93, 18432
    s_waitcnt lgkmcnt(6)
    s_waitcnt vmcnt(17)
    v_mfma_f32_16x16x32_bf16 v[96:99], a[40:43], v[80:83], v[96:99]
    ds_read_b64 v[76:77], v36 offset:52224
    ds_read_b64 v[78:79], v36 offset:52736
    s_waitcnt vmcnt(16)
    v_mfma_f32_16x16x32_bf16 v[100:103], a[44:47], v[80:83], v[100:103]
    buffer_load_dwordx4 a[72:75], v5, s[20:23], s91 offen
    v_mfma_f32_16x16x32_bf16 v[104:107], a[40:43], v[84:87], v[104:107]
    ds_read_b64 v[80:81], v36 offset:54272
    ds_read_b64 v[82:83], v36 offset:54784
    v_mfma_f32_16x16x32_bf16 v[108:111], a[44:47], v[84:87], v[108:111]
    s_waitcnt lgkmcnt(6)
    v_mfma_f32_16x16x32_bf16 v[112:115], a[40:43], v[88:91], v[112:115]
    ds_read_b64 v[84:85], v36 offset:56320
    ds_read_b64 v[86:87], v36 offset:56832
    v_mfma_f32_16x16x32_bf16 v[116:119], a[44:47], v[88:91], v[116:119]
    buffer_load_dwordx4 a[76:79], v5, s[20:23], s91 offen offset:1024
    v_mfma_f32_16x16x32_bf16 v[120:123], a[40:43], v[92:95], v[120:123]
    ds_read_b64 v[88:89], v36 offset:58368
    ds_read_b64 v[90:91], v36 offset:58880
    v_mfma_f32_16x16x32_bf16 v[124:127], a[44:47], v[92:95], v[124:127]
    s_add_u32 s95, s14, 10240
    s_add_u32 m0, s92, 106496
    s_waitcnt lgkmcnt(6)
    v_mfma_f32_16x16x32_bf16 v[128:131], a[40:43], v[72:75], v[128:131]
    ds_read_b64 v[92:93], v36 offset:60416
    ds_read_b64 v[94:95], v36 offset:60928
    v_mfma_f32_16x16x32_bf16 v[132:135], a[44:47], v[72:75], v[132:135]
    buffer_load_dwordx4 v9, s[44:47], s95 offen lds
    v_mfma_f32_16x16x32_bf16 v[136:139], a[40:43], v[76:79], v[136:139]
    s_waitcnt vmcnt(14)
    s_waitcnt lgkmcnt(0)
    s_barrier
    ds_read_b64 v[72:73], v37 offset:0
    ds_read_b64 v[74:75], v37 offset:512
    v_mfma_f32_16x16x32_bf16 v[140:143], a[44:47], v[76:79], v[140:143]
    s_add_u32 m0, s92, 110592
    v_mfma_f32_16x16x32_bf16 v[144:147], a[40:43], v[80:83], v[144:147]
    ds_read_b64 v[76:77], v37 offset:2048
    ds_read_b64 v[78:79], v37 offset:2560
    v_mfma_f32_16x16x32_bf16 v[148:151], a[44:47], v[80:83], v[148:151]
    buffer_load_dwordx4 v10, s[44:47], s95 offen lds
    v_mfma_f32_16x16x32_bf16 v[152:155], a[40:43], v[84:87], v[152:155]
    ds_read_b64 v[80:81], v37 offset:4096
    ds_read_b64 v[82:83], v37 offset:4608
    v_mfma_f32_16x16x32_bf16 v[156:159], a[44:47], v[84:87], v[156:159]
    s_add_u32 m0, s92, 114688
    v_mfma_f32_16x16x32_bf16 v[160:163], a[40:43], v[88:91], v[160:163]
    ds_read_b64 v[84:85], v37 offset:6144
    ds_read_b64 v[86:87], v37 offset:6656
    v_mfma_f32_16x16x32_bf16 v[164:167], a[44:47], v[88:91], v[164:167]
    buffer_load_dwordx4 v11, s[44:47], s95 offen lds
    v_mfma_f32_16x16x32_bf16 v[168:171], a[40:43], v[92:95], v[168:171]
    ds_read_b64 v[88:89], v37 offset:8192
    ds_read_b64 v[90:91], v37 offset:8704
    v_mfma_f32_16x16x32_bf16 v[172:175], a[44:47], v[92:95], v[172:175]
    s_add_u32 m0, s92, 118784
    s_waitcnt lgkmcnt(6)
    s_waitcnt vmcnt(15)
    v_mfma_f32_16x16x32_bf16 v[96:99], a[48:51], v[72:75], v[96:99]
    ds_read_b64 v[92:93], v37 offset:10240
    ds_read_b64 v[94:95], v37 offset:10752
    s_waitcnt vmcnt(14)
    v_mfma_f32_16x16x32_bf16 v[100:103], a[52:55], v[72:75], v[100:103]
    buffer_load_dwordx4 v12, s[44:47], s95 offen lds
    v_lshlrev_b32 v22, 3, v2
    ds_read_b64 v[184:185], v22 offset:2048
    ds_read_b64 v[186:187], v22 offset:2432
    ds_read_b64 v[188:189], v22 offset:2816
    ds_read_b64 v[190:191], v22 offset:3200
    s_waitcnt lgkmcnt(2)
    v_pk_add_f32 v[184:185], v[184:185], v[186:187]
    s_waitcnt lgkmcnt(0)
    v_pk_add_f32 v[188:189], v[188:189], v[190:191]
    v_pk_add_f32 v[184:185], v[184:185], v[188:189]
    s_cmp_lg_u32 s3, 0
    s_cbranch_scc1 CL_st1_10
    s_lshl_b32 s88, s9, 7
    v_cmp_gt_u32 vcc, 16, v1
    v_mov_b32 v23, 0x40000000
    s_nop 0
    v_cndmask_b32 v22, v23, v22, vcc
    buffer_store_dwordx2 v[184:185], v22, s[40:43], s88 offen
CL_st1_10:
    v_mfma_f32_16x16x32_bf16 v[104:107], a[48:51], v[76:79], v[104:107]
    ds_read_b64 v[72:73], v37 offset:12288
    ds_read_b64 v[74:75], v37 offset:12800
    v_mfma_f32_16x16x32_bf16 v[108:111], a[52:55], v[76:79], v[108:111]
    s_add_u32 m0, s92, 122880
    v_mfma_f32_16x16x32_bf16 v[112:115], a[48:51], v[80:83], v[112:115]
    ds_read_b64 v[76:77], v37 offset:14336
    ds_read_b64 v[78:79], v37 offset:14848
    v_mfma_f32_16x16x32_bf16 v[116:119], a[52:55], v[80:83], v[116:119]
    buffer_load_dwordx4 v13, s[44:47], s95 offen lds
    v_mfma_f32_16x16x32_bf16 v[120:123], a[48:51], v[84:87], v[120:123]
    ds_read_b64 v[80:81], v37 offset:16384
    ds_read_b64 v[82:83], v37 offset:16896
    v_mfma_f32_16x16x32_bf16 v[124:127], a[52:55], v[84:87], v[124:127]
    s_add_u32 s91, s93, 20480
    v_mfma_f32_16x16x32_bf16 v[128:131], a[48:51], v[88:91], v[128:131]
    ds_read_b64 v[84:85], v37 offset:18432
    ds_read_b64 v[86:87], v37 offset:18944
    v_mfma_f32_16x16x32_bf16 v[132:135], a[52:55], v[88:91], v[132:135]
    buffer_load_dwordx4 a[80:83], v5, s[20:23], s91 offen
    v_mfma_f32_16x16x32_bf16 v[136:139], a[48:51], v[92:95], v[136:139]
    ds_read_b64 v[88:89], v37 offset:1024
    ds_read_b64 v[90:91], v37 offset:1536
    v_mfma_f32_16x16x32_bf16 v[140:143], a[52:55], v[92:95], v[140:143]
    s_waitcnt lgkmcnt(6)
    v_mfma_f32_16x16x32_bf16 v[144:147], a[48:51], v[72:75], v[144:147]
    ds_read_b64 v[92:93], v37 offset:3072
    ds_read_b64 v[94:95], v37 offset:3584
    v_mfma_f32_16x16x32_bf16 v[148:151], a[52:55], v[72:75], v[148:151]
    buffer_load_dwordx4 a[84:87], v5, s[20:23], s91 offen offset:1024
    v_mfma_f32_16x16x32_bf16 v[152:155], a[48:51], v[76:79], v[152:155]
    ds_read_b64 v[72:73], v37 offset:5120
    ds_read_b64 v[74:75], v37 offset:5632
    v_mfma_f32_16x16x32_bf16 v[156:159], a[52:55], v[76:79], v[156:159]
    s_add_u32 s91, s93, 22528
    s_waitcnt lgkmcnt(6)
    v_mfma_f32_16x16x32_bf16 v[160:163], a[48:51], v[80:83], v[160:163]
    ds_read_b64 v[76:77], v37 offset:7168
    ds_read_b64 v[78:79], v37 offset:7680
    v_mfma_f32_16x16x32_bf16 v[164:167], a[52:55], v[80:83], v[164:167]
    buffer_load_dwordx4 a[88:91], v5, s[20:23], s91 offen
    v_mfma_f32_16x16x32_bf16 v[168:171], a[48:51], v[84:87], v[168:171]
    ds_read_b64 v[80:81], v37 offset:9216
    ds_read_b64 v[82:83], v37 offset:9728
    v_mfma_f32_16x16x32_bf16 v[172:175], a[52:55], v[84:87], v[172:175]
    s_waitcnt lgkmcnt(6)
    s_waitcnt vmcnt(18)
    v_mfma_f32_16x16x32_bf16 v[96:99], a[56:59], v[88:91], v[96:99]
    ds_read_b64 v[84:85], v37 offset:11264
    ds_read_b64 v[86:87], v37 offset:11776
    s_waitcnt vmcnt(17)
    v_mfma_f32_16x16x32_bf16 v[100:103], a[60:63], v[88:91], v[100:103]
    buffer_load_dwordx4 a[92:95], v5, s[20:23], s91 offen offset:1024
    v_mfma_f32_16x16x32_bf16 v[104:107], a[56:59], v[92:95], v[104:107]
    ds_read_b64 v[88:89], v37 offset:13312
    ds_read_b64 v[90:91], v37 offset:13824
    v_mfma_f32_16x16x32_bf16 v[108:111], a[60:63], v[92:95], v[108:111]
    s_add_u32 s95, s14, 12288
    s_add_u32 m0, s92, 126976
    s_waitcnt lgkmcnt(6)
    v_mfma_f32_16x16x32_bf16 v[112:115], a[56:59], v[72:75], v[112:115]
    ds_read_b64 v[92:93], v37 offset:15360
    ds_read_b64 v[94:95], v37 offset:15872
    v_mfma_f32_16x16x32_bf16 v[116:119], a[60:63], v[72:75], v[116:119]
    buffer_load_dwordx4 v9, s[44:47], s95 offen lds
    v_mfma_f32_16x16x32_bf16 v[120:123], a[56:59], v[76:79], v[120:123]
    ds_read_b64 v[72:73], v37 offset:17408
    ds_read_b64 v[74:75], v37 offset:17920
    v_mfma_f32_16x16x32_bf16 v[124:127], a[60:63], v[76:79], v[124:127]
    s_add_u32 m0, s92, 131072
    s_waitcnt lgkmcnt(6)
    v_mfma_f32_16x16x32_bf16 v[128:131], a[56:59], v[80:83], v[128:131]
    ds_read_b64 v[76:77], v37 offset:19456
    ds_read_b64 v[78:79], v37 offset:19968
    v_mfma_f32_16x16x32_bf16 v[132:135], a[60:63], v[80:83], v[132:135]
    buffer_load_dwordx4 v10, s[44:47], s95 offen lds
    v_mfma_f32_16x16x32_bf16 v[136:139], a[56:59], v[84:87], v[136:139]
    s_waitcnt vmcnt(15)
    s_barrier
    ds_read_b64 v[80:81], v37 offset:20480
    ds_read_b64 v[82:83], v37 offset:20992
    v_mfma_f32_16x16x32_bf16 v[140:143], a[60:63], v[84:87], v[140:143]
    s_add_u32 m0, s92, 135168
    s_waitcnt lgkmcnt(6)
    v_mfma_f32_16x16x32_bf16 v[144:147], a[56:59], v[88:91], v[144:147]
    ds_read_b64 v[84:85], v37 offset:22528
    ds_read_b64 v[86:87], v37 offset:23040
    v_mfma_f32_16x16x32_bf16 v[148:151], a[60:63], v[88:91], v[148:151]
    buffer_load_dwordx4 v11, s[44:47], s95 offen lds
    v_mfma_f32_16x16x32_bf16 v[152:155], a[56:59], v[92:95], v[152:155]
    ds_read_b64 v[88:89], v37 offset:24576
    ds_read_b64 v[90:91], v37 offset:25088
    v_mfma_f32_16x16x32_bf16 v[156:159], a[60:63], v[92:95], v[156:159]
    s_add_u32 m0, s92, 139264
    s_waitcnt lgkmcnt(6)
    v_mfma_f32_16x16x32_bf16 v[160:163], a[56:59], v[72:75], v[160:163]
    ds_read_b64 v[92:93], v37 offset:26624
    ds_read_b64 v[94:95], v37 offset:27136
    v_mfma_f32_16x16x32_bf16 v[164:167], a[60:63], v[72:75], v[164:167]
    buffer_load_dwordx4 v12, s[44:47], s95 offen lds
    v_mfma_f32_16x16x32_bf16 v[168:171], a[56:59], v[76:79], v[168:171]
    ds_read_b64 v[72:73], v37 offset:28672
    ds_read_b64 v[74:75], v37 offset:29184
    v_mfma_f32_16x16x32_bf16 v[172:175], a[60:63], v[76:79], v[172:175]
    s_add_u32 m0, s92, 143360
    s_waitcnt lgkmcnt(6)
    s_waitcnt vmcnt(16)
    v_mfma_f32_16x16x32_bf16 v[96:99], a[64:67], v[80:83], v[96:99]
    ds_read_b64 v[76:77], v37 offset:30720
    ds_read_b64 v[78:79], v37 offset:31232
    s_waitcnt vmcnt(15)
    v_mfma_f32_16x16x32_bf16 v[100:103], a[68:71], v[80:83], v[100:103]
    buffer_load_dwordx4 v13, s[44:47], s95 offen lds
    v_mfma_f32_16x16x32_bf16 v[104:107], a[64:67], v[84:87], v[104:107]
    ds_read_b64 v[80:81], v37 offset:32768
    ds_read_b64 v[82:83], v37 offset:33280
    v_mfma_f32_16x16x32_bf16 v[108:111], a[68:71], v[84:87], v[108:111]
    s_add_u32 s91, s93, 24576
    s_waitcnt lgkmcnt(6)
    v_mfma_f32_16x16x32_bf16 v[112:115], a[64:67], v[88:91], v[112:115]
    ds_read_b64 v[84:85], v37 offset:34816
    ds_read_b64 v[86:87], v37 offset:35328
    v_mfma_f32_16x16x32_bf16 v[116:119], a[68:71], v[88:91], v[116:119]
    buffer_load_dwordx4 a[96:99], v5, s[20:23], s91 offen
    v_mfma_f32_16x16x32_bf16 v[120:123], a[64:67], v[92:95], v[120:123]
    ds_read_b64 v[88:89], v37 offset:36864
    ds_read_b64 v[90:91], v37 offset:37376
    v_mfma_f32_16x16x32_bf16 v[124:127], a[68:71], v[92:95], v[124:127]
    s_waitcnt lgkmcnt(6)
    v_mfma_f32_16x16x32_bf16 v[128:131], a[64:67], v[72:75], v[128:131]
    ds_read_b64 v[92:93], v37 offset:38912
    ds_read_b64 v[94:95], v37 offset:39424
    v_mfma_f32_16x16x32_bf16 v[132:135], a[68:71], v[72:75], v[132:135]
    buffer_load_dwordx4 a[100:103], v5, s[20:23], s91 offen offset:1024
    v_mfma_f32_16x16x32_bf16 v[136:139], a[64:67], v[76:79], v[136:139]
    ds_read_b64 v[72:73], v37 offset:21504
    ds_read_b64 v[74:75], v37 offset:22016
    v_mfma_f32_16x16x32_bf16 v[140:143], a[68:71], v[76:79], v[140:143]
    s_add_u32 s91, s93, 26624
    s_waitcnt lgkmcnt(6)
    v_mfma_f32_16x16x32_bf16 v[144:147], a[64:67], v[80:83], v[144:147]
    ds_read_b64 v[76:77], v37 offset:23552
    ds_read_b64 v[78:79], v37 offset:24064
    v_mfma_f32_16x16x32_bf16 v[148:151], a[68:71], v[80:83], v[148:151]
    buffer_load_dwordx4 a[104:107], v5, s[20:23], s91 offen
    v_mfma_f32_16x16x32_bf16 v[152:155], a[64:67], v[84:87], v[152:155]
    ds_read_b64 v[80:81], v37 offset:25600
    ds_read_b64 v[82:83], v37 offset:26112
    v_mfma_f32_16x16x32_bf16 v[156:159], a[68:71], v[84:87], v[156:159]
    s_waitcnt lgkmcnt(6)
    v_mfma_f32_16x16x32_bf16 v[160:163], a[64:67], v[88:91], v[160:163]
    ds_read_b64 v[84:85], v37 offset:27648
    ds_read_b64 v[86:87], v37 offset:28160
    v_mfma_f32_16x16x32_bf16 v[164:167], a[68:71], v[88:91], v[164:167]
    buffer_load_dwordx4 a[108:111], v5, s[20:23], s91 offen offset:1024
    v_mfma_f32_16x16x32_bf16 v[168:171], a[64:67], v[92:95], v[168:171]
    ds_read_b64 v[88:89], v37 offset:29696
    ds_read_b64 v[90:91], v37 offset:30208
    v_mfma_f32_16x16x32_bf16 v[172:175], a[68:71], v[92:95], v[172:175]
    s_add_u32 s95, s14, 14336
    s_add_u32 m0, s92, 4096
    s_waitcnt lgkmcnt(6)
    s_waitcnt vmcnt(19)
    v_mfma_f32_16x16x32_bf16 v[96:99], a[72:75], v[72:75], v[96:99]
    ds_read_b64 v[92:93], v37 offset:31744
    ds_read_b64 v[94:95], v37 offset:32256
    s_waitcnt vmcnt(18)
    v_mfma_f32_16x16x32_bf16 v[100:103], a[76:79], v[72:75], v[100:103]
    buffer_load_dwordx4 v9, s[44:47], s95 offen lds
    s_waitcnt vmcnt(15)
    s_cmp_lg_u32 s3, 0
    s_cbranch_scc1 CL_pub_11
    v_mov_b32 v22, 1
    v_mov_b32 v23, 0
    s_lshl_b32 s88, s9, 2
    v_cmp_eq_u32 vcc, 0, v1
    s_nop 0
    s_and_saveexec_b64 s[86:87], vcc
    buffer_store_dword v22, v23, s[52:55], s88 offen
    s_mov_b64 exec, s[86:87]
CL_pub_11:
    v_mfma_f32_16x16x32_bf16 v[104:107], a[72:75], v[76:79], v[104:107]
    ds_read_b64 v[72:73], v37 offset:33792
    ds_read_b64 v[74:75], v37 offset:34304
    v_mfma_f32_16x16x32_bf16 v[108:111], a[76:79], v[76:79], v[108:111]
    s_add_u32 m0, s92, 8192
    s_waitcnt lgkmcnt(6)
    v_mfma_f32_16x16x32_bf16 v[112:115], a[72:75], v[80:83], v[112:115]
    ds_read_b64 v[76:77], v37 offset:35840
    ds_read_b64 v[78:79], v37 offset:36352
    v_mfma_f32_16x16x32_bf16 v[116:119], a[76:79], v[80:83], v[116:119]
    buffer_load_dwordx4 v10, s[44:47], s95 offen lds
    v_mfma_f32_16x16x32_bf16 v[120:123], a[72:75], v[84:87], v[120:123]
    ds_read_b64 v[80:81], v37 offset:37888
    ds_read_b64 v[82:83], v37 offset:38400
    v_mfma_f32_16x16x32_bf16 v[124:127], a[76:79], v[84:87], v[124:127]
    s_add_u32 m0, s92, 12288
    s_waitcnt lgkmcnt(6)
    v_mfma_f32_16x16x32_bf16 v[128:131], a[72:75], v[88:91], v[128:131]
    ds_read_b64 v[84:85], v37 offset:39936
    ds_read_b64 v[86:87], v37 offset:40448
    v_mfma_f32_16x16x32_bf16 v[132:135], a[76:79], v[88:91], v[132:135]
    buffer_load_dwordx4 v11, s[44:47], s95 offen lds
    v_mfma_f32_16x16x32_bf16 v[136:139], a[72:75], v[92:95], v[136:139]
    s_waitcnt vmcnt(16)
    s_barrier
    ds_read_b64 v[88:89], v37 offset:40960
    ds_read_b64 v[90:91], v37 offset:41472
    v_mfma_f32_16x16x32_bf16 v[140:143], a[76:79], v[92:95], v[140:143]
    s_add_u32 m0, s92, 16384
    s_waitcnt lgkmcnt(6)
    v_mfma_f32_16x16x32_bf16 v[144:147], a[72:75], v[72:75], v[144:147]
    ds_read_b64 v[92:93], v37 offset:43008
    ds_read_b64 v[94:95], v37 offset:43520
    v_mfma_f32_16x16x32_bf16 v[148:151], a[76:79], v[72:75], v[148:151]
    buffer_load_dwordx4 v12, s[44:47], s95 offen lds
    v_mfma_f32_16x16x32_bf16 v[152:155], a[72:75], v[76:79], v[152:155]
    ds_read_b64 v[72:73], v37 offset:45056
    ds_read_b64 v[74:75], v37 offset:45568
    v_mfma_f32_16x16x32_bf16 v[156:159], a[76:79], v[76:79], v[156:159]
    s_add_u32 m0, s92, 20480
    s_waitcnt lgkmcnt(6)
    v_mfma_f32_16x16x32_bf16 v[160:163], a[72:75], v[80:83], v[160:163]
    ds_read_b64 v[76:77], v37 offset:47104
    ds_read_b64 v[78:79], v37 offset:47616
    v_mfma_f32_16x16x32_bf16 v[164:167], a[76:79], v[80:83], v[164:167]
    buffer_load_dwordx4 v13, s[44:47], s95 offen lds
    v_mfma_f32_16x16x32_bf16 v[168:171], a[72:75], v[84:87], v[168:171]
    ds_read_b64 v[80:81], v37 offset:49152
    ds_read_b64 v[82:83], v37 offset:49664
    v_mfma_f32_16x16x32_bf16 v[172:175], a[76:79], v[84:87], v[172:175]
    s_add_u32 s91, s93, 28672
    s_waitcnt lgkmcnt(6)
    s_waitcnt vmcnt(17)
    v_mfma_f32_16x16x32_bf16 v[96:99], a[80:83], v[88:91], v[96:99]
    ds_read_b64 v[84:85], v37 offset:51200
    ds_read_b64 v[86:87], v37 offset:51712
    s_waitcnt vmcnt(16)
    v_mfma_f32_16x16x32_bf16 v[100:103], a[84:87], v[88:91], v[100:103]
    buffer_load_dwordx4 a[112:115], v5, s[20:23], s91 offen
    v_mfma_f32_16x16x32_bf16 v[104:107], a[80:83], v[92:95], v[104:107]
    ds_read_b64 v[88:89], v37 offset:53248
    ds_read_b64 v[90:91], v37 offset:53760
    v_mfma_f32_16x16x32_bf16 v[108:111], a[84:87], v[92:95], v[108:111]
    s_waitcnt lgkmcnt(6)
    v_mfma_f32_16x16x32_bf16 v[112:115], a[80:83], v[72:75], v[112:115]
    ds_read_b64 v[92:93], v37 offset:55296
    ds_read_b64 v[94:95], v37 offset:55808
    v_mfma_f32_16x16x32_bf16 v[116:119], a[84:87], v[72:75], v[116:119]
    buffer_load_dwordx4 a[116:119], v5, s[20:23], s91 offen offset:1024
    v_mfma_f32_16x16x32_bf16 v[120:123], a[80:83], v[76:79], v[120:123]
    ds_read_b64 v[72:73], v37 offset:57344
    ds_read_b64 v[74:75], v37 offset:57856
    v_mfma_f32_16x16x32_bf16 v[124:127], a[84:87], v[76:79], v[124:127]
    s_add_u32 s91, s93, 30720
    s_waitcnt lgkmcnt(6)
    v_mfma_f32_16x16x32_bf16 v[128:131], a[80:83], v[80:83], v[128:131]
    ds_read_b64 v[76:77], v37 offset:59392
    ds_read_b64 v[78:79], v37 offset:59904
    v_mfma_f32_16x16x32_bf16 v[132:135], a[84:87], v[80:83], v[132:135]
    buffer_load_dwordx4 a[120:123], v5, s[20:23], s91 offen
    v_mfma_f32_16x16x32_bf16 v[136:139], a[80:83], v[84:87], v[136:139]
    ds_read_b64 v[80:81], v37 offset:41984
    ds_read_b64 v[82:83], v37 offset:42496
    v_mfma_f32_16x16x32_bf16 v[140:143], a[84:87], v[84:87], v[140:143]
    s_waitcnt lgkmcnt(6)
    v_mfma_f32_16x16x32_bf16 v[144:147], a[80:83], v[88:91], v[144:147]
    ds_read_b64 v[84:85], v37 offset:44032
    ds_read_b64 v[86:87], v37 offset:44544
    v_mfma_f32_16x16x32_bf16 v[148:151], a[84:87], v[88:91], v[148:151]
    buffer_load_dwordx4 a[124:127], v5, s[20:23], s91 offen offset:1024
    v_mfma_f32_16x16x32_bf16 v[152:155], a[80:83], v[92:95], v[152:155]
    ds_read_b64 v[88:89], v37 offset:46080
    ds_read_b64 v[90:91], v37 offset:46592
    v_mfma_f32_16x16x32_bf16 v[156:159], a[84:87], v[92:95], v[156:159]
    s_add_u32 s95, s14, 16384
    s_add_u32 m0, s92, 24576
    s_waitcnt lgkmcnt(6)
    v_mfma_f32_16x16x32_bf16 v[160:163], a[80:83], v[72:75], v[160:163]
    ds_read_b64 v[92:93], v37 offset:48128
    ds_read_b64 v[94:95], v37 offset:48640
    v_mfma_f32_16x16x32_bf16 v[164:167], a[84:87], v[72:75], v[164:167]
    buffer_load_dwordx4 v9, s[44:47], s95 offen lds
    v_mfma_f32_16x16x32_bf16 v[168:171], a[80:83], v[76:79], v[168:171]
    ds_read_b64 v[72:73], v37 offset:50176
    ds_read_b64 v[74:75], v37 offset:50688
    v_mfma_f32_16x16x32_bf16 v[172:175], a[84:87], v[76:79], v[172:175]
    s_add_u32 m0, s92, 28672
    s_waitcnt lgkmcnt(6)
    s_waitcnt vmcnt(20)
    v_mfma_f32_16x16x32_bf16 v[96:99], a[88:91], v[80:83], v[96:99]
    ds_read_b64 v[76:77], v37 offset:52224
    ds_read_b64 v[78:79], v37 offset:52736
    s_waitcnt vmcnt(19)
    v_mfma_f32_16x16x32_bf16 v[100:103], a[92:95], v[80:83], v[100:103]
    buffer_load_dwordx4 v10, s[44:47], s95 offen lds
    v_mfma_f32_16x16x32_bf16 v[104:107], a[88:91], v[84:87], v[104:107]
    ds_read_b64 v[80:81], v37 offset:54272
    ds_read_b64 v[82:83], v37 offset:54784
    v_mfma_f32_16x16x32_bf16 v[108:111], a[92:95], v[84:87], v[108:111]
    s_add_u32 m0, s92, 32768
    s_waitcnt lgkmcnt(6)
    v_mfma_f32_16x16x32_bf16 v[112:115], a[88:91], v[88:91], v[112:115]
    ds_read_b64 v[84:85], v37 offset:56320
    ds_read_b64 v[86:87], v37 offset:56832
    v_mfma_f32_16x16x32_bf16 v[116:119], a[92:95], v[88:91], v[116:119]
    buffer_load_dwordx4 v11, s[44:47], s95 offen lds
    v_mfma_f32_16x16x32_bf16 v[120:123], a[88:91], v[92:95], v[120:123]
    ds_read_b64 v[88:89], v37 offset:58368
    ds_read_b64 v[90:91], v37 offset:58880
    v_mfma_f32_16x16x32_bf16 v[124:127], a[92:95], v[92:95], v[124:127]
    s_add_u32 m0, s92, 36864
    s_waitcnt lgkmcnt(6)
    v_mfma_f32_16x16x32_bf16 v[128:131], a[88:91], v[72:75], v[128:131]
    ds_read_b64 v[92:93], v37 offset:60416
    ds_read_b64 v[94:95], v37 offset:60928
    v_mfma_f32_16x16x32_bf16 v[132:135], a[92:95], v[72:75], v[132:135]
    buffer_load_dwordx4 v12, s[44:47], s95 offen lds
    v_mfma_f32_16x16x32_bf16 v[136:139], a[88:91], v[76:79], v[136:139]
    s_waitcnt vmcnt(17)
    s_barrier
    ds_read_b64 v[72:73], v38 offset:0
    ds_read_b64 v[74:75], v38 offset:512
    v_mfma_f32_16x16x32_bf16 v[140:143], a[92:95], v[76:79], v[140:143]
    s_add_u32 m0, s92, 40960
    s_waitcnt lgkmcnt(6)
    v_mfma_f32_16x16x32_bf16 v[144:147], a[88:91], v[80:83], v[144:147]
    ds_read_b64 v[76:77], v38 offset:2048
    ds_read_b64 v[78:79], v38 offset:2560
    v_mfma_f32_16x16x32_bf16 v[148:151], a[92:95], v[80:83], v[148:151]
    buffer_load_dwordx4 v13, s[44:47], s95 offen lds
    v_mfma_f32_16x16x32_bf16 v[152:155], a[88:91], v[84:87], v[152:155]
    ds_read_b64 v[80:81], v38 offset:4096
    ds_read_b64 v[82:83], v38 offset:4608
    v_mfma_f32_16x16x32_bf16 v[156:159], a[92:95], v[84:87], v[156:159]
    s_add_u32 s91, s93, 32768
    s_waitcnt lgkmcnt(6)
    v_mfma_f32_16x16x32_bf16 v[160:163], a[88:91], v[88:91], v[160:163]
    ds_read_b64 v[84:85], v38 offset:6144
    ds_read_b64 v[86:87], v38 offset:6656
    v_mfma_f32_16x16x32_bf16 v[164:167], a[92:95], v[88:91], v[164:167]
    buffer_load_dwordx4 a[128:131], v5, s[20:23], s91 offen
    v_mfma_f32_16x16x32_bf16 v[168:171], a[88:91], v[92:95], v[168:171]
    ds_read_b64 v[88:89], v38 offset:8192
    ds_read_b64 v[90:91], v38 offset:8704
    v_mfma_f32_16x16x32_bf16 v[172:175], a[92:95], v[92:95], v[172:175]
    s_waitcnt lgkmcnt(6)
    s_waitcnt vmcnt(18)
    v_mfma_f32_16x16x32_bf16 v[96:99], a[96:99], v[72:75], v[96:99]
    ds_read_b64 v[92:93], v38 offset:10240
    ds_read_b64 v[94:95], v38 offset:10752
    s_waitcnt vmcnt(17)
    v_mfma_f32_16x16x32_bf16 v[100:103], a[100:103], v[72:75], v[100:103]
    buffer_load_dwordx4 a[132:135], v5, s[20:23], s91 offen offset:1024
    v_mfma_f32_16x16x32_bf16 v[104:107], a[96:99], v[76:79], v[104:107]
    ds_read_b64 v[72:73], v38 offset:12288
    ds_read_b64 v[74:75], v38 offset:12800
    v_mfma_f32_16x16x32_bf16 v[108:111], a[100:103], v[76:79], v[108:111]
    s_add_u32 s91, s93, 34816
    s_waitcnt lgkmcnt(6)
    v_mfma_f32_16x16x32_bf16 v[112:115], a[96:99], v[80:83], v[112:115]
    ds_read_b64 v[76:77], v38 offset:14336
    ds_read_b64 v[78:79], v38 offset:14848
    v_mfma_f32_16x16x32_bf16 v[116:119], a[100:103], v[80:83], v[116:119]
    buffer_load_dwordx4 a[136:139], v5, s[20:23], s91 offen
    s_getpc_b64 s[76:77]
CL_pc_12:
    s_sub_u32 s76, s76, CL_pc_12-interleave_layers__ssm_conv_h3__sliding_local_dilated__prompt_kernel
    s_subb_u32 s77, s77, 0
    s_mov_b32 s78, code_end-interleave_layers__ssm_conv_h3__sliding_local_dilated__prompt_kernel
    s_mov_b32 s79, 0x20000
    v_lshlrev_b32 v64, 7, v0
    s_mov_b32 s89, 15360
    buffer_load_dword v65, v64, s[76:79], s89 offen
    v_mfma_f32_16x16x32_bf16 v[120:123], a[96:99], v[84:87], v[120:123]
    ds_read_b64 v[80:81], v38 offset:16384
    ds_read_b64 v[82:83], v38 offset:16896
    v_mfma_f32_16x16x32_bf16 v[124:127], a[100:103], v[84:87], v[124:127]
    s_waitcnt lgkmcnt(6)
    v_mfma_f32_16x16x32_bf16 v[128:131], a[96:99], v[88:91], v[128:131]
    ds_read_b64 v[84:85], v38 offset:18432
    ds_read_b64 v[86:87], v38 offset:18944
    v_mfma_f32_16x16x32_bf16 v[132:135], a[100:103], v[88:91], v[132:135]
    buffer_load_dwordx4 a[140:143], v5, s[20:23], s91 offen offset:1024
    v_mfma_f32_16x16x32_bf16 v[136:139], a[96:99], v[92:95], v[136:139]
    ds_read_b64 v[88:89], v38 offset:1024
    ds_read_b64 v[90:91], v38 offset:1536
    v_mfma_f32_16x16x32_bf16 v[140:143], a[100:103], v[92:95], v[140:143]
    s_add_u32 s95, s14, 18432
    s_add_u32 m0, s92, 45056
    s_waitcnt lgkmcnt(6)
    v_mfma_f32_16x16x32_bf16 v[144:147], a[96:99], v[72:75], v[144:147]
    ds_read_b64 v[92:93], v38 offset:3072
    ds_read_b64 v[94:95], v38 offset:3584
    v_mfma_f32_16x16x32_bf16 v[148:151], a[100:103], v[72:75], v[148:151]
    buffer_load_dwordx4 v9, s[44:47], s95 offen lds
    v_mfma_f32_16x16x32_bf16 v[152:155], a[96:99], v[76:79], v[152:155]
    ds_read_b64 v[72:73], v38 offset:5120
    ds_read_b64 v[74:75], v38 offset:5632
    v_mfma_f32_16x16x32_bf16 v[156:159], a[100:103], v[76:79], v[156:159]
    s_add_u32 m0, s92, 49152
    s_waitcnt lgkmcnt(6)
    v_mfma_f32_16x16x32_bf16 v[160:163], a[96:99], v[80:83], v[160:163]
    ds_read_b64 v[76:77], v38 offset:7168
    ds_read_b64 v[78:79], v38 offset:7680
    v_mfma_f32_16x16x32_bf16 v[164:167], a[100:103], v[80:83], v[164:167]
    buffer_load_dwordx4 v10, s[44:47], s95 offen lds
    v_mfma_f32_16x16x32_bf16 v[168:171], a[96:99], v[84:87], v[168:171]
    ds_read_b64 v[80:81], v38 offset:9216
    ds_read_b64 v[82:83], v38 offset:9728
    v_mfma_f32_16x16x32_bf16 v[172:175], a[100:103], v[84:87], v[172:175]
    s_add_u32 m0, s92, 53248
    s_waitcnt lgkmcnt(6)
    s_waitcnt vmcnt(22)
    v_mfma_f32_16x16x32_bf16 v[96:99], a[104:107], v[88:91], v[96:99]
    ds_read_b64 v[84:85], v38 offset:11264
    ds_read_b64 v[86:87], v38 offset:11776
    s_waitcnt vmcnt(21)
    v_mfma_f32_16x16x32_bf16 v[100:103], a[108:111], v[88:91], v[100:103]
    buffer_load_dwordx4 v11, s[44:47], s95 offen lds
    v_mfma_f32_16x16x32_bf16 v[104:107], a[104:107], v[92:95], v[104:107]
    ds_read_b64 v[88:89], v38 offset:13312
    ds_read_b64 v[90:91], v38 offset:13824
    v_mfma_f32_16x16x32_bf16 v[108:111], a[108:111], v[92:95], v[108:111]
    s_add_u32 m0, s92, 57344
    s_waitcnt lgkmcnt(6)
    v_mfma_f32_16x16x32_bf16 v[112:115], a[104:107], v[72:75], v[112:115]
    ds_read_b64 v[92:93], v38 offset:15360
    ds_read_b64 v[94:95], v38 offset:15872
    v_mfma_f32_16x16x32_bf16 v[116:119], a[108:111], v[72:75], v[116:119]
    buffer_load_dwordx4 v12, s[44:47], s95 offen lds
    v_mfma_f32_16x16x32_bf16 v[120:123], a[104:107], v[76:79], v[120:123]
    ds_read_b64 v[72:73], v38 offset:17408
    ds_read_b64 v[74:75], v38 offset:17920
    v_mfma_f32_16x16x32_bf16 v[124:127], a[108:111], v[76:79], v[124:127]
    s_add_u32 m0, s92, 61440
    s_waitcnt lgkmcnt(6)
    v_mfma_f32_16x16x32_bf16 v[128:131], a[104:107], v[80:83], v[128:131]
    ds_read_b64 v[76:77], v38 offset:19456
    ds_read_b64 v[78:79], v38 offset:19968
    v_mfma_f32_16x16x32_bf16 v[132:135], a[108:111], v[80:83], v[132:135]
    buffer_load_dwordx4 v13, s[44:47], s95 offen lds
    v_mfma_f32_16x16x32_bf16 v[136:139], a[104:107], v[84:87], v[136:139]
    s_waitcnt vmcnt(19)
    s_barrier
    ds_read_b64 v[80:81], v36 offset:0
    ds_read_b64 v[82:83], v36 offset:512
    v_mfma_f32_16x16x32_bf16 v[140:143], a[108:111], v[84:87], v[140:143]
    s_add_u32 s91, s93, 36864
    s_waitcnt lgkmcnt(6)
    v_mfma_f32_16x16x32_bf16 v[144:147], a[104:107], v[88:91], v[144:147]
    ds_read_b64 v[84:85], v36 offset:2048
    ds_read_b64 v[86:87], v36 offset:2560
    v_mfma_f32_16x16x32_bf16 v[148:151], a[108:111], v[88:91], v[148:151]
    buffer_load_dwordx4 a[144:147], v5, s[20:23], s91 offen
    v_mfma_f32_16x16x32_bf16 v[152:155], a[104:107], v[92:95], v[152:155]
    ds_read_b64 v[88:89], v36 offset:4096
    ds_read_b64 v[90:91], v36 offset:4608
    v_mfma_f32_16x16x32_bf16 v[156:159], a[108:111], v[92:95], v[156:159]
    s_waitcnt lgkmcnt(6)
    v_mfma_f32_16x16x32_bf16 v[160:163], a[104:107], v[72:75], v[160:163]
    ds_read_b64 v[92:93], v36 offset:6144
    ds_read_b64 v[94:95], v36 offset:6656
    v_mfma_f32_16x16x32_bf16 v[164:167], a[108:111], v[72:75], v[164:167]
    buffer_load_dwordx4 a[148:151], v5, s[20:23], s91 offen offset:1024
    v_mfma_f32_16x16x32_bf16 v[168:171], a[104:107], v[76:79], v[168:171]
    ds_read_b64 v[72:73], v36 offset:8192
    ds_read_b64 v[74:75], v36 offset:8704
    v_mfma_f32_16x16x32_bf16 v[172:175], a[108:111], v[76:79], v[172:175]
    s_add_u32 s91, s93, 38912
    s_waitcnt lgkmcnt(6)
    s_waitcnt vmcnt(20)
    v_mfma_f32_16x16x32_bf16 v[96:99], a[112:115], v[80:83], v[96:99]
    ds_read_b64 v[76:77], v36 offset:10240
    ds_read_b64 v[78:79], v36 offset:10752
    s_waitcnt vmcnt(19)
    v_mfma_f32_16x16x32_bf16 v[100:103], a[116:119], v[80:83], v[100:103]
    buffer_load_dwordx4 a[152:155], v5, s[20:23], s91 offen
    v_mfma_f32_16x16x32_bf16 v[104:107], a[112:115], v[84:87], v[104:107]
    ds_read_b64 v[80:81], v36 offset:12288
    ds_read_b64 v[82:83], v36 offset:12800
    v_mfma_f32_16x16x32_bf16 v[108:111], a[116:119], v[84:87], v[108:111]
    s_waitcnt lgkmcnt(6)
    v_mfma_f32_16x16x32_bf16 v[112:115], a[112:115], v[88:91], v[112:115]
    ds_read_b64 v[84:85], v36 offset:14336
    ds_read_b64 v[86:87], v36 offset:14848
    v_mfma_f32_16x16x32_bf16 v[116:119], a[116:119], v[88:91], v[116:119]
    buffer_load_dwordx4 a[156:159], v5, s[20:23], s91 offen offset:1024
    v_mfma_f32_16x16x32_bf16 v[120:123], a[112:115], v[92:95], v[120:123]
    ds_read_b64 v[88:89], v36 offset:16384
    ds_read_b64 v[90:91], v36 offset:16896
    v_mfma_f32_16x16x32_bf16 v[124:127], a[116:119], v[92:95], v[124:127]
    s_add_u32 s91, s94, 0
    s_waitcnt lgkmcnt(6)
    v_mfma_f32_16x16x32_bf16 v[128:131], a[112:115], v[72:75], v[128:131]
    ds_read_b64 v[92:93], v36 offset:18432
    ds_read_b64 v[94:95], v36 offset:18944
    v_mfma_f32_16x16x32_bf16 v[132:135], a[116:119], v[72:75], v[132:135]
    buffer_load_dwordx4 a[160:163], v5, s[24:27], s91 offen offset:0
    s_lshl_b32 s90, s10, 5
    v_min_u32 v62, 9, v1
    v_lshlrev_b32 v62, 2, v62
    buffer_load_dword v61, v62, s[52:55], s90 offen sc1
    v_mfma_f32_16x16x32_bf16 v[136:139], a[112:115], v[76:79], v[136:139]
    ds_read_b64 v[72:73], v36 offset:1024
    ds_read_b64 v[74:75], v36 offset:1536
    v_mfma_f32_16x16x32_bf16 v[140:143], a[116:119], v[76:79], v[140:143]
    s_waitcnt lgkmcnt(6)
    v_mfma_f32_16x16x32_bf16 v[144:147], a[112:115], v[80:83], v[144:147]
    ds_read_b64 v[76:77], v36 offset:3072
    ds_read_b64 v[78:79], v36 offset:3584
    v_mfma_f32_16x16x32_bf16 v[148:151], a[116:119], v[80:83], v[148:151]
    buffer_load_dwordx4 a[164:167], v5, s[24:27], s91 offen offset:1024
    v_mfma_f32_16x16x32_bf16 v[152:155], a[112:115], v[84:87], v[152:155]
    ds_read_b64 v[80:81], v36 offset:5120
    ds_read_b64 v[82:83], v36 offset:5632
    v_mfma_f32_16x16x32_bf16 v[156:159], a[116:119], v[84:87], v[156:159]
    s_add_u32 s91, s94, 2048
    s_waitcnt lgkmcnt(6)
    v_mfma_f32_16x16x32_bf16 v[160:163], a[112:115], v[88:91], v[160:163]
    ds_read_b64 v[84:85], v36 offset:7168
    ds_read_b64 v[86:87], v36 offset:7680
    v_mfma_f32_16x16x32_bf16 v[164:167], a[116:119], v[88:91], v[164:167]
    buffer_load_dwordx4 a[168:171], v5, s[24:27], s91 offen offset:0
    v_mfma_f32_16x16x32_bf16 v[168:171], a[112:115], v[92:95], v[168:171]
    ds_read_b64 v[88:89], v36 offset:9216
    ds_read_b64 v[90:91], v36 offset:9728
    v_mfma_f32_16x16x32_bf16 v[172:175], a[116:119], v[92:95], v[172:175]
    s_waitcnt lgkmcnt(6)
    s_waitcnt vmcnt(24)
    v_mfma_f32_16x16x32_bf16 v[96:99], a[120:123], v[72:75], v[96:99]
    ds_read_b64 v[92:93], v36 offset:11264
    ds_read_b64 v[94:95], v36 offset:11776
    s_waitcnt vmcnt(23)
    v_mfma_f32_16x16x32_bf16 v[100:103], a[124:127], v[72:75], v[100:103]
    buffer_load_dwordx4 a[172:175], v5, s[24:27], s91 offen offset:1024
    v_mfma_f32_16x16x32_bf16 v[104:107], a[120:123], v[76:79], v[104:107]
    ds_read_b64 v[72:73], v36 offset:13312
    ds_read_b64 v[74:75], v36 offset:13824
    v_mfma_f32_16x16x32_bf16 v[108:111], a[124:127], v[76:79], v[108:111]
    s_add_u32 s91, s94, 4096
    s_waitcnt lgkmcnt(6)
    v_mfma_f32_16x16x32_bf16 v[112:115], a[120:123], v[80:83], v[112:115]
    ds_read_b64 v[76:77], v36 offset:15360
    ds_read_b64 v[78:79], v36 offset:15872
    v_mfma_f32_16x16x32_bf16 v[116:119], a[124:127], v[80:83], v[116:119]
    buffer_load_dwordx4 a[176:179], v5, s[24:27], s91 offen offset:0
    v_mfma_f32_16x16x32_bf16 v[120:123], a[120:123], v[84:87], v[120:123]
    ds_read_b64 v[80:81], v36 offset:17408
    ds_read_b64 v[82:83], v36 offset:17920
    v_mfma_f32_16x16x32_bf16 v[124:127], a[124:127], v[84:87], v[124:127]
    s_waitcnt lgkmcnt(6)
    v_mfma_f32_16x16x32_bf16 v[128:131], a[120:123], v[88:91], v[128:131]
    ds_read_b64 v[84:85], v36 offset:19456
    ds_read_b64 v[86:87], v36 offset:19968
    v_mfma_f32_16x16x32_bf16 v[132:135], a[124:127], v[88:91], v[132:135]
    buffer_load_dwordx4 a[180:183], v5, s[24:27], s91 offen offset:1024
    v_mfma_f32_16x16x32_bf16 v[136:139], a[120:123], v[92:95], v[136:139]
    s_waitcnt vmcnt(21)
    s_barrier
    ds_read_b64 v[88:89], v36 offset:20480
    ds_read_b64 v[90:91], v36 offset:20992
    v_mfma_f32_16x16x32_bf16 v[140:143], a[124:127], v[92:95], v[140:143]
    s_add_u32 s91, s94, 24576
    s_waitcnt lgkmcnt(6)
    v_mfma_f32_16x16x32_bf16 v[144:147], a[120:123], v[72:75], v[144:147]
    ds_read_b64 v[92:93], v36 offset:22528
    ds_read_b64 v[94:95], v36 offset:23040
    v_mfma_f32_16x16x32_bf16 v[148:151], a[124:127], v[72:75], v[148:151]
    buffer_load_dwordx4 v[184:187], v5, s[24:27], s91 offen offset:0
    v_mfma_f32_16x16x32_bf16 v[152:155], a[120:123], v[76:79], v[152:155]
    ds_read_b64 v[72:73], v36 offset:24576
    ds_read_b64 v[74:75], v36 offset:25088
    v_mfma_f32_16x16x32_bf16 v[156:159], a[124:127], v[76:79], v[156:159]
    s_waitcnt lgkmcnt(6)
    v_mfma_f32_16x16x32_bf16 v[160:163], a[120:123], v[80:83], v[160:163]
    ds_read_b64 v[76:77], v36 offset:26624
    ds_read_b64 v[78:79], v36 offset:27136
    v_mfma_f32_16x16x32_bf16 v[164:167], a[124:127], v[80:83], v[164:167]
    buffer_load_dwordx4 v[188:191], v5, s[24:27], s91 offen offset:1024
    v_mfma_f32_16x16x32_bf16 v[168:171], a[120:123], v[84:87], v[168:171]
    ds_read_b64 v[80:81], v36 offset:28672
    ds_read_b64 v[82:83], v36 offset:29184
    v_mfma_f32_16x16x32_bf16 v[172:175], a[124:127], v[84:87], v[172:175]
    s_add_u32 s91, s94, 26624
    s_waitcnt lgkmcnt(6)
    s_waitcnt vmcnt(22)
    v_mfma_f32_16x16x32_bf16 v[96:99], a[128:131], v[88:91], v[96:99]
    ds_read_b64 v[84:85], v36 offset:30720
    ds_read_b64 v[86:87], v36 offset:31232
    s_waitcnt vmcnt(21)
    v_mfma_f32_16x16x32_bf16 v[100:103], a[132:135], v[88:91], v[100:103]
    buffer_load_dwordx4 v[192:195], v5, s[24:27], s91 offen offset:0
    v_mfma_f32_16x16x32_bf16 v[104:107], a[128:131], v[92:95], v[104:107]
    ds_read_b64 v[88:89], v36 offset:32768
    ds_read_b64 v[90:91], v36 offset:33280
    v_mfma_f32_16x16x32_bf16 v[108:111], a[132:135], v[92:95], v[108:111]
    s_waitcnt lgkmcnt(6)
    v_mfma_f32_16x16x32_bf16 v[112:115], a[128:131], v[72:75], v[112:115]
    ds_read_b64 v[92:93], v36 offset:34816
    ds_read_b64 v[94:95], v36 offset:35328
    v_mfma_f32_16x16x32_bf16 v[116:119], a[132:135], v[72:75], v[116:119]
    buffer_load_dwordx4 v[196:199], v5, s[24:27], s91 offen offset:1024
    v_mfma_f32_16x16x32_bf16 v[120:123], a[128:131], v[76:79], v[120:123]
    ds_read_b64 v[72:73], v36 offset:36864
    ds_read_b64 v[74:75], v36 offset:37376
    v_mfma_f32_16x16x32_bf16 v[124:127], a[132:135], v[76:79], v[124:127]
    s_add_u32 s91, s94, 28672
    s_waitcnt lgkmcnt(6)
    v_mfma_f32_16x16x32_bf16 v[128:131], a[128:131], v[80:83], v[128:131]
    ds_read_b64 v[76:77], v36 offset:38912
    ds_read_b64 v[78:79], v36 offset:39424
    v_mfma_f32_16x16x32_bf16 v[132:135], a[132:135], v[80:83], v[132:135]
    buffer_load_dwordx4 v[200:203], v5, s[24:27], s91 offen offset:0
    v_mfma_f32_16x16x32_bf16 v[136:139], a[128:131], v[84:87], v[136:139]
    ds_read_b64 v[80:81], v36 offset:21504
    ds_read_b64 v[82:83], v36 offset:22016
    v_mfma_f32_16x16x32_bf16 v[140:143], a[132:135], v[84:87], v[140:143]
    s_waitcnt lgkmcnt(6)
    v_mfma_f32_16x16x32_bf16 v[144:147], a[128:131], v[88:91], v[144:147]
    ds_read_b64 v[84:85], v36 offset:23552
    ds_read_b64 v[86:87], v36 offset:24064
    v_mfma_f32_16x16x32_bf16 v[148:151], a[132:135], v[88:91], v[148:151]
    buffer_load_dwordx4 v[204:207], v5, s[24:27], s91 offen offset:1024
    v_mfma_f32_16x16x32_bf16 v[152:155], a[128:131], v[92:95], v[152:155]
    ds_read_b64 v[88:89], v36 offset:25600
    ds_read_b64 v[90:91], v36 offset:26112
    v_mfma_f32_16x16x32_bf16 v[156:159], a[132:135], v[92:95], v[156:159]
    s_add_u32 s91, s94, 30720
    s_waitcnt lgkmcnt(6)
    v_mfma_f32_16x16x32_bf16 v[160:163], a[128:131], v[72:75], v[160:163]
    ds_read_b64 v[92:93], v36 offset:27648
    ds_read_b64 v[94:95], v36 offset:28160
    v_mfma_f32_16x16x32_bf16 v[164:167], a[132:135], v[72:75], v[164:167]
    buffer_load_dwordx4 v[208:211], v5, s[24:27], s91 offen offset:0
    s_waitcnt vmcnt(12)
    v_cmp_eq_u32 vcc, 0, v61
    s_nop 1
    s_cbranch_vccnz CL_sf_slow_13
CL_sf_back_14:
    s_lshl_b32 s88, s10, 10
    v_lshlrev_b32 v22, 3, v0
    buffer_load_dwordx2 v[48:49], v22, s[40:43], s88 offen sc1
    v_mfma_f32_16x16x32_bf16 v[168:171], a[128:131], v[76:79], v[168:171]
    ds_read_b64 v[72:73], v36 offset:29696
    ds_read_b64 v[74:75], v36 offset:30208
    v_mfma_f32_16x16x32_bf16 v[172:175], a[132:135], v[76:79], v[172:175]
    s_waitcnt lgkmcnt(6)
    v_mfma_f32_16x16x32_bf16 v[96:99], a[136:139], v[80:83], v[96:99]
    ds_read_b64 v[76:77], v36 offset:31744
    ds_read_b64 v[78:79], v36 offset:32256
    v_mfma_f32_16x16x32_bf16 v[100:103], a[140:143], v[80:83], v[100:103]
    buffer_load_dwordx4 v[212:215], v5, s[24:27], s91 offen offset:1024
    v_mfma_f32_16x16x32_bf16 v[104:107], a[136:139], v[84:87], v[104:107]
    ds_read_b64 v[80:81], v36 offset:33792
    ds_read_b64 v[82:83], v36 offset:34304
    v_mfma_f32_16x16x32_bf16 v[108:111], a[140:143], v[84:87], v[108:111]
    s_add_u32 s91, s94, 32768
    s_waitcnt lgkmcnt(6)
    v_mfma_f32_16x16x32_bf16 v[112:115], a[136:139], v[88:91], v[112:115]
    ds_read_b64 v[84:85], v36 offset:35840
    ds_read_b64 v[86:87], v36 offset:36352
    v_mfma_f32_16x16x32_bf16 v[116:119], a[140:143], v[88:91], v[116:119]
    buffer_load_dwordx4 v[216:219], v5, s[24:27], s91 offen offset:0
    v_mfma_f32_16x16x32_bf16 v[120:123], a[136:139], v[92:95], v[120:123]
    ds_read_b64 v[88:89], v36 offset:37888
    ds_read_b64 v[90:91], v36 offset:38400
    v_mfma_f32_16x16x32_bf16 v[124:127], a[140:143], v[92:95], v[124:127]
    s_waitcnt lgkmcnt(6)
    v_mfma_f32_16x16x32_bf16 v[128:131], a[136:139], v[72:75], v[128:131]
    ds_read_b64 v[92:93], v36 offset:39936
    ds_read_b64 v[94:95], v36 offset:40448
    v_mfma_f32_16x16x32_bf16 v[132:135], a[140:143], v[72:75], v[132:135]
    buffer_load_dwordx4 v[220:223], v5, s[24:27], s91 offen offset:1024
    v_mfma_f32_16x16x32_bf16 v[136:139], a[136:139], v[76:79], v[136:139]
    s_barrier
    ds_read_b64 v[72:73], v36 offset:40960
    ds_read_b64 v[74:75], v36 offset:41472
    v_mfma_f32_16x16x32_bf16 v[140:143], a[140:143], v[76:79], v[140:143]
    s_add_u32 s91, s94, 34816
    s_waitcnt lgkmcnt(6)
    v_mfma_f32_16x16x32_bf16 v[144:147], a[136:139], v[80:83], v[144:147]
    ds_read_b64 v[76:77], v36 offset:43008
    ds_read_b64 v[78:79], v36 offset:43520
    v_mfma_f32_16x16x32_bf16 v[148:151], a[140:143], v[80:83], v[148:151]
    buffer_load_dwordx4 v[224:227], v5, s[24:27], s91 offen offset:0
    v_mfma_f32_16x16x32_bf16 v[152:155], a[136:139], v[84:87], v[152:155]
    ds_read_b64 v[80:81], v36 offset:45056
    ds_read_b64 v[82:83], v36 offset:45568
    v_mfma_f32_16x16x32_bf16 v[156:159], a[140:143], v[84:87], v[156:159]
    s_waitcnt lgkmcnt(6)
    v_mfma_f32_16x16x32_bf16 v[160:163], a[136:139], v[88:91], v[160:163]
    ds_read_b64 v[84:85], v36 offset:47104
    ds_read_b64 v[86:87], v36 offset:47616
    v_mfma_f32_16x16x32_bf16 v[164:167], a[140:143], v[88:91], v[164:167]
    buffer_load_dwordx4 v[228:231], v5, s[24:27], s91 offen offset:1024
    v_mfma_f32_16x16x32_bf16 v[168:171], a[136:139], v[92:95], v[168:171]
    ds_read_b64 v[88:89], v36 offset:49152
    ds_read_b64 v[90:91], v36 offset:49664
    v_mfma_f32_16x16x32_bf16 v[172:175], a[140:143], v[92:95], v[172:175]
    s_add_u32 s91, s94, 36864
    s_waitcnt lgkmcnt(6)
    v_mfma_f32_16x16x32_bf16 v[96:99], a[144:147], v[72:75], v[96:99]
    ds_read_b64 v[92:93], v36 offset:51200
    ds_read_b64 v[94:95], v36 offset:51712
    v_mfma_f32_16x16x32_bf16 v[100:103], a[148:151], v[72:75], v[100:103]
    buffer_load_dwordx4 v[232:235], v5, s[24:27], s91 offen offset:0
    v_mfma_f32_16x16x32_bf16 v[104:107], a[144:147], v[76:79], v[104:107]
    ds_read_b64 v[72:73], v36 offset:53248
    ds_read_b64 v[74:75], v36 offset:53760
    v_mfma_f32_16x16x32_bf16 v[108:111], a[148:151], v[76:79], v[108:111]
    s_waitcnt lgkmcnt(6)
    v_mfma_f32_16x16x32_bf16 v[112:115], a[144:147], v[80:83], v[112:115]
    ds_read_b64 v[76:77], v36 offset:55296
    ds_read_b64 v[78:79], v36 offset:55808
    v_mfma_f32_16x16x32_bf16 v[116:119], a[148:151], v[80:83], v[116:119]
    buffer_load_dwordx4 v[236:239], v5, s[24:27], s91 offen offset:1024
    v_mfma_f32_16x16x32_bf16 v[120:123], a[144:147], v[84:87], v[120:123]
    ds_read_b64 v[80:81], v36 offset:57344
    ds_read_b64 v[82:83], v36 offset:57856
    v_mfma_f32_16x16x32_bf16 v[124:127], a[148:151], v[84:87], v[124:127]
    s_add_u32 s91, s94, 38912
    s_waitcnt lgkmcnt(6)
    v_mfma_f32_16x16x32_bf16 v[128:131], a[144:147], v[88:91], v[128:131]
    ds_read_b64 v[84:85], v36 offset:59392
    ds_read_b64 v[86:87], v36 offset:59904
    v_mfma_f32_16x16x32_bf16 v[132:135], a[148:151], v[88:91], v[132:135]
    buffer_load_dwordx4 v[240:243], v5, s[24:27], s91 offen offset:0
    v_mfma_f32_16x16x32_bf16 v[136:139], a[144:147], v[92:95], v[136:139]
    ds_read_b64 v[88:89], v36 offset:41984
    ds_read_b64 v[90:91], v36 offset:42496
    v_mfma_f32_16x16x32_bf16 v[140:143], a[148:151], v[92:95], v[140:143]
    s_waitcnt lgkmcnt(6)
    v_mfma_f32_16x16x32_bf16 v[144:147], a[144:147], v[72:75], v[144:147]
    ds_read_b64 v[92:93], v36 offset:44032
    ds_read_b64 v[94:95], v36 offset:44544
    v_mfma_f32_16x16x32_bf16 v[148:151], a[148:151], v[72:75], v[148:151]
    buffer_load_dwordx4 v[244:247], v5, s[24:27], s91 offen offset:1024
    v_mfma_f32_16x16x32_bf16 v[152:155], a[144:147], v[76:79], v[152:155]
    ds_read_b64 v[72:73], v36 offset:46080
    ds_read_b64 v[74:75], v36 offset:46592
    v_mfma_f32_16x16x32_bf16 v[156:159], a[148:151], v[76:79], v[156:159]
    s_waitcnt lgkmcnt(6)
    v_mfma_f32_16x16x32_bf16 v[160:163], a[144:147], v[80:83], v[160:163]
    ds_read_b64 v[76:77], v36 offset:48128
    ds_read_b64 v[78:79], v36 offset:48640
    v_mfma_f32_16x16x32_bf16 v[164:167], a[148:151], v[80:83], v[164:167]
    v_mfma_f32_16x16x32_bf16 v[168:171], a[144:147], v[84:87], v[168:171]
    ds_read_b64 v[80:81], v36 offset:50176
    ds_read_b64 v[82:83], v36 offset:50688
    v_mfma_f32_16x16x32_bf16 v[172:175], a[148:151], v[84:87], v[172:175]
    s_waitcnt lgkmcnt(6)
    v_mfma_f32_16x16x32_bf16 v[96:99], a[152:155], v[88:91], v[96:99]
    ds_read_b64 v[84:85], v36 offset:52224
    ds_read_b64 v[86:87], v36 offset:52736
    v_mfma_f32_16x16x32_bf16 v[100:103], a[156:159], v[88:91], v[100:103]
    v_mfma_f32_16x16x32_bf16 v[104:107], a[152:155], v[92:95], v[104:107]
    ds_read_b64 v[88:89], v36 offset:54272
    ds_read_b64 v[90:91], v36 offset:54784
    v_mfma_f32_16x16x32_bf16 v[108:111], a[156:159], v[92:95], v[108:111]
    s_waitcnt lgkmcnt(6)
    v_mfma_f32_16x16x32_bf16 v[112:115], a[152:155], v[72:75], v[112:115]
    ds_read_b64 v[92:93], v36 offset:56320
    ds_read_b64 v[94:95], v36 offset:56832
    v_mfma_f32_16x16x32_bf16 v[116:119], a[156:159], v[72:75], v[116:119]
    v_mfma_f32_16x16x32_bf16 v[120:123], a[152:155], v[76:79], v[120:123]
    ds_read_b64 v[72:73], v36 offset:58368
    ds_read_b64 v[74:75], v36 offset:58880
    v_mfma_f32_16x16x32_bf16 v[124:127], a[156:159], v[76:79], v[124:127]
    s_waitcnt lgkmcnt(6)
    v_mfma_f32_16x16x32_bf16 v[128:131], a[152:155], v[80:83], v[128:131]
    ds_read_b64 v[76:77], v36 offset:60416
    ds_read_b64 v[78:79], v36 offset:60928
    v_mfma_f32_16x16x32_bf16 v[132:135], a[156:159], v[80:83], v[132:135]
    v_mfma_f32_16x16x32_bf16 v[136:139], a[152:155], v[84:87], v[136:139]
    v_mfma_f32_16x16x32_bf16 v[140:143], a[156:159], v[84:87], v[140:143]
    s_waitcnt lgkmcnt(4)
    v_mfma_f32_16x16x32_bf16 v[144:147], a[152:155], v[88:91], v[144:147]
    v_mfma_f32_16x16x32_bf16 v[148:151], a[156:159], v[88:91], v[148:151]
    v_mfma_f32_16x16x32_bf16 v[152:155], a[152:155], v[92:95], v[152:155]
    v_mfma_f32_16x16x32_bf16 v[156:159], a[156:159], v[92:95], v[156:159]
    s_waitcnt lgkmcnt(0)
    v_mfma_f32_16x16x32_bf16 v[160:163], a[152:155], v[72:75], v[160:163]
    v_mfma_f32_16x16x32_bf16 v[164:167], a[156:159], v[72:75], v[164:167]
    v_mfma_f32_16x16x32_bf16 v[168:171], a[152:155], v[76:79], v[168:171]
    v_mfma_f32_16x16x32_bf16 v[172:175], a[156:159], v[76:79], v[172:175]
    s_mov_b32 s88, 0x3acccccd
    s_waitcnt vmcnt(9)
    v_mul_f32 v48, s88, v48
    v_mul_f32 v49, s88, v49
    v_fma_f32 v49, -v48, v48, v49
    v_max_f32 v49, 0, v49
    v_add_f32 v49, 0x3727c5ac, v49
    v_rsq_f32 v50, v49
    s_nop 0
    v_mul_f32 v51, v48, v50
    v_sub_f32 v51, 0, v51
    v_lshlrev_b32 v22, 3, v0
    v_cmp_gt_u32 vcc, 160, v0
    s_nop 0
    s_and_saveexec_b64 s[86:87], vcc
    ds_write_b64 v22, v[50:51] offset:0
    s_mov_b64 exec, s[86:87]
    s_waitcnt lgkmcnt(0)
    s_barrier
    v_mov_b32 v48, 0
    v_mov_b32 v49, 0
    v_mov_b32 v50, 0
    v_mov_b32 v51, 0
    v_mul_u32_u24 v22, 80, v0
    ds_write_b128 v22, v[48:51] offset:4144
    v_cmp_gt_u32 vcc, 64, v0
    s_nop 0
    s_and_saveexec_b64 s[86:87], vcc
    ds_write_b128 v22, v[48:51] offset:24624
    s_mov_b64 exec, s[86:87]
    v_lshlrev_b32 v22, 3, v2
    ds_read_b64 v[52:53], v22 offset:0
    ds_read_b64 v[54:55], v22 offset:128
    ds_read_b64 v[56:57], v22 offset:256
    ds_read_b64 v[58:59], v22 offset:384
    ds_read_b64 v[60:61], v22 offset:512
    ds_read_b64 v[62:63], v22 offset:640
    ds_read_b64 v[64:65], v22 offset:768
    ds_read_b64 v[66:67], v22 offset:896
    ds_read_b64 v[68:69], v22 offset:1024
    ds_read_b64 v[70:71], v22 offset:1152
    s_waitcnt lgkmcnt(9)
    v_pk_mul_f32 v[72:73], v[28:29], v[52:53] op_sel:[0,1] op_sel_hi:[1,1]
    v_pk_mul_f32 v[78:79], v[32:33], v[52:53] op_sel:[0,1] op_sel_hi:[1,1]
    s_waitcnt lgkmcnt(8)
    v_pk_mul_f32 v[84:85], v[28:29], v[54:55] op_sel:[0,1] op_sel_hi:[1,1]
    v_pk_mul_f32 v[90:91], v[32:33], v[54:55] op_sel:[0,1] op_sel_hi:[1,1]
    v_pk_mul_f32 v[74:75], v[30:31], v[52:53] op_sel:[0,1] op_sel_hi:[1,1]
    v_pk_mul_f32 v[80:81], v[34:35], v[52:53] op_sel:[0,1] op_sel_hi:[1,1]
    v_pk_mul_f32 v[86:87], v[30:31], v[54:55] op_sel:[0,1] op_sel_hi:[1,1]
    v_pk_mul_f32 v[92:93], v[34:35], v[54:55] op_sel:[0,1] op_sel_hi:[1,1]
    v_pk_fma_f32 v[72:73], v[96:97], v[52:53], v[72:73] op_sel:[0,0,0] op_sel_hi:[1,0,1]
    v_pk_fma_f32 v[78:79], v[100:101], v[52:53], v[78:79] op_sel:[0,0,0] op_sel_hi:[1,0,1]
    s_add_u32 s91, s94, 6144
    buffer_load_dwordx4 a[184:187], v5, s[24:27], s91 offen offset:0
    v_pk_fma_f32 v[84:85], v[104:105], v[54:55], v[84:85] op_sel:[0,0,0] op_sel_hi:[1,0,1]
    v_pk_fma_f32 v[90:91], v[108:109], v[54:55], v[90:91] op_sel:[0,0,0] op_sel_hi:[1,0,1]
    v_pk_fma_f32 v[74:75], v[98:99], v[52:53], v[74:75] op_sel:[0,0,0] op_sel_hi:[1,0,1]
    v_pk_fma_f32 v[80:81], v[102:103], v[52:53], v[80:81] op_sel:[0,0,0] op_sel_hi:[1,0,1]
    v_pk_fma_f32 v[86:87], v[106:107], v[54:55], v[86:87] op_sel:[0,0,0] op_sel_hi:[1,0,1]
    v_pk_fma_f32 v[92:93], v[110:111], v[54:55], v[92:93] op_sel:[0,0,0] op_sel_hi:[1,0,1]
    v_cvt_pk_bf16_f32 v76, v72, v73
    v_cvt_pk_bf16_f32 v82, v78, v79
    v_cvt_pk_bf16_f32 v88, v84, v85
    v_cvt_pk_bf16_f32 v94, v90, v91
    buffer_load_dwordx4 a[188:191], v5, s[24:27], s91 offen offset:1024
    v_cvt_pk_bf16_f32 v77, v74, v75
    v_cvt_pk_bf16_f32 v83, v80, v81
    v_cvt_pk_bf16_f32 v89, v86, v87
    v_cvt_pk_bf16_f32 v95, v92, v93
    ds_write_b64 v14, v[76:77] offset:0
    ds_write_b64 v15, v[82:83] offset:0
    ds_write_b64 v14, v[88:89] offset:1280
    ds_write_b64 v15, v[94:95] offset:1280
    s_waitcnt lgkmcnt(11)
    v_pk_mul_f32 v[72:73], v[28:29], v[56:57] op_sel:[0,1] op_sel_hi:[1,1]
    v_pk_mul_f32 v[78:79], v[32:33], v[56:57] op_sel:[0,1] op_sel_hi:[1,1]
    s_add_u32 s91, s94, 8192
    buffer_load_dwordx4 a[192:195], v5, s[24:27], s91 offen offset:0
    s_waitcnt lgkmcnt(10)
    v_pk_mul_f32 v[84:85], v[28:29], v[58:59] op_sel:[0,1] op_sel_hi:[1,1]
    v_pk_mul_f32 v[90:91], v[32:33], v[58:59] op_sel:[0,1] op_sel_hi:[1,1]
    v_pk_mul_f32 v[74:75], v[30:31], v[56:57] op_sel:[0,1] op_sel_hi:[1,1]
    v_pk_mul_f32 v[80:81], v[34:35], v[56:57] op_sel:[0,1] op_sel_hi:[1,1]
    v_pk_mul_f32 v[86:87], v[30:31], v[58:59] op_sel:[0,1] op_sel_hi:[1,1]
    v_pk_mul_f32 v[92:93], v[34:35], v[58:59] op_sel:[0,1] op_sel_hi:[1,1]
    v_pk_fma_f32 v[72:73], v[112:113], v[56:57], v[72:73] op_sel:[0,0,0] op_sel_hi:[1,0,1]
    v_pk_fma_f32 v[78:79], v[116:117], v[56:57], v[78:79] op_sel:[0,0,0] op_sel_hi:[1,0,1]
    v_pk_fma_f32 v[84:85], v[120:121], v[58:59], v[84:85] op_sel:[0,0,0] op_sel_hi:[1,0,1]
    v_pk_fma_f32 v[90:91], v[124:125], v[58:59], v[90:91] op_sel:[0,0,0] op_sel_hi:[1,0,1]
    buffer_load_dwordx4 a[196:199], v5, s[24:27], s91 offen offset:1024
    v_pk_fma_f32 v[74:75], v[114:115], v[56:57], v[74:75] op_sel:[0,0,0] op_sel_hi:[1,0,1]
    v_pk_fma_f32 v[80:81], v[118:119], v[56:57], v[80:81] op_sel:[0,0,0] op_sel_hi:[1,0,1]
    v_pk_fma_f32 v[86:87], v[122:123], v[58:59], v[86:87] op_sel:[0,0,0] op_sel_hi:[1,0,1]
    v_pk_fma_f32 v[92:93], v[126:127], v[58:59], v[92:93] op_sel:[0,0,0] op_sel_hi:[1,0,1]
    v_cvt_pk_bf16_f32 v76, v72, v73
    v_cvt_pk_bf16_f32 v82, v78, v79
    v_cvt_pk_bf16_f32 v88, v84, v85
    v_cvt_pk_bf16_f32 v94, v90, v91
    v_cvt_pk_bf16_f32 v77, v74, v75
    v_cvt_pk_bf16_f32 v83, v80, v81
    s_add_u32 s91, s94, 10240
    buffer_load_dwordx4 a[200:203], v5, s[24:27], s91 offen offset:0
    v_cvt_pk_bf16_f32 v89, v86, v87
    v_cvt_pk_bf16_f32 v95, v92, v93
    ds_write_b64 v14, v[76:77] offset:2560
    ds_write_b64 v15, v[82:83] offset:2560
    ds_write_b64 v14, v[88:89] offset:3840
    ds_write_b64 v15, v[94:95] offset:3840
    s_waitcnt lgkmcnt(13)
    v_pk_mul_f32 v[72:73], v[28:29], v[60:61] op_sel:[0,1] op_sel_hi:[1,1]
    v_pk_mul_f32 v[78:79], v[32:33], v[60:61] op_sel:[0,1] op_sel_hi:[1,1]
    s_waitcnt lgkmcnt(12)
    v_pk_mul_f32 v[84:85], v[28:29], v[62:63] op_sel:[0,1] op_sel_hi:[1,1]
    v_pk_mul_f32 v[90:91], v[32:33], v[62:63] op_sel:[0,1] op_sel_hi:[1,1]
    buffer_load_dwordx4 a[204:207], v5, s[24:27], s91 offen offset:1024
    v_pk_mul_f32 v[74:75], v[30:31], v[60:61] op_sel:[0,1] op_sel_hi:[1,1]
    v_pk_mul_f32 v[80:81], v[34:35], v[60:61] op_sel:[0,1] op_sel_hi:[1,1]
    v_pk_mul_f32 v[86:87], v[30:31], v[62:63] op_sel:[0,1] op_sel_hi:[1,1]
    v_pk_mul_f32 v[92:93], v[34:35], v[62:63] op_sel:[0,1] op_sel_hi:[1,1]
    v_pk_fma_f32 v[72:73], v[128:129], v[60:61], v[72:73] op_sel:[0,0,0] op_sel_hi:[1,0,1]
    v_pk_fma_f32 v[78:79], v[132:133], v[60:61], v[78:79] op_sel:[0,0,0] op_sel_hi:[1,0,1]
    v_pk_fma_f32 v[84:85], v[136:137], v[62:63], v[84:85] op_sel:[0,0,0] op_sel_hi:[1,0,1]
    v_pk_fma_f32 v[90:91], v[140:141], v[62:63], v[90:91] op_sel:[0,0,0] op_sel_hi:[1,0,1]
    v_pk_fma_f32 v[74:75], v[130:131], v[60:61], v[74:75] op_sel:[0,0,0] op_sel_hi:[1,0,1]
    v_pk_fma_f32 v[80:81], v[134:135], v[60:61], v[80:81] op_sel:[0,0,0] op_sel_hi:[1,0,1]
    s_add_u32 s91, s94, 12288
    buffer_load_dwordx4 a[208:211], v5, s[24:27], s91 offen offset:0
    v_pk_fma_f32 v[86:87], v[138:139], v[62:63], v[86:87] op_sel:[0,0,0] op_sel_hi:[1,0,1]
    v_pk_fma_f32 v[92:93], v[142:143], v[62:63], v[92:93] op_sel:[0,0,0] op_sel_hi:[1,0,1]
    v_cvt_pk_bf16_f32 v76, v72, v73
    v_cvt_pk_bf16_f32 v82, v78, v79
    v_cvt_pk_bf16_f32 v88, v84, v85
    v_cvt_pk_bf16_f32 v94, v90, v91
    v_cvt_pk_bf16_f32 v77, v74, v75
    v_cvt_pk_bf16_f32 v83, v80, v81
    v_cvt_pk_bf16_f32 v89, v86, v87
    v_cvt_pk_bf16_f32 v95, v92, v93
    buffer_load_dwordx4 a[212:215], v5, s[24:27], s91 offen offset:1024
    ds_write_b64 v14, v[76:77] offset:5120
    ds_write_b64 v15, v[82:83] offset:5120
    ds_write_b64 v14, v[88:89] offset:6400
    ds_write_b64 v15, v[94:95] offset:6400
    s_waitcnt lgkmcnt(15)
    v_pk_mul_f32 v[72:73], v[28:29], v[64:65] op_sel:[0,1] op_sel_hi:[1,1]
    v_pk_mul_f32 v[78:79], v[32:33], v[64:65] op_sel:[0,1] op_sel_hi:[1,1]
    s_waitcnt lgkmcnt(14)
    v_pk_mul_f32 v[84:85], v[28:29], v[66:67] op_sel:[0,1] op_sel_hi:[1,1]
    v_pk_mul_f32 v[90:91], v[32:33], v[66:67] op_sel:[0,1] op_sel_hi:[1,1]
    v_pk_mul_f32 v[74:75], v[30:31], v[64:65] op_sel:[0,1] op_sel_hi:[1,1]
    v_pk_mul_f32 v[80:81], v[34:35], v[64:65] op_sel:[0,1] op_sel_hi:[1,1]
    s_add_u32 s91, s94, 14336
    buffer_load_dwordx4 a[216:219], v5, s[24:27], s91 offen offset:0
    v_pk_mul_f32 v[86:87], v[30:31], v[66:67] op_sel:[0,1] op_sel_hi:[1,1]
    v_pk_mul_f32 v[92:93], v[34:35], v[66:67] op_sel:[0,1] op_sel_hi:[1,1]
    v_pk_fma_f32 v[72:73], v[144:145], v[64:65], v[72:73] op_sel:[0,0,0] op_sel_hi:[1,0,1]
    v_pk_fma_f32 v[78:79], v[148:149], v[64:65], v[78:79] op_sel:[0,0,0] op_sel_hi:[1,0,1]
    v_pk_fma_f32 v[84:85], v[152:153], v[66:67], v[84:85] op_sel:[0,0,0] op_sel_hi:[1,0,1]
    v_pk_fma_f32 v[90:91], v[156:157], v[66:67], v[90:91] op_sel:[0,0,0] op_sel_hi:[1,0,1]
    v_pk_fma_f32 v[74:75], v[146:147], v[64:65], v[74:75] op_sel:[0,0,0] op_sel_hi:[1,0,1]
    v_pk_fma_f32 v[80:81], v[150:151], v[64:65], v[80:81] op_sel:[0,0,0] op_sel_hi:[1,0,1]
    v_pk_fma_f32 v[86:87], v[154:155], v[66:67], v[86:87] op_sel:[0,0,0] op_sel_hi:[1,0,1]
    v_pk_fma_f32 v[92:93], v[158:159], v[66:67], v[92:93] op_sel:[0,0,0] op_sel_hi:[1,0,1]
    buffer_load_dwordx4 a[220:223], v5, s[24:27], s91 offen offset:1024
    v_cvt_pk_bf16_f32 v76, v72, v73
    v_cvt_pk_bf16_f32 v82, v78, v79
    v_cvt_pk_bf16_f32 v88, v84, v85
    v_cvt_pk_bf16_f32 v94, v90, v91
    v_cvt_pk_bf16_f32 v77, v74, v75
    v_cvt_pk_bf16_f32 v83, v80, v81
    v_cvt_pk_bf16_f32 v89, v86, v87
    v_cvt_pk_bf16_f32 v95, v92, v93
    ds_write_b64 v14, v[76:77] offset:7680
    ds_write_b64 v15, v[82:83] offset:7680
    s_add_u32 s91, s94, 16384
    buffer_load_dwordx4 a[224:227], v5, s[24:27], s91 offen offset:0
    ds_write_b64 v14, v[88:89] offset:8960
    ds_write_b64 v15, v[94:95] offset:8960
    s_waitcnt lgkmcnt(15)
    v_pk_mul_f32 v[72:73], v[28:29], v[68:69] op_sel:[0,1] op_sel_hi:[1,1]
    v_pk_mul_f32 v[78:79], v[32:33], v[68:69] op_sel:[0,1] op_sel_hi:[1,1]
    v_pk_mul_f32 v[84:85], v[28:29], v[70:71] op_sel:[0,1] op_sel_hi:[1,1]
    v_pk_mul_f32 v[90:91], v[32:33], v[70:71] op_sel:[0,1] op_sel_hi:[1,1]
    v_pk_mul_f32 v[74:75], v[30:31], v[68:69] op_sel:[0,1] op_sel_hi:[1,1]
    v_pk_mul_f32 v[80:81], v[34:35], v[68:69] op_sel:[0,1] op_sel_hi:[1,1]
    v_pk_mul_f32 v[86:87], v[30:31], v[70:71] op_sel:[0,1] op_sel_hi:[1,1]
    v_pk_mul_f32 v[92:93], v[34:35], v[70:71] op_sel:[0,1] op_sel_hi:[1,1]
    buffer_load_dwordx4 a[228:231], v5, s[24:27], s91 offen offset:1024
    v_pk_fma_f32 v[72:73], v[160:161], v[68:69], v[72:73] op_sel:[0,0,0] op_sel_hi:[1,0,1]
    v_pk_fma_f32 v[78:79], v[164:165], v[68:69], v[78:79] op_sel:[0,0,0] op_sel_hi:[1,0,1]
    v_pk_fma_f32 v[84:85], v[168:169], v[70:71], v[84:85] op_sel:[0,0,0] op_sel_hi:[1,0,1]
    v_pk_fma_f32 v[90:91], v[172:173], v[70:71], v[90:91] op_sel:[0,0,0] op_sel_hi:[1,0,1]
    v_pk_fma_f32 v[74:75], v[162:163], v[68:69], v[74:75] op_sel:[0,0,0] op_sel_hi:[1,0,1]
    v_pk_fma_f32 v[80:81], v[166:167], v[68:69], v[80:81] op_sel:[0,0,0] op_sel_hi:[1,0,1]
    v_pk_fma_f32 v[86:87], v[170:171], v[70:71], v[86:87] op_sel:[0,0,0] op_sel_hi:[1,0,1]
    v_pk_fma_f32 v[92:93], v[174:175], v[70:71], v[92:93] op_sel:[0,0,0] op_sel_hi:[1,0,1]
    v_cvt_pk_bf16_f32 v76, v72, v73
    v_cvt_pk_bf16_f32 v82, v78, v79
    s_add_u32 s91, s94, 18432
    buffer_load_dwordx4 a[232:235], v5, s[24:27], s91 offen offset:0
    v_cvt_pk_bf16_f32 v88, v84, v85
    v_cvt_pk_bf16_f32 v94, v90, v91
    v_cvt_pk_bf16_f32 v77, v74, v75
    v_cvt_pk_bf16_f32 v83, v80, v81
    v_cvt_pk_bf16_f32 v89, v86, v87
    v_cvt_pk_bf16_f32 v95, v92, v93
    ds_write_b64 v14, v[76:77] offset:10240
    ds_write_b64 v15, v[82:83] offset:10240
    ds_write_b64 v14, v[88:89] offset:11520
    ds_write_b64 v15, v[94:95] offset:11520
    buffer_load_dwordx4 a[236:239], v5, s[24:27], s91 offen offset:1024
    s_waitcnt lgkmcnt(0)
    s_barrier
    ds_read_b128 v[96:99], v16 offset:0
    ds_read_b128 v[100:103], v17 offset:0
    ds_read_b128 v[104:107], v16 offset:80
    ds_read_b128 v[108:111], v18 offset:0
    ds_read_b128 v[118:121], v16 offset:2560
    ds_read_b128 v[122:125], v17 offset:2560
    ds_read_b128 v[126:129], v16 offset:2640
    ds_read_b128 v[130:133], v18 offset:2560
    ds_read_b128 v[140:143], v16 offset:5120
    ds_read_b128 v[144:147], v17 offset:5120
    s_add_u32 s91, s94, 20480
    buffer_load_dwordx4 a[240:243], v5, s[24:27], s91 offen offset:0
    ds_read_b128 v[148:151], v16 offset:5200
    ds_read_b128 v[152:155], v18 offset:5120
    ds_read_b128 v[162:165], v16 offset:7680
    ds_read_b128 v[166:169], v17 offset:7680
    ds_read_b128 v[170:173], v16 offset:7760
    ds_read_b128 v[174:177], v18 offset:7680
    ds_read_b128 v[72:75], v16 offset:10240
    ds_read_b128 v[76:79], v17 offset:10240
    ds_read_b128 v[80:83], v16 offset:10320
    ds_read_b128 v[84:87], v18 offset:10240
    buffer_load_dwordx4 a[244:247], v5, s[24:27], s91 offen offset:1024
    s_add_u32 s88, s98, s99
    v_lshlrev_b32 v22, 3, v1
    s_add_u32 s90, s88, 0
    buffer_load_dwordx2 v[48:49], v22, s[44:47], s90 offen
    buffer_load_dwordx2 v[50:51], v22, s[44:47], s90 offen offset:512
    buffer_load_dwordx2 v[60:61], v22, s[48:51], s90 offen
    buffer_load_dwordx2 v[62:63], v22, s[48:51], s90 offen offset:512
    s_add_u32 s90, s88, 20480
    buffer_load_dwordx2 v[52:53], v22, s[44:47], s90 offen
    buffer_load_dwordx2 v[54:55], v22, s[44:47], s90 offen offset:512
    buffer_load_dwordx2 v[64:65], v22, s[48:51], s90 offen
    buffer_load_dwordx2 v[66:67], v22, s[48:51], s90 offen offset:512
    s_add_u32 s90, s88, 40960
    buffer_load_dwordx2 v[56:57], v22, s[44:47], s90 offen
    buffer_load_dwordx2 v[58:59], v22, s[44:47], s90 offen offset:512
    buffer_load_dwordx2 v[68:69], v22, s[48:51], s90 offen
    buffer_load_dwordx2 v[70:71], v22, s[48:51], s90 offen offset:512
    s_mov_b32 s90, 0x3ea52b5c
    s_lshl_b32 s15, s10, 3
    s_lshr_b32 s88, s3, 1
    s_add_u32 s15, s15, s88
    s_add_u32 s15, s15, 1
    s_lshl_b32 s89, s8, 8
    s_add_u32 s85, s89, s15
    s_mul_i32 s15, s15, 20480
    v_cmp_gt_u32 vcc, 8, v2
    s_nop 1
    v_cndmask_b32 v22, 0, -1, vcc
    v_not_b32 v23, v22
    s_waitcnt lgkmcnt(15)
    v_mfma_f32_16x16x32_bf16 v[112:115], v[96:99], v[100:103], 0
    s_waitcnt lgkmcnt(14)
    v_mfma_f32_16x16x32_bf16 v[134:137], v[118:121], v[122:125], 0
    s_waitcnt lgkmcnt(10)
    v_mfma_f32_16x16x32_bf16 v[156:159], v[140:143], v[144:147], 0
    s_waitcnt lgkmcnt(6)
    v_mfma_f32_16x16x32_bf16 v[178:181], v[162:165], v[166:169], 0
    s_waitcnt lgkmcnt(2)
    v_mfma_f32_16x16x32_bf16 v[88:91], v[72:75], v[76:79], 0
    v_mfma_f32_16x16x32_bf16 v[112:115], v[104:107], v[108:111], v[112:115]
    s_add_u32 s91, s94, 22528
    buffer_load_dwordx4 a[248:251], v5, s[24:27], s91 offen offset:0
    v_mfma_f32_16x16x32_bf16 v[134:137], v[126:129], v[130:133], v[134:137]
    v_mfma_f32_16x16x32_bf16 v[156:159], v[148:151], v[152:155], v[156:159]
    v_mfma_f32_16x16x32_bf16 v[178:181], v[170:173], v[174:177], v[178:181]
    s_waitcnt lgkmcnt(0)
    v_mfma_f32_16x16x32_bf16 v[88:91], v[80:83], v[84:87], v[88:91]
    ds_read_b64_tr_b16 v[96:97], v19 offset:0
    ds_read_b64_tr_b16 v[98:99], v19 offset:80
    ds_read_b64_tr_b16 v[100:101], v19 offset:32
    ds_read_b64_tr_b16 v[102:103], v19 offset:112
    ds_read_b64_tr_b16 v[118:119], v19 offset:2560
    ds_read_b64_tr_b16 v[120:121], v19 offset:2640
    buffer_load_dwordx4 a[252:255], v5, s[24:27], s91 offen offset:1024
    ds_read_b64_tr_b16 v[122:123], v19 offset:2592
    ds_read_b64_tr_b16 v[124:125], v19 offset:2672
    ds_read_b64_tr_b16 v[140:141], v19 offset:5120
    ds_read_b64_tr_b16 v[142:143], v19 offset:5200
    ds_read_b64_tr_b16 v[144:145], v19 offset:5152
    ds_read_b64_tr_b16 v[146:147], v19 offset:5232
    ds_read_b64_tr_b16 v[162:163], v19 offset:7680
    ds_read_b64_tr_b16 v[164:165], v19 offset:7760
    ds_read_b64_tr_b16 v[166:167], v19 offset:7712
    ds_read_b64_tr_b16 v[168:169], v19 offset:7792
    ds_read_b64_tr_b16 v[72:73], v19 offset:10240
    ds_read_b64_tr_b16 v[74:75], v19 offset:10320
    ds_read_b64_tr_b16 v[76:77], v19 offset:10272
    ds_read_b64_tr_b16 v[78:79], v19 offset:10352
    s_mov_b32 s62, s90
    s_mov_b32 s63, s90
    v_pk_fma_f32 v[112:113], v[112:113], s[62:63], v[24:25]
    v_pk_fma_f32 v[134:135], v[134:135], s[62:63], v[24:25]
    v_pk_fma_f32 v[156:157], v[156:157], s[62:63], v[24:25]
    v_pk_fma_f32 v[178:179], v[178:179], s[62:63], v[24:25]
    v_pk_fma_f32 v[88:89], v[88:89], s[62:63], v[24:25]
    v_pk_fma_f32 v[114:115], v[114:115], s[62:63], v[26:27]
    v_pk_fma_f32 v[136:137], v[136:137], s[62:63], v[26:27]
    v_pk_fma_f32 v[158:159], v[158:159], s[62:63], v[26:27]
    v_pk_fma_f32 v[180:181], v[180:181], s[62:63], v[26:27]
    v_pk_fma_f32 v[90:91], v[90:91], s[62:63], v[26:27]
    s_cmp_lg_u32 s85, 2
    s_cbranch_scc1 CL_start_15
    v_cmp_gt_u32 vcc, 2, v3
    v_mov_b32 v116, 0xf149f2ca
    s_nop 0
    v_cndmask_b32 v112, v112, v116, vcc
    v_cndmask_b32 v113, v113, v116, vcc
    v_cndmask_b32 v114, v114, v116, vcc
    v_cndmask_b32 v115, v115, v116, vcc
CL_start_15:
    v_max3_f32 v116, v112, v113, v114
    v_max3_f32 v138, v134, v135, v136
    v_max3_f32 v160, v156, v157, v158
    v_max3_f32 v182, v178, v179, v180
    v_max3_f32 v92, v88, v89, v90
    v_max_f32 v116, v116, v115
    v_max_f32 v138, v138, v137
    v_max_f32 v160, v160, v159
    v_max_f32 v182, v182, v181
    v_max_f32 v92, v92, v91
    v_mov_b32 v117, v116
    v_mov_b32 v139, v138
    v_mov_b32 v161, v160
    v_mov_b32 v183, v182
    v_mov_b32 v93, v92
    v_permlane32_swap_b32 v116, v117
    v_permlane32_swap_b32 v138, v139
    v_permlane32_swap_b32 v160, v161
    v_permlane32_swap_b32 v182, v183
    v_permlane32_swap_b32 v92, v93
    v_max_f32 v116, v116, v117
    v_max_f32 v138, v138, v139
    v_max_f32 v160, v160, v161
    v_max_f32 v182, v182, v183
    v_max_f32 v92, v92, v93
    v_mov_b32 v117, v116
    v_mov_b32 v139, v138
    v_mov_b32 v161, v160
    v_mov_b32 v183, v182
    v_mov_b32 v93, v92
    v_permlane16_swap_b32 v116, v117
    v_permlane16_swap_b32 v138, v139
    v_permlane16_swap_b32 v160, v161
    v_permlane16_swap_b32 v182, v183
    v_permlane16_swap_b32 v92, v93
    v_max_f32 v116, v116, v117
    v_max_f32 v138, v138, v139
    v_max_f32 v160, v160, v161
    v_max_f32 v182, v182, v183
    v_max_f32 v92, v92, v93
    v_pk_add_f32 v[112:113], v[112:113], v[116:117] op_sel_hi:[1,0] neg_lo:[0,1] neg_hi:[0,1]
    v_pk_add_f32 v[134:135], v[134:135], v[138:139] op_sel_hi:[1,0] neg_lo:[0,1] neg_hi:[0,1]
    v_pk_add_f32 v[156:157], v[156:157], v[160:161] op_sel_hi:[1,0] neg_lo:[0,1] neg_hi:[0,1]
    v_pk_add_f32 v[178:179], v[178:179], v[182:183] op_sel_hi:[1,0] neg_lo:[0,1] neg_hi:[0,1]
    v_pk_add_f32 v[88:89], v[88:89], v[92:93] op_sel_hi:[1,0] neg_lo:[0,1] neg_hi:[0,1]
    v_pk_add_f32 v[114:115], v[114:115], v[116:117] op_sel_hi:[1,0] neg_lo:[0,1] neg_hi:[0,1]
    v_pk_add_f32 v[136:137], v[136:137], v[138:139] op_sel_hi:[1,0] neg_lo:[0,1] neg_hi:[0,1]
    v_pk_add_f32 v[158:159], v[158:159], v[160:161] op_sel_hi:[1,0] neg_lo:[0,1] neg_hi:[0,1]
    v_pk_add_f32 v[180:181], v[180:181], v[182:183] op_sel_hi:[1,0] neg_lo:[0,1] neg_hi:[0,1]
    v_pk_add_f32 v[90:91], v[90:91], v[92:93] op_sel_hi:[1,0] neg_lo:[0,1] neg_hi:[0,1]
    v_exp_f32 v112, v112
    v_exp_f32 v134, v134
    v_exp_f32 v156, v156
    v_exp_f32 v178, v178
    v_exp_f32 v88, v88
    v_exp_f32 v113, v113
    v_exp_f32 v135, v135
    v_exp_f32 v157, v157
    v_exp_f32 v179, v179
    v_exp_f32 v89, v89
    v_exp_f32 v114, v114
    v_exp_f32 v136, v136
    v_exp_f32 v158, v158
    v_exp_f32 v180, v180
    v_exp_f32 v90, v90
    v_exp_f32 v115, v115
    v_exp_f32 v137, v137
    v_exp_f32 v159, v159
    v_exp_f32 v181, v181
    v_exp_f32 v91, v91
    v_cvt_pk_bf16_f32 v116, v112, v113
    v_cvt_pk_bf16_f32 v138, v134, v135
    v_cvt_pk_bf16_f32 v160, v156, v157
    v_cvt_pk_bf16_f32 v182, v178, v179
    v_cvt_pk_bf16_f32 v92, v88, v89
    v_cvt_pk_bf16_f32 v117, v114, v115
    v_cvt_pk_bf16_f32 v139, v136, v137
    v_cvt_pk_bf16_f32 v161, v158, v159
    v_cvt_pk_bf16_f32 v183, v180, v181
    v_cvt_pk_bf16_f32 v93, v90, v91
    v_and_b32 v104, v116, v22
    v_and_b32 v126, v138, v22
    v_and_b32 v148, v160, v22
    v_and_b32 v170, v182, v22
    v_and_b32 v80, v92, v22
    v_and_b32 v105, v117, v22
    v_and_b32 v127, v139, v22
    v_and_b32 v149, v161, v22
    v_and_b32 v171, v183, v22
    v_and_b32 v81, v93, v22
    v_and_b32 v106, v116, v23
    v_and_b32 v128, v138, v23
    v_and_b32 v150, v160, v23
    v_and_b32 v172, v182, v23
    v_and_b32 v82, v92, v23
    v_and_b32 v107, v117, v23
    v_and_b32 v129, v139, v23
    v_and_b32 v151, v161, v23
    v_and_b32 v173, v183, v23
    v_and_b32 v83, v93, v23
    s_mov_b32 s88, 0x3f803f80
    v_mov_b32 v248, s88
    v_mov_b32 v249, s88
    v_mov_b32 v250, s88
    v_mov_b32 v251, s88
    s_nop 1
    v_mfma_f32_16x16x32_bf16 v[112:115], v[248:251], v[104:107], 0
    s_waitcnt lgkmcnt(15)
    v_mfma_f32_16x16x32_bf16 v[108:111], v[96:99], v[104:107], 0
    v_mfma_f32_16x16x32_bf16 v[134:137], v[248:251], v[126:129], 0
    s_waitcnt lgkmcnt(14)
    v_mfma_f32_16x16x32_bf16 v[130:133], v[118:121], v[126:129], 0
    v_mfma_f32_16x16x32_bf16 v[156:159], v[248:251], v[148:151], 0
    s_waitcnt lgkmcnt(10)
    v_mfma_f32_16x16x32_bf16 v[152:155], v[140:143], v[148:151], 0
    v_mfma_f32_16x16x32_bf16 v[178:181], v[248:251], v[170:173], 0
    s_waitcnt lgkmcnt(6)
    v_mfma_f32_16x16x32_bf16 v[174:177], v[162:165], v[170:173], 0
    v_mfma_f32_16x16x32_bf16 v[88:91], v[248:251], v[80:83], 0
    s_waitcnt lgkmcnt(2)
    v_mfma_f32_16x16x32_bf16 v[84:87], v[72:75], v[80:83], 0
    v_mfma_f32_16x16x32_bf16 v[96:99], v[100:103], v[104:107], 0
    v_mfma_f32_16x16x32_bf16 v[118:121], v[122:125], v[126:129], 0
    v_mfma_f32_16x16x32_bf16 v[140:143], v[144:147], v[148:151], 0
    v_mfma_f32_16x16x32_bf16 v[162:165], v[166:169], v[170:173], 0
    s_waitcnt lgkmcnt(0)
    v_mfma_f32_16x16x32_bf16 v[72:75], v[76:79], v[80:83], 0
    v_rcp_f32 v116, v112
    v_rcp_f32 v138, v134
    v_rcp_f32 v160, v156
    v_rcp_f32 v182, v178
    v_rcp_f32 v92, v88
    v_pk_mul_f32 v[108:109], v[108:109], v[116:117] op_sel_hi:[1,0]
    v_pk_mul_f32 v[130:131], v[130:131], v[138:139] op_sel_hi:[1,0]
    v_pk_mul_f32 v[152:153], v[152:153], v[160:161] op_sel_hi:[1,0]
    v_pk_mul_f32 v[174:175], v[174:175], v[182:183] op_sel_hi:[1,0]
    v_pk_mul_f32 v[84:85], v[84:85], v[92:93] op_sel_hi:[1,0]
    v_pk_mul_f32 v[110:111], v[110:111], v[116:117] op_sel_hi:[1,0]
    v_pk_mul_f32 v[132:133], v[132:133], v[138:139] op_sel_hi:[1,0]
    v_pk_mul_f32 v[154:155], v[154:155], v[160:161] op_sel_hi:[1,0]
    v_pk_mul_f32 v[176:177], v[176:177], v[182:183] op_sel_hi:[1,0]
    v_pk_mul_f32 v[86:87], v[86:87], v[92:93] op_sel_hi:[1,0]
    v_pk_mul_f32 v[96:97], v[96:97], v[116:117] op_sel_hi:[1,0]
    v_pk_mul_f32 v[118:119], v[118:119], v[138:139] op_sel_hi:[1,0]
    v_pk_mul_f32 v[140:141], v[140:141], v[160:161] op_sel_hi:[1,0]
    v_pk_mul_f32 v[162:163], v[162:163], v[182:183] op_sel_hi:[1,0]
    v_pk_mul_f32 v[72:73], v[72:73], v[92:93] op_sel_hi:[1,0]
    v_pk_mul_f32 v[98:99], v[98:99], v[116:117] op_sel_hi:[1,0]
    v_pk_mul_f32 v[120:121], v[120:121], v[138:139] op_sel_hi:[1,0]
    v_pk_mul_f32 v[142:143], v[142:143], v[160:161] op_sel_hi:[1,0]
    v_pk_mul_f32 v[164:165], v[164:165], v[182:183] op_sel_hi:[1,0]
    v_pk_mul_f32 v[74:75], v[74:75], v[92:93] op_sel_hi:[1,0]
    v_cvt_pk_bf16_f32 v104, v108, v109
    v_cvt_pk_bf16_f32 v105, v110, v111
    v_cvt_pk_bf16_f32 v126, v130, v131
    v_cvt_pk_bf16_f32 v127, v132, v133
    v_cvt_pk_bf16_f32 v148, v152, v153
    v_cvt_pk_bf16_f32 v149, v154, v155
    v_cvt_pk_bf16_f32 v170, v174, v175
    v_cvt_pk_bf16_f32 v171, v176, v177
    v_cvt_pk_bf16_f32 v80, v84, v85
    v_cvt_pk_bf16_f32 v81, v86, v87
    v_cvt_pk_bf16_f32 v106, v96, v97
    v_cvt_pk_bf16_f32 v107, v98, v99
    v_cvt_pk_bf16_f32 v128, v118, v119
    v_cvt_pk_bf16_f32 v129, v120, v121
    v_cvt_pk_bf16_f32 v150, v140, v141
    v_cvt_pk_bf16_f32 v151, v142, v143
    v_cvt_pk_bf16_f32 v172, v162, v163
    v_cvt_pk_bf16_f32 v173, v164, v165
    v_cvt_pk_bf16_f32 v82, v72, v73
    v_cvt_pk_bf16_f32 v83, v74, v75
    s_add_u32 s88, s15, 0
    buffer_store_dwordx2 v[104:105], v20, s[28:31], s88 offen
    buffer_store_dwordx2 v[106:107], v21, s[28:31], s88 offen
    s_add_u32 s89, s15, 40960
    buffer_store_dwordx2 v[126:127], v20, s[28:31], s89 offen
    buffer_store_dwordx2 v[128:129], v21, s[28:31], s89 offen
    s_add_u32 s88, s15, 81920
    buffer_store_dwordx2 v[148:149], v20, s[28:31], s88 offen
    buffer_store_dwordx2 v[150:151], v21, s[28:31], s88 offen
    s_add_u32 s89, s15, 122880
    buffer_store_dwordx2 v[170:171], v20, s[28:31], s89 offen
    buffer_store_dwordx2 v[172:173], v21, s[28:31], s89 offen
    s_add_u32 s88, s15, 163840
    s_cmp_ge_u32 s3, 2
    s_cselect_b32 s88, 0x40000000, s88
    buffer_store_dwordx2 v[80:81], v20, s[28:31], s88 offen
    buffer_store_dwordx2 v[82:83], v21, s[28:31], s88 offen
    s_waitcnt vmcnt(0) lgkmcnt(0)
    s_barrier
    s_cmp_lg_u32 s3, 0
    s_cbranch_scc1 CL_xb_skip_16
    v_mov_b32 v22, 1
    s_lshl_b32 s88, s9, 2
    v_mov_b32 v23, 0
    v_cmp_eq_u32 vcc, 0, v1
    s_nop 0
    s_and_saveexec_b64 s[86:87], vcc
    buffer_store_dword v22, v23, s[52:55], s88 offen offset:128
    s_mov_b64 exec, s[86:87]
CL_xb_skip_16:
    v_lshlrev_b32 v160, 16, v48
    v_and_b32 v161, 0xffff0000, v48
    v_lshlrev_b32 v162, 16, v49
    v_and_b32 v163, 0xffff0000, v49
    v_lshlrev_b32 v164, 16, v50
    v_and_b32 v165, 0xffff0000, v50
    v_lshlrev_b32 v166, 16, v51
    v_and_b32 v167, 0xffff0000, v51
    v_lshlrev_b32 v168, 16, v52
    v_and_b32 v169, 0xffff0000, v52
    v_lshlrev_b32 v170, 16, v53
    v_and_b32 v171, 0xffff0000, v53
    v_lshlrev_b32 v172, 16, v54
    v_and_b32 v173, 0xffff0000, v54
    v_lshlrev_b32 v174, 16, v55
    v_and_b32 v175, 0xffff0000, v55
    v_lshlrev_b32 v176, 16, v56
    v_and_b32 v177, 0xffff0000, v56
    v_lshlrev_b32 v178, 16, v57
    v_and_b32 v179, 0xffff0000, v57
    v_lshlrev_b32 v180, 16, v58
    v_and_b32 v181, 0xffff0000, v58
    v_lshlrev_b32 v182, 16, v59
    v_and_b32 v183, 0xffff0000, v59
    s_mov_b32 s88, 0x3f803f80
    v_mov_b32 v248, s88
    v_mov_b32 v249, s88
    v_mov_b32 v250, s88
    v_mov_b32 v251, s88
    v_and_b32 v252, 3, v2
    v_cmp_eq_u32 s[56:57], 1, v252
    v_cmp_eq_u32 s[58:59], 2, v252
    v_cmp_eq_u32 s[60:61], 3, v252
    v_lshrrev_b32 v252, 2, v2
    v_cmp_eq_u32 vcc, v252, v3
    s_mul_i32 s88, s3, 384
    v_lshlrev_b32 v252, 3, v2
    v_add_u32 v252, s88, v252
    v_mov_b32 v255, 1536
    v_cndmask_b32 v255, v255, v252, vcc
    s_cmp_lg_u32 s3, 0
    s_cbranch_scc1 CL_xb_skip_17
    v_and_b32 v23, 31, v1
    v_lshlrev_b32 v23, 2, v23
    s_mov_b32 s89, 1048576
CL_xb_loop_18:
    buffer_load_dword v22, v23, s[52:55], 0 offen offset:128 sc1
    s_waitcnt vmcnt(0)
    v_cmp_eq_u32 vcc, 0, v22
    s_cbranch_vccz CL_xb_done_19
    s_sub_u32 s89, s89, 1
    s_cmp_eq_u32 s89, 0
    s_cbranch_scc1 L_k2_end
    s_branch CL_xb_loop_18
CL_xb_done_19:
CL_xb_skip_17:
    s_barrier
    s_add_u32 s14, s98, s92
    s_mul_i32 s15, s3, 3072
    v_add_u32 v96, 20480, v5
    v_add_u32 v97, 40960, v5
    s_add_u32 s90, s14, 0
    s_add_u32 m0, s15, 4096
    s_nop 0
    buffer_load_dwordx4 v5, s[28:31], s90 offen sc1 lds
    s_add_u32 m0, s15, 5120
    s_nop 0
    buffer_load_dwordx4 v96, s[28:31], s90 offen sc1 lds
    s_add_u32 m0, s15, 6144
    s_nop 0
    buffer_load_dwordx4 v97, s[28:31], s90 offen sc1 lds
    s_add_u32 s90, s14, 4096
    s_add_u32 m0, s15, 16384
    s_nop 0
    buffer_load_dwordx4 v5, s[28:31], s90 offen sc1 lds
    s_add_u32 m0, s15, 17408
    s_nop 0
    buffer_load_dwordx4 v96, s[28:31], s90 offen sc1 lds
    s_add_u32 m0, s15, 18432
    s_nop 0
    buffer_load_dwordx4 v97, s[28:31], s90 offen sc1 lds
    s_add_u32 s90, s14, 8192
    s_add_u32 m0, s15, 28672
    s_nop 0
    buffer_load_dwordx4 v5, s[28:31], s90 offen sc1 lds
    s_add_u32 m0, s15, 29696
    s_nop 0
    buffer_load_dwordx4 v96, s[28:31], s90 offen sc1 lds
    s_add_u32 m0, s15, 30720
    s_nop 0
    buffer_load_dwordx4 v97, s[28:31], s90 offen sc1 lds
    s_waitcnt vmcnt(6)
    s_barrier
    ds_read_b128 v[72:75], v5 offset:4096
    ds_read_b128 v[76:79], v5 offset:5120
    ds_read_b128 v[80:83], v5 offset:6144
    ds_read_b128 v[84:87], v5 offset:7168
    s_add_u32 s90, s14, 12288
    s_add_u32 m0, s15, 40960
    s_waitcnt lgkmcnt(3)
    v_mfma_f32_16x16x32_bf16 v[160:163], a[160:163], v[72:75], v[160:163]
    ds_read_b128 v[88:91], v5 offset:8192
    v_mfma_f32_16x16x32_bf16 v[164:167], a[164:167], v[72:75], v[164:167]
    buffer_load_dwordx4 v5, s[28:31], s90 offen sc1 lds
    s_waitcnt lgkmcnt(3)
    v_mfma_f32_16x16x32_bf16 v[168:171], a[160:163], v[76:79], v[168:171]
    ds_read_b128 v[92:95], v5 offset:9216
    v_mfma_f32_16x16x32_bf16 v[172:175], a[164:167], v[76:79], v[172:175]
    s_add_u32 m0, s15, 41984
    s_waitcnt lgkmcnt(3)
    v_mfma_f32_16x16x32_bf16 v[176:179], a[160:163], v[80:83], v[176:179]
    ds_read_b128 v[72:75], v5 offset:10240
    v_mfma_f32_16x16x32_bf16 v[180:183], a[164:167], v[80:83], v[180:183]
    buffer_load_dwordx4 v96, s[28:31], s90 offen sc1 lds
    s_waitcnt lgkmcnt(3)
    v_mfma_f32_16x16x32_bf16 v[160:163], a[168:171], v[84:87], v[160:163]
    ds_read_b128 v[76:79], v5 offset:11264
    v_mfma_f32_16x16x32_bf16 v[164:167], a[172:175], v[84:87], v[164:167]
    s_add_u32 m0, s15, 43008
    s_waitcnt lgkmcnt(3)
    v_mfma_f32_16x16x32_bf16 v[168:171], a[168:171], v[88:91], v[168:171]
    ds_read_b128 v[80:83], v5 offset:12288
    v_mfma_f32_16x16x32_bf16 v[172:175], a[172:175], v[88:91], v[172:175]
    buffer_load_dwordx4 v97, s[28:31], s90 offen sc1 lds
    s_waitcnt lgkmcnt(3)
    v_mfma_f32_16x16x32_bf16 v[176:179], a[168:171], v[92:95], v[176:179]
    ds_read_b128 v[84:87], v5 offset:13312
    v_mfma_f32_16x16x32_bf16 v[180:183], a[172:175], v[92:95], v[180:183]
    s_add_u32 s90, s14, 16384
    s_add_u32 m0, s15, 53248
    s_waitcnt lgkmcnt(3)
    v_mfma_f32_16x16x32_bf16 v[160:163], a[176:179], v[72:75], v[160:163]
    ds_read_b128 v[88:91], v5 offset:14336
    v_mfma_f32_16x16x32_bf16 v[164:167], a[180:183], v[72:75], v[164:167]
    buffer_load_dwordx4 v5, s[28:31], s90 offen sc1 lds
    s_waitcnt lgkmcnt(3)
    v_mfma_f32_16x16x32_bf16 v[168:171], a[176:179], v[76:79], v[168:171]
    ds_read_b128 v[92:95], v5 offset:15360
    v_mfma_f32_16x16x32_bf16 v[172:175], a[180:183], v[76:79], v[172:175]
    s_add_u32 m0, s15, 54272
    s_waitcnt lgkmcnt(3)
    v_mfma_f32_16x16x32_bf16 v[176:179], a[176:179], v[80:83], v[176:179]
    s_waitcnt vmcnt(7)
    s_barrier
    ds_read_b128 v[72:75], v5 offset:16384
    v_mfma_f32_16x16x32_bf16 v[180:183], a[180:183], v[80:83], v[180:183]
    buffer_load_dwordx4 v96, s[28:31], s90 offen sc1 lds
    s_waitcnt lgkmcnt(3)
    v_mfma_f32_16x16x32_bf16 v[160:163], a[184:187], v[84:87], v[160:163]
    ds_read_b128 v[76:79], v5 offset:17408
    v_mfma_f32_16x16x32_bf16 v[164:167], a[188:191], v[84:87], v[164:167]
    s_add_u32 m0, s15, 55296
    s_waitcnt lgkmcnt(3)
    v_mfma_f32_16x16x32_bf16 v[168:171], a[184:187], v[88:91], v[168:171]
    ds_read_b128 v[80:83], v5 offset:18432
    v_mfma_f32_16x16x32_bf16 v[172:175], a[188:191], v[88:91], v[172:175]
    buffer_load_dwordx4 v97, s[28:31], s90 offen sc1 lds
    s_waitcnt lgkmcnt(3)
    v_mfma_f32_16x16x32_bf16 v[176:179], a[184:187], v[92:95], v[176:179]
    ds_read_b128 v[84:87], v5 offset:19456
    v_mfma_f32_16x16x32_bf16 v[180:183], a[188:191], v[92:95], v[180:183]
    s_waitcnt lgkmcnt(3)
    v_mfma_f32_16x16x32_bf16 v[160:163], a[192:195], v[72:75], v[160:163]
    ds_read_b128 v[88:91], v5 offset:20480
    v_mfma_f32_16x16x32_bf16 v[164:167], a[196:199], v[72:75], v[164:167]
    s_waitcnt lgkmcnt(3)
    v_mfma_f32_16x16x32_bf16 v[168:171], a[192:195], v[76:79], v[168:171]
    ds_read_b128 v[92:95], v5 offset:21504
    v_mfma_f32_16x16x32_bf16 v[172:175], a[196:199], v[76:79], v[172:175]
    s_waitcnt lgkmcnt(3)
    v_mfma_f32_16x16x32_bf16 v[176:179], a[192:195], v[80:83], v[176:179]
    ds_read_b128 v[72:75], v5 offset:22528
    v_mfma_f32_16x16x32_bf16 v[180:183], a[196:199], v[80:83], v[180:183]
    s_waitcnt lgkmcnt(3)
    v_mfma_f32_16x16x32_bf16 v[160:163], a[200:203], v[84:87], v[160:163]
    ds_read_b128 v[76:79], v5 offset:23552
    v_mfma_f32_16x16x32_bf16 v[164:167], a[204:207], v[84:87], v[164:167]
    s_waitcnt lgkmcnt(3)
    v_mfma_f32_16x16x32_bf16 v[168:171], a[200:203], v[88:91], v[168:171]
    ds_read_b128 v[80:83], v5 offset:24576
    v_mfma_f32_16x16x32_bf16 v[172:175], a[204:207], v[88:91], v[172:175]
    s_waitcnt lgkmcnt(3)
    v_mfma_f32_16x16x32_bf16 v[176:179], a[200:203], v[92:95], v[176:179]
    ds_read_b128 v[84:87], v5 offset:25600
    v_mfma_f32_16x16x32_bf16 v[180:183], a[204:207], v[92:95], v[180:183]
    s_waitcnt lgkmcnt(3)
    v_mfma_f32_16x16x32_bf16 v[160:163], a[208:211], v[72:75], v[160:163]
    ds_read_b128 v[88:91], v5 offset:26624
    v_mfma_f32_16x16x32_bf16 v[164:167], a[212:215], v[72:75], v[164:167]
    s_waitcnt lgkmcnt(3)
    v_mfma_f32_16x16x32_bf16 v[168:171], a[208:211], v[76:79], v[168:171]
    ds_read_b128 v[92:95], v5 offset:27648
    v_mfma_f32_16x16x32_bf16 v[172:175], a[212:215], v[76:79], v[172:175]
    s_waitcnt lgkmcnt(3)
    v_mfma_f32_16x16x32_bf16 v[176:179], a[208:211], v[80:83], v[176:179]
    s_waitcnt vmcnt(6)
    s_barrier
    ds_read_b128 v[72:75], v5 offset:28672
    v_mfma_f32_16x16x32_bf16 v[180:183], a[212:215], v[80:83], v[180:183]
    s_waitcnt lgkmcnt(3)
    v_mfma_f32_16x16x32_bf16 v[160:163], a[216:219], v[84:87], v[160:163]
    ds_read_b128 v[76:79], v5 offset:29696
    v_mfma_f32_16x16x32_bf16 v[164:167], a[220:223], v[84:87], v[164:167]
    s_waitcnt lgkmcnt(3)
    v_mfma_f32_16x16x32_bf16 v[168:171], a[216:219], v[88:91], v[168:171]
    ds_read_b128 v[80:83], v5 offset:30720
    v_mfma_f32_16x16x32_bf16 v[172:175], a[220:223], v[88:91], v[172:175]
    s_waitcnt lgkmcnt(3)
    v_mfma_f32_16x16x32_bf16 v[176:179], a[216:219], v[92:95], v[176:179]
    ds_read_b128 v[84:87], v5 offset:31744
    v_mfma_f32_16x16x32_bf16 v[180:183], a[220:223], v[92:95], v[180:183]
    s_waitcnt lgkmcnt(3)
    v_mfma_f32_16x16x32_bf16 v[160:163], a[224:227], v[72:75], v[160:163]
    ds_read_b128 v[88:91], v5 offset:32768
    v_mfma_f32_16x16x32_bf16 v[164:167], a[228:231], v[72:75], v[164:167]
    s_waitcnt lgkmcnt(3)
    v_mfma_f32_16x16x32_bf16 v[168:171], a[224:227], v[76:79], v[168:171]
    ds_read_b128 v[92:95], v5 offset:33792
    v_mfma_f32_16x16x32_bf16 v[172:175], a[228:231], v[76:79], v[172:175]
    s_waitcnt lgkmcnt(3)
    v_mfma_f32_16x16x32_bf16 v[176:179], a[224:227], v[80:83], v[176:179]
    ds_read_b128 v[72:75], v5 offset:34816
    v_mfma_f32_16x16x32_bf16 v[180:183], a[228:231], v[80:83], v[180:183]
    s_waitcnt lgkmcnt(3)
    v_mfma_f32_16x16x32_bf16 v[160:163], a[232:235], v[84:87], v[160:163]
    ds_read_b128 v[76:79], v5 offset:35840
    v_mfma_f32_16x16x32_bf16 v[164:167], a[236:239], v[84:87], v[164:167]
    s_waitcnt lgkmcnt(3)
    v_mfma_f32_16x16x32_bf16 v[168:171], a[232:235], v[88:91], v[168:171]
    ds_read_b128 v[80:83], v5 offset:36864
    v_mfma_f32_16x16x32_bf16 v[172:175], a[236:239], v[88:91], v[172:175]
    s_waitcnt lgkmcnt(3)
    v_mfma_f32_16x16x32_bf16 v[176:179], a[232:235], v[92:95], v[176:179]
    ds_read_b128 v[84:87], v5 offset:37888
    v_mfma_f32_16x16x32_bf16 v[180:183], a[236:239], v[92:95], v[180:183]
    s_waitcnt lgkmcnt(3)
    v_mfma_f32_16x16x32_bf16 v[160:163], a[240:243], v[72:75], v[160:163]
    ds_read_b128 v[88:91], v5 offset:38912
    v_mfma_f32_16x16x32_bf16 v[164:167], a[244:247], v[72:75], v[164:167]
    s_waitcnt lgkmcnt(3)
    v_mfma_f32_16x16x32_bf16 v[168:171], a[240:243], v[76:79], v[168:171]
    ds_read_b128 v[92:95], v5 offset:39936
    v_mfma_f32_16x16x32_bf16 v[172:175], a[244:247], v[76:79], v[172:175]
    s_waitcnt lgkmcnt(3)
    v_mfma_f32_16x16x32_bf16 v[176:179], a[240:243], v[80:83], v[176:179]
    s_waitcnt vmcnt(3)
    s_barrier
    ds_read_b128 v[72:75], v5 offset:40960
    v_mfma_f32_16x16x32_bf16 v[180:183], a[244:247], v[80:83], v[180:183]
    s_waitcnt lgkmcnt(3)
    v_mfma_f32_16x16x32_bf16 v[160:163], a[248:251], v[84:87], v[160:163]
    ds_read_b128 v[76:79], v5 offset:41984
    v_mfma_f32_16x16x32_bf16 v[164:167], a[252:255], v[84:87], v[164:167]
    s_waitcnt lgkmcnt(3)
    v_mfma_f32_16x16x32_bf16 v[168:171], a[248:251], v[88:91], v[168:171]
    ds_read_b128 v[80:83], v5 offset:43008
    v_mfma_f32_16x16x32_bf16 v[172:175], a[252:255], v[88:91], v[172:175]
    s_waitcnt lgkmcnt(3)
    v_mfma_f32_16x16x32_bf16 v[176:179], a[248:251], v[92:95], v[176:179]
    ds_read_b128 v[84:87], v5 offset:44032
    v_mfma_f32_16x16x32_bf16 v[180:183], a[252:255], v[92:95], v[180:183]
    s_waitcnt lgkmcnt(3)
    v_mfma_f32_16x16x32_bf16 v[160:163], v[184:187], v[72:75], v[160:163]
    ds_read_b128 v[88:91], v5 offset:45056
    v_mfma_f32_16x16x32_bf16 v[164:167], v[188:191], v[72:75], v[164:167]
    s_waitcnt lgkmcnt(3)
    v_mfma_f32_16x16x32_bf16 v[168:171], v[184:187], v[76:79], v[168:171]
    ds_read_b128 v[92:95], v5 offset:46080
    v_mfma_f32_16x16x32_bf16 v[172:175], v[188:191], v[76:79], v[172:175]
    s_waitcnt lgkmcnt(3)
    v_mfma_f32_16x16x32_bf16 v[176:179], v[184:187], v[80:83], v[176:179]
    ds_read_b128 v[72:75], v5 offset:47104
    v_mfma_f32_16x16x32_bf16 v[180:183], v[188:191], v[80:83], v[180:183]
    s_waitcnt lgkmcnt(3)
    v_mfma_f32_16x16x32_bf16 v[160:163], v[192:195], v[84:87], v[160:163]
    ds_read_b128 v[76:79], v5 offset:48128
    v_mfma_f32_16x16x32_bf16 v[164:167], v[196:199], v[84:87], v[164:167]
    s_waitcnt lgkmcnt(3)
    v_mfma_f32_16x16x32_bf16 v[168:171], v[192:195], v[88:91], v[168:171]
    ds_read_b128 v[80:83], v5 offset:49152
    v_mfma_f32_16x16x32_bf16 v[172:175], v[196:199], v[88:91], v[172:175]
    s_waitcnt lgkmcnt(3)
    v_mfma_f32_16x16x32_bf16 v[176:179], v[192:195], v[92:95], v[176:179]
    ds_read_b128 v[84:87], v5 offset:50176
    v_mfma_f32_16x16x32_bf16 v[180:183], v[196:199], v[92:95], v[180:183]
    s_waitcnt lgkmcnt(3)
    v_mfma_f32_16x16x32_bf16 v[160:163], v[200:203], v[72:75], v[160:163]
    ds_read_b128 v[88:91], v5 offset:51200
    v_mfma_f32_16x16x32_bf16 v[164:167], v[204:207], v[72:75], v[164:167]
    s_waitcnt lgkmcnt(3)
    v_mfma_f32_16x16x32_bf16 v[168:171], v[200:203], v[76:79], v[168:171]
    ds_read_b128 v[92:95], v5 offset:52224
    v_mfma_f32_16x16x32_bf16 v[172:175], v[204:207], v[76:79], v[172:175]
    s_waitcnt lgkmcnt(3)
    v_mfma_f32_16x16x32_bf16 v[176:179], v[200:203], v[80:83], v[176:179]
    s_waitcnt vmcnt(0)
    s_barrier
    ds_read_b128 v[72:75], v5 offset:53248
    v_mfma_f32_16x16x32_bf16 v[180:183], v[204:207], v[80:83], v[180:183]
    s_waitcnt lgkmcnt(3)
    v_mfma_f32_16x16x32_bf16 v[160:163], v[208:211], v[84:87], v[160:163]
    ds_read_b128 v[76:79], v5 offset:54272
    v_mfma_f32_16x16x32_bf16 v[164:167], v[212:215], v[84:87], v[164:167]
    s_waitcnt lgkmcnt(3)
    v_mfma_f32_16x16x32_bf16 v[168:171], v[208:211], v[88:91], v[168:171]
    ds_read_b128 v[80:83], v5 offset:55296
    v_mfma_f32_16x16x32_bf16 v[172:175], v[212:215], v[88:91], v[172:175]
    s_waitcnt lgkmcnt(3)
    v_mfma_f32_16x16x32_bf16 v[176:179], v[208:211], v[92:95], v[176:179]
    ds_read_b128 v[84:87], v5 offset:56320
    v_mfma_f32_16x16x32_bf16 v[180:183], v[212:215], v[92:95], v[180:183]
    s_waitcnt lgkmcnt(3)
    v_mfma_f32_16x16x32_bf16 v[160:163], v[216:219], v[72:75], v[160:163]
    ds_read_b128 v[88:91], v5 offset:57344
    v_mfma_f32_16x16x32_bf16 v[164:167], v[220:223], v[72:75], v[164:167]
    s_waitcnt lgkmcnt(3)
    v_mfma_f32_16x16x32_bf16 v[168:171], v[216:219], v[76:79], v[168:171]
    ds_read_b128 v[92:95], v5 offset:58368
    v_mfma_f32_16x16x32_bf16 v[172:175], v[220:223], v[76:79], v[172:175]
    s_waitcnt lgkmcnt(3)
    v_mfma_f32_16x16x32_bf16 v[176:179], v[216:219], v[80:83], v[176:179]
    ds_read_b128 v[72:75], v5 offset:59392
    v_mfma_f32_16x16x32_bf16 v[180:183], v[220:223], v[80:83], v[180:183]
    s_waitcnt lgkmcnt(3)
    v_mfma_f32_16x16x32_bf16 v[160:163], v[224:227], v[84:87], v[160:163]
    ds_read_b128 v[76:79], v5 offset:60416
    v_mfma_f32_16x16x32_bf16 v[164:167], v[228:231], v[84:87], v[164:167]
    s_waitcnt lgkmcnt(3)
    v_mfma_f32_16x16x32_bf16 v[168:171], v[224:227], v[88:91], v[168:171]
    ds_read_b128 v[80:83], v5 offset:61440
    v_mfma_f32_16x16x32_bf16 v[172:175], v[228:231], v[88:91], v[172:175]
    s_waitcnt lgkmcnt(3)
    v_mfma_f32_16x16x32_bf16 v[176:179], v[224:227], v[92:95], v[176:179]
    ds_read_b128 v[84:87], v5 offset:62464
    v_mfma_f32_16x16x32_bf16 v[180:183], v[228:231], v[92:95], v[180:183]
    s_waitcnt lgkmcnt(3)
    v_mfma_f32_16x16x32_bf16 v[160:163], v[232:235], v[72:75], v[160:163]
    ds_read_b128 v[88:91], v5 offset:63488
    v_mfma_f32_16x16x32_bf16 v[164:167], v[236:239], v[72:75], v[164:167]
    s_waitcnt lgkmcnt(3)
    v_mfma_f32_16x16x32_bf16 v[168:171], v[232:235], v[76:79], v[168:171]
    ds_read_b128 v[92:95], v5 offset:64512
    v_mfma_f32_16x16x32_bf16 v[172:175], v[236:239], v[76:79], v[172:175]
    s_waitcnt lgkmcnt(3)
    v_mfma_f32_16x16x32_bf16 v[176:179], v[232:235], v[80:83], v[176:179]
    v_mfma_f32_16x16x32_bf16 v[180:183], v[236:239], v[80:83], v[180:183]
    s_waitcnt lgkmcnt(2)
    v_mfma_f32_16x16x32_bf16 v[160:163], v[240:243], v[84:87], v[160:163]
    v_mfma_f32_16x16x32_bf16 v[164:167], v[244:247], v[84:87], v[164:167]
    s_waitcnt lgkmcnt(1)
    v_mfma_f32_16x16x32_bf16 v[168:171], v[240:243], v[88:91], v[168:171]
    v_mfma_f32_16x16x32_bf16 v[172:175], v[244:247], v[88:91], v[172:175]
    s_waitcnt lgkmcnt(0)
    v_mfma_f32_16x16x32_bf16 v[176:179], v[240:243], v[92:95], v[176:179]
    v_mfma_f32_16x16x32_bf16 v[180:183], v[244:247], v[92:95], v[180:183]
    s_nop 0
    v_cvt_pk_bf16_f32 v48, v160, v161
    v_cvt_pk_bf16_f32 v49, v162, v163
    v_cvt_pk_bf16_f32 v50, v164, v165
    v_cvt_pk_bf16_f32 v51, v166, v167
    v_cvt_pk_bf16_f32 v52, v168, v169
    v_cvt_pk_bf16_f32 v53, v170, v171
    v_cvt_pk_bf16_f32 v54, v172, v173
    v_cvt_pk_bf16_f32 v55, v174, v175
    v_cvt_pk_bf16_f32 v56, v176, v177
    v_cvt_pk_bf16_f32 v57, v178, v179
    v_cvt_pk_bf16_f32 v58, v180, v181
    v_cvt_pk_bf16_f32 v59, v182, v183
    v_mfma_f32_16x16x32_bf16 v[96:99], v[248:251], v[48:51], 0
    v_mfma_f32_16x16x32_bf16 v[100:103], v[48:51], v[48:51], 0
    v_mfma_f32_16x16x32_bf16 v[104:107], v[248:251], v[52:55], 0
    v_mfma_f32_16x16x32_bf16 v[108:111], v[52:55], v[52:55], 0
    v_mfma_f32_16x16x32_bf16 v[112:115], v[248:251], v[56:59], 0
    v_mfma_f32_16x16x32_bf16 v[116:119], v[56:59], v[56:59], 0
    s_nop 3
    v_cndmask_b32 v100, v100, v101, s[56:57]
    v_cndmask_b32 v100, v100, v102, s[58:59]
    v_cndmask_b32 v97, v100, v103, s[60:61]
    ds_write_b64 v255, v[96:97] offset:2048
    v_cndmask_b32 v108, v108, v109, s[56:57]
    v_cndmask_b32 v108, v108, v110, s[58:59]
    v_cndmask_b32 v105, v108, v111, s[60:61]
    ds_write_b64 v255, v[104:105] offset:2176
    v_cndmask_b32 v116, v116, v117, s[56:57]
    v_cndmask_b32 v116, v116, v118, s[58:59]
    v_cndmask_b32 v113, v116, v119, s[60:61]
    ds_write_b64 v255, v[112:113] offset:2304
    s_waitcnt lgkmcnt(0)
    s_barrier
    v_lshlrev_b32 v22, 3, v0
    ds_read_b64 v[120:121], v22 offset:2048
    ds_read_b64 v[122:123], v22 offset:2432
    ds_read_b64 v[124:125], v22 offset:2816
    ds_read_b64 v[126:127], v22 offset:3200
    s_lshl_b32 s89, s13, 7
    s_add_u32 s88, s100, s89
    s_add_u32 s88, s88, 4096
    v_lshrrev_b32 v22, 4, v0
    v_mul_u32_u24 v22, 640, v22
    v_lshl_add_u32 v22, v2, 3, v22
    v_cmp_gt_u32 vcc, 48, v0
    v_mov_b32 v23, 0x40000000
    s_nop 0
    v_cndmask_b32 v22, v23, v22, vcc
    s_waitcnt lgkmcnt(2)
    v_pk_add_f32 v[120:121], v[120:121], v[122:123]
    s_waitcnt lgkmcnt(0)
    v_pk_add_f32 v[124:125], v[124:125], v[126:127]
    v_pk_add_f32 v[120:121], v[120:121], v[124:125]
    v_or_b32 v121, 0x80000000, v121
    buffer_store_dwordx2 v[120:121], v22, s[40:43], s88 offen
    v_lshlrev_b32 v128, 16, v60
    v_and_b32 v129, 0xffff0000, v60
    v_lshlrev_b32 v130, 16, v61
    v_and_b32 v131, 0xffff0000, v61
    v_lshlrev_b32 v132, 16, v62
    v_and_b32 v133, 0xffff0000, v62
    v_lshlrev_b32 v134, 16, v63
    v_and_b32 v135, 0xffff0000, v63
    v_lshlrev_b32 v136, 16, v64
    v_and_b32 v137, 0xffff0000, v64
    v_lshlrev_b32 v138, 16, v65
    v_and_b32 v139, 0xffff0000, v65
    v_lshlrev_b32 v140, 16, v66
    v_and_b32 v141, 0xffff0000, v66
    v_lshlrev_b32 v142, 16, v67
    v_and_b32 v143, 0xffff0000, v67
    v_lshlrev_b32 v144, 16, v68
    v_and_b32 v145, 0xffff0000, v68
    v_lshlrev_b32 v146, 16, v69
    v_and_b32 v147, 0xffff0000, v69
    v_lshlrev_b32 v148, 16, v70
    v_and_b32 v149, 0xffff0000, v70
    v_lshlrev_b32 v150, 16, v71
    v_and_b32 v151, 0xffff0000, v71
    v_lshrrev_b32 v152, 4, v0
    v_mul_u32_u24 v152, 640, v152
    v_lshl_add_u32 v152, v2, 3, v152
    s_add_u32 s85, s100, 4096
    s_cmp_lg_u32 s3, 0
    s_cbranch_scc1 CL_p2_skip_20
    s_cmp_ge_u32 s9, 30
    s_cbranch_scc1 CL_p2_skip_20
    s_mov_b32 s89, 1048576
CL_p2_loop_21:
    buffer_load_dwordx2 v[96:97], v152, s[40:43], s85 offen offset:0 sc1
    buffer_load_dwordx2 v[98:99], v152, s[40:43], s85 offen offset:128 sc1
    buffer_load_dwordx2 v[100:101], v152, s[40:43], s85 offen offset:256 sc1
    buffer_load_dwordx2 v[102:103], v152, s[40:43], s85 offen offset:384 sc1
    buffer_load_dwordx2 v[104:105], v152, s[40:43], s85 offen offset:512 sc1
    s_waitcnt vmcnt(0)
    v_and_b32 v106, v97, v99
    v_and_b32 v107, v101, v103
    v_and_b32 v106, v106, v105
    v_and_b32 v106, v106, v107
    v_cmp_le_i32 vcc, 0, v106
    v_cmp_gt_u32 s[86:87], 48, v0
    s_nop 0
    s_and_b64 vcc, vcc, s[86:87]
    s_cbranch_vccz CL_p2_done_22
    s_sub_u32 s89, s89, 1
    s_cmp_eq_u32 s89, 0
    s_cbranch_scc1 L_k2_end
    s_branch CL_p2_loop_21
CL_p2_done_22:
    v_and_b32 v97, 0x7fffffff, v97
    v_and_b32 v99, 0x7fffffff, v99
    v_and_b32 v101, 0x7fffffff, v101
    v_and_b32 v103, 0x7fffffff, v103
    v_and_b32 v105, 0x7fffffff, v105
    v_pk_add_f32 v[96:97], v[96:97], v[98:99]
    v_pk_add_f32 v[100:101], v[100:101], v[102:103]
    v_pk_add_f32 v[96:97], v[96:97], v[104:105]
    v_pk_add_f32 v[96:97], v[96:97], v[100:101]
    s_mov_b32 s88, 0x3acccccd
    v_mul_f32 v96, s88, v96
    v_mul_f32 v97, s88, v97
    v_fma_f32 v97, -v96, v96, v97
    v_max_f32 v97, 0, v97
    v_add_f32 v97, 0x3727c5ac, v97
    v_rsq_f32 v98, v97
    s_nop 0
    v_mul_f32 v99, v96, v98
    v_sub_f32 v99, 0, v99
    v_lshlrev_b32 v22, 3, v0
    v_cmp_gt_u32 vcc, 48, v0
    s_nop 0
    s_and_saveexec_b64 s[86:87], vcc
    ds_write_b64 v22, v[98:99] offset:0
    s_mov_b64 exec, s[86:87]
    s_waitcnt lgkmcnt(0)
CL_p2_skip_20:
    s_barrier
    v_lshlrev_b32 v22, 3, v2
    ds_read_b64 v[108:109], v22 offset:0
    ds_read_b64 v[110:111], v22 offset:128
    ds_read_b64 v[112:113], v22 offset:256
    s_add_u32 s15, s98, s99
    s_waitcnt lgkmcnt(2)
    v_pk_fma_f32 v[116:117], v[160:161], v[108:109], v[108:109] op_sel:[0,0,1] op_sel_hi:[1,0,1]
    v_pk_fma_f32 v[118:119], v[162:163], v[108:109], v[108:109] op_sel:[0,0,1] op_sel_hi:[1,0,1]
    v_pk_fma_f32 v[120:121], v[164:165], v[108:109], v[108:109] op_sel:[0,0,1] op_sel_hi:[1,0,1]
    v_pk_fma_f32 v[122:123], v[166:167], v[108:109], v[108:109] op_sel:[0,0,1] op_sel_hi:[1,0,1]
    v_pk_fma_f32 v[160:161], v[116:117], v[128:129], v[160:161]
    v_pk_fma_f32 v[162:163], v[118:119], v[130:131], v[162:163]
    v_pk_fma_f32 v[164:165], v[120:121], v[132:133], v[164:165]
    v_pk_fma_f32 v[166:167], v[122:123], v[134:135], v[166:167]
    v_cvt_pk_bf16_f32 v36, v160, v161
    v_cvt_pk_bf16_f32 v37, v162, v163
    v_cvt_pk_bf16_f32 v38, v164, v165
    v_cvt_pk_bf16_f32 v39, v166, v167
    s_add_u32 s90, s15, 0
    buffer_store_dwordx4 v[36:39], v5, s[32:35], s90 offen
    s_waitcnt lgkmcnt(1)
    v_pk_fma_f32 v[116:117], v[168:169], v[110:111], v[110:111] op_sel:[0,0,1] op_sel_hi:[1,0,1]
    v_pk_fma_f32 v[118:119], v[170:171], v[110:111], v[110:111] op_sel:[0,0,1] op_sel_hi:[1,0,1]
    v_pk_fma_f32 v[120:121], v[172:173], v[110:111], v[110:111] op_sel:[0,0,1] op_sel_hi:[1,0,1]
    v_pk_fma_f32 v[122:123], v[174:175], v[110:111], v[110:111] op_sel:[0,0,1] op_sel_hi:[1,0,1]
    v_pk_fma_f32 v[168:169], v[116:117], v[136:137], v[168:169]
    v_pk_fma_f32 v[170:171], v[118:119], v[138:139], v[170:171]
    v_pk_fma_f32 v[172:173], v[120:121], v[140:141], v[172:173]
    v_pk_fma_f32 v[174:175], v[122:123], v[142:143], v[174:175]
    v_cvt_pk_bf16_f32 v40, v168, v169
    v_cvt_pk_bf16_f32 v41, v170, v171
    v_cvt_pk_bf16_f32 v42, v172, v173
    v_cvt_pk_bf16_f32 v43, v174, v175
    s_add_u32 s90, s15, 20480
    buffer_store_dwordx4 v[40:43], v5, s[32:35], s90 offen
    s_waitcnt lgkmcnt(0)
    v_pk_fma_f32 v[116:117], v[176:177], v[112:113], v[112:113] op_sel:[0,0,1] op_sel_hi:[1,0,1]
    v_pk_fma_f32 v[118:119], v[178:179], v[112:113], v[112:113] op_sel:[0,0,1] op_sel_hi:[1,0,1]
    v_pk_fma_f32 v[120:121], v[180:181], v[112:113], v[112:113] op_sel:[0,0,1] op_sel_hi:[1,0,1]
    v_pk_fma_f32 v[122:123], v[182:183], v[112:113], v[112:113] op_sel:[0,0,1] op_sel_hi:[1,0,1]
    v_pk_fma_f32 v[176:177], v[116:117], v[144:145], v[176:177]
    v_pk_fma_f32 v[178:179], v[118:119], v[146:147], v[178:179]
    v_pk_fma_f32 v[180:181], v[120:121], v[148:149], v[180:181]
    v_pk_fma_f32 v[182:183], v[122:123], v[150:151], v[182:183]
    v_cvt_pk_bf16_f32 v44, v176, v177
    v_cvt_pk_bf16_f32 v45, v178, v179
    v_cvt_pk_bf16_f32 v46, v180, v181
    v_cvt_pk_bf16_f32 v47, v182, v183
    s_add_u32 s90, s15, 40960
    buffer_store_dwordx4 v[44:47], v5, s[32:35], s90 offen
    s_waitcnt vmcnt(0) lgkmcnt(0)
    s_barrier
    s_cmp_lg_u32 s3, 0
    s_cbranch_scc1 CL_xb_skip_23
    v_mov_b32 v22, 1
    s_lshl_b32 s88, s9, 2
    v_mov_b32 v23, 0
    v_cmp_eq_u32 vcc, 0, v1
    s_nop 0
    s_and_saveexec_b64 s[86:87], vcc
    buffer_store_dword v22, v23, s[52:55], s88 offen offset:384
    s_mov_b64 exec, s[86:87]
CL_xb_skip_23:
    v_mfma_f32_16x16x32_bf16 v[96:99], v[248:251], v[36:39], 0
    v_mfma_f32_16x16x32_bf16 v[100:103], v[36:39], v[36:39], 0
    v_mfma_f32_16x16x32_bf16 v[104:107], v[248:251], v[40:43], 0
    v_mfma_f32_16x16x32_bf16 v[108:111], v[40:43], v[40:43], 0
    v_mfma_f32_16x16x32_bf16 v[112:115], v[248:251], v[44:47], 0
    v_mfma_f32_16x16x32_bf16 v[116:119], v[44:47], v[44:47], 0
    s_nop 3
    v_cndmask_b32 v100, v100, v101, s[56:57]
    v_cndmask_b32 v100, v100, v102, s[58:59]
    v_cndmask_b32 v97, v100, v103, s[60:61]
    ds_write_b64 v255, v[96:97] offset:2048
    v_cndmask_b32 v108, v108, v109, s[56:57]
    v_cndmask_b32 v108, v108, v110, s[58:59]
    v_cndmask_b32 v105, v108, v111, s[60:61]
    ds_write_b64 v255, v[104:105] offset:2176
    v_cndmask_b32 v116, v116, v117, s[56:57]
    v_cndmask_b32 v116, v116, v118, s[58:59]
    v_cndmask_b32 v113, v116, v119, s[60:61]
    ds_write_b64 v255, v[112:113] offset:2304
    s_waitcnt lgkmcnt(0)
    s_barrier
    v_lshlrev_b32 v22, 3, v0
    ds_read_b64 v[120:121], v22 offset:2048
    ds_read_b64 v[122:123], v22 offset:2432
    ds_read_b64 v[124:125], v22 offset:2816
    ds_read_b64 v[126:127], v22 offset:3200
    s_lshl_b32 s89, s13, 7
    s_add_u32 s88, s100, s89
    s_add_u32 s88, s88, 18432
    v_lshrrev_b32 v22, 4, v0
    v_mul_u32_u24 v22, 640, v22
    v_lshl_add_u32 v22, v2, 3, v22
    v_cmp_gt_u32 vcc, 48, v0
    v_mov_b32 v23, 0x40000000
    s_nop 0
    v_cndmask_b32 v22, v23, v22, vcc
    s_waitcnt lgkmcnt(2)
    v_pk_add_f32 v[120:121], v[120:121], v[122:123]
    s_waitcnt lgkmcnt(0)
    v_pk_add_f32 v[124:125], v[124:125], v[126:127]
    v_pk_add_f32 v[120:121], v[120:121], v[124:125]
    v_or_b32 v121, 0x80000000, v121
    buffer_store_dwordx2 v[120:121], v22, s[40:43], s88 offen
    s_cmp_lg_u32 s3, 0
    s_cbranch_scc1 CL_xb_skip_24
    v_and_b32 v23, 31, v1
    v_lshlrev_b32 v23, 2, v23
    s_mov_b32 s89, 1048576
CL_xb_loop_25:
    buffer_load_dword v22, v23, s[52:55], 0 offen offset:384 sc1
    s_waitcnt vmcnt(0)
    v_cmp_eq_u32 vcc, 0, v22
    s_cbranch_vccz CL_xb_done_26
    s_sub_u32 s89, s89, 1
    s_cmp_eq_u32 s89, 0
    s_cbranch_scc1 L_k2_end
    s_branch CL_xb_loop_25
CL_xb_done_26:
CL_xb_skip_24:
    s_barrier
    s_lshl_b32 s14, s10, 3
    s_add_u32 s14, s14, 1
    s_mul_i32 s14, s14, 20480
    s_add_u32 s95, s14, 0
    s_add_u32 m0, s92, 4096
    s_nop 0
    buffer_load_dwordx4 v9, s[32:35], s95 offen sc1 lds
    s_add_u32 m0, s92, 8192
    s_nop 0
    buffer_load_dwordx4 v10, s[32:35], s95 offen sc1 lds
    s_add_u32 m0, s92, 12288
    s_nop 0
    buffer_load_dwordx4 v11, s[32:35], s95 offen sc1 lds
    s_add_u32 m0, s92, 16384
    s_nop 0
    buffer_load_dwordx4 v12, s[32:35], s95 offen sc1 lds
    s_add_u32 m0, s92, 20480
    s_nop 0
    buffer_load_dwordx4 v13, s[32:35], s95 offen sc1 lds
    s_add_u32 s95, s14, 2048
    s_add_u32 m0, s92, 24576
    s_nop 0
    buffer_load_dwordx4 v9, s[32:35], s95 offen sc1 lds
    s_add_u32 m0, s92, 28672
    s_nop 0
    buffer_load_dwordx4 v10, s[32:35], s95 offen sc1 lds
    s_add_u32 m0, s92, 32768
    s_nop 0
    buffer_load_dwordx4 v11, s[32:35], s95 offen sc1 lds
    s_add_u32 m0, s92, 36864
    s_nop 0
    buffer_load_dwordx4 v12, s[32:35], s95 offen sc1 lds
    s_add_u32 m0, s92, 40960
    s_nop 0
    buffer_load_dwordx4 v13, s[32:35], s95 offen sc1 lds
    s_add_u32 s95, s14, 4096
    s_add_u32 m0, s92, 45056
    s_nop 0
    buffer_load_dwordx4 v9, s[32:35], s95 offen sc1 lds
    s_add_u32 m0, s92, 49152
    s_nop 0
    buffer_load_dwordx4 v10, s[32:35], s95 offen sc1 lds
    s_add_u32 m0, s92, 53248
    s_nop 0
    buffer_load_dwordx4 v11, s[32:35], s95 offen sc1 lds
    s_add_u32 m0, s92, 57344
    s_nop 0
    buffer_load_dwordx4 v12, s[32:35], s95 offen sc1 lds
    s_add_u32 m0, s92, 61440
    s_nop 0
    buffer_load_dwordx4 v13, s[32:35], s95 offen sc1 lds
    s_waitcnt vmcnt(10)
    s_barrier
    ds_read_b128 v[72:75], v6 offset:0
    ds_read_b128 v[76:79], v6 offset:2048
    ds_read_b128 v[80:83], v6 offset:4096
    ds_read_b128 v[84:87], v6 offset:6144
    ds_read_b128 v[88:91], v6 offset:8192
    s_add_u32 s95, s14, 6144
    s_add_u32 m0, s92, 65536
    s_waitcnt lgkmcnt(4)
    v_mfma_f32_16x16x32_bf16 v[96:99], a[0:3], v[72:75], 0
    ds_read_b128 v[92:95], v6 offset:10240
    v_mfma_f32_16x16x32_bf16 v[100:103], a[4:7], v[72:75], 0
    buffer_load_dwordx4 v9, s[32:35], s95 offen sc1 lds
    s_waitcnt lgkmcnt(4)
    v_mfma_f32_16x16x32_bf16 v[104:107], a[0:3], v[76:79], 0
    ds_read_b128 v[72:75], v6 offset:12288
    v_mfma_f32_16x16x32_bf16 v[108:111], a[4:7], v[76:79], 0
    s_waitcnt lgkmcnt(4)
    v_mfma_f32_16x16x32_bf16 v[112:115], a[0:3], v[80:83], 0
    ds_read_b128 v[76:79], v6 offset:14336
    v_mfma_f32_16x16x32_bf16 v[116:119], a[4:7], v[80:83], 0
    s_add_u32 m0, s92, 69632
    s_waitcnt lgkmcnt(4)
    v_mfma_f32_16x16x32_bf16 v[120:123], a[0:3], v[84:87], 0
    ds_read_b128 v[80:83], v6 offset:16384
    v_mfma_f32_16x16x32_bf16 v[124:127], a[4:7], v[84:87], 0
    buffer_load_dwordx4 v10, s[32:35], s95 offen sc1 lds
    s_waitcnt lgkmcnt(4)
    v_mfma_f32_16x16x32_bf16 v[128:131], a[0:3], v[88:91], 0
    ds_read_b128 v[84:87], v6 offset:1024
    v_mfma_f32_16x16x32_bf16 v[132:135], a[4:7], v[88:91], 0
    s_waitcnt lgkmcnt(4)
    v_mfma_f32_16x16x32_bf16 v[136:139], a[0:3], v[92:95], 0
    ds_read_b128 v[88:91], v6 offset:3072
    v_mfma_f32_16x16x32_bf16 v[140:143], a[4:7], v[92:95], 0
    s_add_u32 m0, s92, 73728
    s_waitcnt lgkmcnt(4)
    v_mfma_f32_16x16x32_bf16 v[144:147], a[0:3], v[72:75], 0
    ds_read_b128 v[92:95], v6 offset:5120
    v_mfma_f32_16x16x32_bf16 v[148:151], a[4:7], v[72:75], 0
    buffer_load_dwordx4 v11, s[32:35], s95 offen sc1 lds
    s_waitcnt lgkmcnt(4)
    v_mfma_f32_16x16x32_bf16 v[152:155], a[0:3], v[76:79], 0
    ds_read_b128 v[72:75], v6 offset:7168
    v_mfma_f32_16x16x32_bf16 v[156:159], a[4:7], v[76:79], 0
    s_waitcnt lgkmcnt(4)
    v_mfma_f32_16x16x32_bf16 v[160:163], a[0:3], v[80:83], 0
    ds_read_b128 v[76:79], v6 offset:9216
    v_mfma_f32_16x16x32_bf16 v[164:167], a[4:7], v[80:83], 0
    s_add_u32 m0, s92, 77824
    s_waitcnt lgkmcnt(4)
    v_mfma_f32_16x16x32_bf16 v[96:99], a[8:11], v[84:87], v[96:99]
    ds_read_b128 v[80:83], v6 offset:11264
    v_mfma_f32_16x16x32_bf16 v[100:103], a[12:15], v[84:87], v[100:103]
    buffer_load_dwordx4 v12, s[32:35], s95 offen sc1 lds
    s_waitcnt lgkmcnt(4)
    v_mfma_f32_16x16x32_bf16 v[104:107], a[8:11], v[88:91], v[104:107]
    ds_read_b128 v[84:87], v6 offset:13312
    v_mfma_f32_16x16x32_bf16 v[108:111], a[12:15], v[88:91], v[108:111]
    s_waitcnt lgkmcnt(4)
    v_mfma_f32_16x16x32_bf16 v[112:115], a[8:11], v[92:95], v[112:115]
    ds_read_b128 v[88:91], v6 offset:15360
    v_mfma_f32_16x16x32_bf16 v[116:119], a[12:15], v[92:95], v[116:119]
    s_add_u32 m0, s92, 81920
    s_waitcnt lgkmcnt(4)
    v_mfma_f32_16x16x32_bf16 v[120:123], a[8:11], v[72:75], v[120:123]
    ds_read_b128 v[92:95], v6 offset:17408
    v_mfma_f32_16x16x32_bf16 v[124:127], a[12:15], v[72:75], v[124:127]
    buffer_load_dwordx4 v13, s[32:35], s95 offen sc1 lds
    s_waitcnt lgkmcnt(4)
    v_mfma_f32_16x16x32_bf16 v[128:131], a[8:11], v[76:79], v[128:131]
    s_waitcnt vmcnt(10)
    s_barrier
    ds_read_b128 v[72:75], v6 offset:20480
    v_mfma_f32_16x16x32_bf16 v[132:135], a[12:15], v[76:79], v[132:135]
    s_waitcnt lgkmcnt(4)
    v_mfma_f32_16x16x32_bf16 v[136:139], a[8:11], v[80:83], v[136:139]
    ds_read_b128 v[76:79], v6 offset:22528
    v_mfma_f32_16x16x32_bf16 v[140:143], a[12:15], v[80:83], v[140:143]
    s_add_u32 s95, s14, 8192
    s_add_u32 m0, s92, 86016
    s_waitcnt lgkmcnt(4)
    v_mfma_f32_16x16x32_bf16 v[144:147], a[8:11], v[84:87], v[144:147]
    ds_read_b128 v[80:83], v6 offset:24576
    v_mfma_f32_16x16x32_bf16 v[148:151], a[12:15], v[84:87], v[148:151]
    buffer_load_dwordx4 v9, s[32:35], s95 offen sc1 lds
    s_waitcnt lgkmcnt(4)
    v_mfma_f32_16x16x32_bf16 v[152:155], a[8:11], v[88:91], v[152:155]
    ds_read_b128 v[84:87], v6 offset:26624
    v_mfma_f32_16x16x32_bf16 v[156:159], a[12:15], v[88:91], v[156:159]
    s_waitcnt lgkmcnt(4)
    v_mfma_f32_16x16x32_bf16 v[160:163], a[8:11], v[92:95], v[160:163]
    ds_read_b128 v[88:91], v6 offset:28672
    v_mfma_f32_16x16x32_bf16 v[164:167], a[12:15], v[92:95], v[164:167]
    s_add_u32 m0, s92, 90112
    s_waitcnt lgkmcnt(4)
    v_mfma_f32_16x16x32_bf16 v[96:99], a[16:19], v[72:75], v[96:99]
    ds_read_b128 v[92:95], v6 offset:30720
    v_mfma_f32_16x16x32_bf16 v[100:103], a[20:23], v[72:75], v[100:103]
    buffer_load_dwordx4 v10, s[32:35], s95 offen sc1 lds
    s_waitcnt lgkmcnt(4)
    v_mfma_f32_16x16x32_bf16 v[104:107], a[16:19], v[76:79], v[104:107]
    ds_read_b128 v[72:75], v6 offset:32768
    v_mfma_f32_16x16x32_bf16 v[108:111], a[20:23], v[76:79], v[108:111]
    s_waitcnt lgkmcnt(4)
    v_mfma_f32_16x16x32_bf16 v[112:115], a[16:19], v[80:83], v[112:115]
    ds_read_b128 v[76:79], v6 offset:34816
    v_mfma_f32_16x16x32_bf16 v[116:119], a[20:23], v[80:83], v[116:119]
    s_add_u32 m0, s92, 94208
    s_waitcnt lgkmcnt(4)
    v_mfma_f32_16x16x32_bf16 v[120:123], a[16:19], v[84:87], v[120:123]
    ds_read_b128 v[80:83], v6 offset:36864
    v_mfma_f32_16x16x32_bf16 v[124:127], a[20:23], v[84:87], v[124:127]
    buffer_load_dwordx4 v11, s[32:35], s95 offen sc1 lds
    s_waitcnt lgkmcnt(4)
    v_mfma_f32_16x16x32_bf16 v[128:131], a[16:19], v[88:91], v[128:131]
    ds_read_b128 v[84:87], v6 offset:21504
    v_mfma_f32_16x16x32_bf16 v[132:135], a[20:23], v[88:91], v[132:135]
    s_waitcnt lgkmcnt(4)
    v_mfma_f32_16x16x32_bf16 v[136:139], a[16:19], v[92:95], v[136:139]
    ds_read_b128 v[88:91], v6 offset:23552
    v_mfma_f32_16x16x32_bf16 v[140:143], a[20:23], v[92:95], v[140:143]
    s_add_u32 m0, s92, 98304
    s_waitcnt lgkmcnt(4)
    v_mfma_f32_16x16x32_bf16 v[144:147], a[16:19], v[72:75], v[144:147]
    ds_read_b128 v[92:95], v6 offset:25600
    v_mfma_f32_16x16x32_bf16 v[148:151], a[20:23], v[72:75], v[148:151]
    buffer_load_dwordx4 v12, s[32:35], s95 offen sc1 lds
    s_waitcnt lgkmcnt(4)
    v_mfma_f32_16x16x32_bf16 v[152:155], a[16:19], v[76:79], v[152:155]
    ds_read_b128 v[72:75], v6 offset:27648
    v_mfma_f32_16x16x32_bf16 v[156:159], a[20:23], v[76:79], v[156:159]
    s_waitcnt lgkmcnt(4)
    v_mfma_f32_16x16x32_bf16 v[160:163], a[16:19], v[80:83], v[160:163]
    ds_read_b128 v[76:79], v6 offset:29696
    v_mfma_f32_16x16x32_bf16 v[164:167], a[20:23], v[80:83], v[164:167]
    s_add_u32 m0, s92, 102400
    s_waitcnt lgkmcnt(4)
    v_mfma_f32_16x16x32_bf16 v[96:99], a[24:27], v[84:87], v[96:99]
    ds_read_b128 v[80:83], v6 offset:31744
    v_mfma_f32_16x16x32_bf16 v[100:103], a[28:31], v[84:87], v[100:103]
    buffer_load_dwordx4 v13, s[32:35], s95 offen sc1 lds
    s_waitcnt lgkmcnt(4)
    v_mfma_f32_16x16x32_bf16 v[104:107], a[24:27], v[88:91], v[104:107]
    ds_read_b128 v[84:87], v6 offset:33792
    v_mfma_f32_16x16x32_bf16 v[108:111], a[28:31], v[88:91], v[108:111]
    s_waitcnt lgkmcnt(4)
    v_mfma_f32_16x16x32_bf16 v[112:115], a[24:27], v[92:95], v[112:115]
    ds_read_b128 v[88:91], v6 offset:35840
    v_mfma_f32_16x16x32_bf16 v[116:119], a[28:31], v[92:95], v[116:119]
    s_add_u32 s95, s14, 10240
    s_add_u32 m0, s92, 106496
    s_waitcnt lgkmcnt(4)
    v_mfma_f32_16x16x32_bf16 v[120:123], a[24:27], v[72:75], v[120:123]
    ds_read_b128 v[92:95], v6 offset:37888
    v_mfma_f32_16x16x32_bf16 v[124:127], a[28:31], v[72:75], v[124:127]
    buffer_load_dwordx4 v9, s[32:35], s95 offen sc1 lds
    s_waitcnt lgkmcnt(4)
    v_mfma_f32_16x16x32_bf16 v[128:131], a[24:27], v[76:79], v[128:131]
    s_waitcnt vmcnt(11)
    s_barrier
    ds_read_b128 v[72:75], v6 offset:40960
    v_mfma_f32_16x16x32_bf16 v[132:135], a[28:31], v[76:79], v[132:135]
    s_waitcnt lgkmcnt(4)
    v_mfma_f32_16x16x32_bf16 v[136:139], a[24:27], v[80:83], v[136:139]
    ds_read_b128 v[76:79], v6 offset:43008
    v_mfma_f32_16x16x32_bf16 v[140:143], a[28:31], v[80:83], v[140:143]
    s_add_u32 m0, s92, 110592
    s_waitcnt lgkmcnt(4)
    v_mfma_f32_16x16x32_bf16 v[144:147], a[24:27], v[84:87], v[144:147]
    ds_read_b128 v[80:83], v6 offset:45056
    v_mfma_f32_16x16x32_bf16 v[148:151], a[28:31], v[84:87], v[148:151]
    buffer_load_dwordx4 v10, s[32:35], s95 offen sc1 lds
    s_waitcnt lgkmcnt(4)
    v_mfma_f32_16x16x32_bf16 v[152:155], a[24:27], v[88:91], v[152:155]
    ds_read_b128 v[84:87], v6 offset:47104
    v_mfma_f32_16x16x32_bf16 v[156:159], a[28:31], v[88:91], v[156:159]
    s_waitcnt lgkmcnt(4)
    v_mfma_f32_16x16x32_bf16 v[160:163], a[24:27], v[92:95], v[160:163]
    ds_read_b128 v[88:91], v6 offset:49152
    v_mfma_f32_16x16x32_bf16 v[164:167], a[28:31], v[92:95], v[164:167]
    s_add_u32 m0, s92, 114688
    s_waitcnt lgkmcnt(4)
    v_mfma_f32_16x16x32_bf16 v[96:99], a[32:35], v[72:75], v[96:99]
    ds_read_b128 v[92:95], v6 offset:51200
    v_mfma_f32_16x16x32_bf16 v[100:103], a[36:39], v[72:75], v[100:103]
    buffer_load_dwordx4 v11, s[32:35], s95 offen sc1 lds
    s_waitcnt lgkmcnt(4)
    v_mfma_f32_16x16x32_bf16 v[104:107], a[32:35], v[76:79], v[104:107]
    ds_read_b128 v[72:75], v6 offset:53248
    v_mfma_f32_16x16x32_bf16 v[108:111], a[36:39], v[76:79], v[108:111]
    s_waitcnt lgkmcnt(4)
    v_mfma_f32_16x16x32_bf16 v[112:115], a[32:35], v[80:83], v[112:115]
    ds_read_b128 v[76:79], v6 offset:55296
    v_mfma_f32_16x16x32_bf16 v[116:119], a[36:39], v[80:83], v[116:119]
    s_add_u32 m0, s92, 118784
    s_waitcnt lgkmcnt(4)
    v_mfma_f32_16x16x32_bf16 v[120:123], a[32:35], v[84:87], v[120:123]
    ds_read_b128 v[80:83], v6 offset:57344
    v_mfma_f32_16x16x32_bf16 v[124:127], a[36:39], v[84:87], v[124:127]
    buffer_load_dwordx4 v12, s[32:35], s95 offen sc1 lds
    s_waitcnt lgkmcnt(4)
    v_mfma_f32_16x16x32_bf16 v[128:131], a[32:35], v[88:91], v[128:131]
    ds_read_b128 v[84:87], v6 offset:41984
    v_mfma_f32_16x16x32_bf16 v[132:135], a[36:39], v[88:91], v[132:135]
    s_waitcnt lgkmcnt(4)
    v_mfma_f32_16x16x32_bf16 v[136:139], a[32:35], v[92:95], v[136:139]
    ds_read_b128 v[88:91], v6 offset:44032
    v_mfma_f32_16x16x32_bf16 v[140:143], a[36:39], v[92:95], v[140:143]
    s_add_u32 m0, s92, 122880
    s_waitcnt lgkmcnt(4)
    v_mfma_f32_16x16x32_bf16 v[144:147], a[32:35], v[72:75], v[144:147]
    ds_read_b128 v[92:95], v6 offset:46080
    v_mfma_f32_16x16x32_bf16 v[148:151], a[36:39], v[72:75], v[148:151]
    buffer_load_dwordx4 v13, s[32:35], s95 offen sc1 lds
    s_waitcnt lgkmcnt(4)
    v_mfma_f32_16x16x32_bf16 v[152:155], a[32:35], v[76:79], v[152:155]
    ds_read_b128 v[72:75], v6 offset:48128
    v_mfma_f32_16x16x32_bf16 v[156:159], a[36:39], v[76:79], v[156:159]
    s_waitcnt lgkmcnt(4)
    v_mfma_f32_16x16x32_bf16 v[160:163], a[32:35], v[80:83], v[160:163]
    ds_read_b128 v[76:79], v6 offset:50176
    v_mfma_f32_16x16x32_bf16 v[164:167], a[36:39], v[80:83], v[164:167]
    s_add_u32 s95, s14, 12288
    s_add_u32 m0, s92, 126976
    s_waitcnt lgkmcnt(4)
    v_mfma_f32_16x16x32_bf16 v[96:99], a[40:43], v[84:87], v[96:99]
    ds_read_b128 v[80:83], v6 offset:52224
    v_mfma_f32_16x16x32_bf16 v[100:103], a[44:47], v[84:87], v[100:103]
    buffer_load_dwordx4 v9, s[32:35], s95 offen sc1 lds
    s_waitcnt lgkmcnt(4)
    v_mfma_f32_16x16x32_bf16 v[104:107], a[40:43], v[88:91], v[104:107]
    ds_read_b128 v[84:87], v6 offset:54272
    v_mfma_f32_16x16x32_bf16 v[108:111], a[44:47], v[88:91], v[108:111]
    s_waitcnt lgkmcnt(4)
    v_mfma_f32_16x16x32_bf16 v[112:115], a[40:43], v[92:95], v[112:115]
    ds_read_b128 v[88:91], v6 offset:56320
    v_mfma_f32_16x16x32_bf16 v[116:119], a[44:47], v[92:95], v[116:119]
    s_add_u32 m0, s92, 131072
    s_waitcnt lgkmcnt(4)
    v_mfma_f32_16x16x32_bf16 v[120:123], a[40:43], v[72:75], v[120:123]
    ds_read_b128 v[92:95], v6 offset:58368
    v_mfma_f32_16x16x32_bf16 v[124:127], a[44:47], v[72:75], v[124:127]
    buffer_load_dwordx4 v10, s[32:35], s95 offen sc1 lds
    s_waitcnt lgkmcnt(4)
    v_mfma_f32_16x16x32_bf16 v[128:131], a[40:43], v[76:79], v[128:131]
    s_waitcnt vmcnt(12)
    s_barrier
    ds_read_b128 v[72:75], v7 offset:0
    v_mfma_f32_16x16x32_bf16 v[132:135], a[44:47], v[76:79], v[132:135]
    s_waitcnt lgkmcnt(4)
    v_mfma_f32_16x16x32_bf16 v[136:139], a[40:43], v[80:83], v[136:139]
    ds_read_b128 v[76:79], v7 offset:2048
    v_mfma_f32_16x16x32_bf16 v[140:143], a[44:47], v[80:83], v[140:143]
    s_add_u32 m0, s92, 135168
    s_waitcnt lgkmcnt(4)
    v_mfma_f32_16x16x32_bf16 v[144:147], a[40:43], v[84:87], v[144:147]
    ds_read_b128 v[80:83], v7 offset:4096
    v_mfma_f32_16x16x32_bf16 v[148:151], a[44:47], v[84:87], v[148:151]
    buffer_load_dwordx4 v11, s[32:35], s95 offen sc1 lds
    s_waitcnt lgkmcnt(4)
    v_mfma_f32_16x16x32_bf16 v[152:155], a[40:43], v[88:91], v[152:155]
    ds_read_b128 v[84:87], v7 offset:6144
    v_mfma_f32_16x16x32_bf16 v[156:159], a[44:47], v[88:91], v[156:159]
    s_waitcnt lgkmcnt(4)
    v_mfma_f32_16x16x32_bf16 v[160:163], a[40:43], v[92:95], v[160:163]
    ds_read_b128 v[88:91], v7 offset:8192
    v_mfma_f32_16x16x32_bf16 v[164:167], a[44:47], v[92:95], v[164:167]
    s_add_u32 m0, s92, 139264
    s_waitcnt lgkmcnt(4)
    v_mfma_f32_16x16x32_bf16 v[96:99], a[48:51], v[72:75], v[96:99]
    ds_read_b128 v[92:95], v7 offset:10240
    v_mfma_f32_16x16x32_bf16 v[100:103], a[52:55], v[72:75], v[100:103]
    buffer_load_dwordx4 v12, s[32:35], s95 offen sc1 lds
    s_waitcnt lgkmcnt(4)
    v_mfma_f32_16x16x32_bf16 v[104:107], a[48:51], v[76:79], v[104:107]
    ds_read_b128 v[72:75], v7 offset:12288
    v_mfma_f32_16x16x32_bf16 v[108:111], a[52:55], v[76:79], v[108:111]
    s_waitcnt lgkmcnt(4)
    v_mfma_f32_16x16x32_bf16 v[112:115], a[48:51], v[80:83], v[112:115]
    ds_read_b128 v[76:79], v7 offset:14336
    v_mfma_f32_16x16x32_bf16 v[116:119], a[52:55], v[80:83], v[116:119]
    s_add_u32 m0, s92, 143360
    s_waitcnt lgkmcnt(4)
    v_mfma_f32_16x16x32_bf16 v[120:123], a[48:51], v[84:87], v[120:123]
    ds_read_b128 v[80:83], v7 offset:16384
    v_mfma_f32_16x16x32_bf16 v[124:127], a[52:55], v[84:87], v[124:127]
    buffer_load_dwordx4 v13, s[32:35], s95 offen sc1 lds
    s_waitcnt lgkmcnt(4)
    v_mfma_f32_16x16x32_bf16 v[128:131], a[48:51], v[88:91], v[128:131]
    ds_read_b128 v[84:87], v7 offset:1024
    v_mfma_f32_16x16x32_bf16 v[132:135], a[52:55], v[88:91], v[132:135]
    s_waitcnt lgkmcnt(4)
    v_mfma_f32_16x16x32_bf16 v[136:139], a[48:51], v[92:95], v[136:139]
    ds_read_b128 v[88:91], v7 offset:3072
    v_mfma_f32_16x16x32_bf16 v[140:143], a[52:55], v[92:95], v[140:143]
    s_add_u32 s95, s14, 14336
    s_add_u32 m0, s92, 4096
    s_waitcnt lgkmcnt(4)
    v_mfma_f32_16x16x32_bf16 v[144:147], a[48:51], v[72:75], v[144:147]
    ds_read_b128 v[92:95], v7 offset:5120
    v_mfma_f32_16x16x32_bf16 v[148:151], a[52:55], v[72:75], v[148:151]
    buffer_load_dwordx4 v9, s[32:35], s95 offen sc1 lds
    s_waitcnt lgkmcnt(4)
    v_mfma_f32_16x16x32_bf16 v[152:155], a[48:51], v[76:79], v[152:155]
    ds_read_b128 v[72:75], v7 offset:7168
    v_mfma_f32_16x16x32_bf16 v[156:159], a[52:55], v[76:79], v[156:159]
    s_waitcnt lgkmcnt(4)
    v_mfma_f32_16x16x32_bf16 v[160:163], a[48:51], v[80:83], v[160:163]
    ds_read_b128 v[76:79], v7 offset:9216
    v_mfma_f32_16x16x32_bf16 v[164:167], a[52:55], v[80:83], v[164:167]
    s_add_u32 m0, s92, 8192
    s_waitcnt lgkmcnt(4)
    v_mfma_f32_16x16x32_bf16 v[96:99], a[56:59], v[84:87], v[96:99]
    ds_read_b128 v[80:83], v7 offset:11264
    v_mfma_f32_16x16x32_bf16 v[100:103], a[60:63], v[84:87], v[100:103]
    buffer_load_dwordx4 v10, s[32:35], s95 offen sc1 lds
    s_waitcnt lgkmcnt(4)
    v_mfma_f32_16x16x32_bf16 v[104:107], a[56:59], v[88:91], v[104:107]
    ds_read_b128 v[84:87], v7 offset:13312
    v_mfma_f32_16x16x32_bf16 v[108:111], a[60:63], v[88:91], v[108:111]
    s_waitcnt lgkmcnt(4)
    v_mfma_f32_16x16x32_bf16 v[112:115], a[56:59], v[92:95], v[112:115]
    ds_read_b128 v[88:91], v7 offset:15360
    v_mfma_f32_16x16x32_bf16 v[116:119], a[60:63], v[92:95], v[116:119]
    s_add_u32 m0, s92, 12288
    s_waitcnt lgkmcnt(4)
    v_mfma_f32_16x16x32_bf16 v[120:123], a[56:59], v[72:75], v[120:123]
    ds_read_b128 v[92:95], v7 offset:17408
    v_mfma_f32_16x16x32_bf16 v[124:127], a[60:63], v[72:75], v[124:127]
    buffer_load_dwordx4 v11, s[32:35], s95 offen sc1 lds
    s_waitcnt lgkmcnt(4)
    v_mfma_f32_16x16x32_bf16 v[128:131], a[56:59], v[76:79], v[128:131]
    s_waitcnt vmcnt(13)
    s_barrier
    ds_read_b128 v[72:75], v7 offset:20480
    v_mfma_f32_16x16x32_bf16 v[132:135], a[60:63], v[76:79], v[132:135]
    s_waitcnt lgkmcnt(4)
    v_mfma_f32_16x16x32_bf16 v[136:139], a[56:59], v[80:83], v[136:139]
    ds_read_b128 v[76:79], v7 offset:22528
    v_mfma_f32_16x16x32_bf16 v[140:143], a[60:63], v[80:83], v[140:143]
    s_add_u32 m0, s92, 16384
    s_waitcnt lgkmcnt(4)
    v_mfma_f32_16x16x32_bf16 v[144:147], a[56:59], v[84:87], v[144:147]
    ds_read_b128 v[80:83], v7 offset:24576
    v_mfma_f32_16x16x32_bf16 v[148:151], a[60:63], v[84:87], v[148:151]
    buffer_load_dwordx4 v12, s[32:35], s95 offen sc1 lds
    s_waitcnt lgkmcnt(4)
    v_mfma_f32_16x16x32_bf16 v[152:155], a[56:59], v[88:91], v[152:155]
    ds_read_b128 v[84:87], v7 offset:26624
    v_mfma_f32_16x16x32_bf16 v[156:159], a[60:63], v[88:91], v[156:159]
    s_waitcnt lgkmcnt(4)
    v_mfma_f32_16x16x32_bf16 v[160:163], a[56:59], v[92:95], v[160:163]
    ds_read_b128 v[88:91], v7 offset:28672
    v_mfma_f32_16x16x32_bf16 v[164:167], a[60:63], v[92:95], v[164:167]
    s_add_u32 m0, s92, 20480
    s_waitcnt lgkmcnt(4)
    v_mfma_f32_16x16x32_bf16 v[96:99], a[64:67], v[72:75], v[96:99]
    ds_read_b128 v[92:95], v7 offset:30720
    v_mfma_f32_16x16x32_bf16 v[100:103], a[68:71], v[72:75], v[100:103]
    buffer_load_dwordx4 v13, s[32:35], s95 offen sc1 lds
    s_waitcnt lgkmcnt(4)
    v_mfma_f32_16x16x32_bf16 v[104:107], a[64:67], v[76:79], v[104:107]
    ds_read_b128 v[72:75], v7 offset:32768
    v_mfma_f32_16x16x32_bf16 v[108:111], a[68:71], v[76:79], v[108:111]
    s_waitcnt lgkmcnt(4)
    v_mfma_f32_16x16x32_bf16 v[112:115], a[64:67], v[80:83], v[112:115]
    ds_read_b128 v[76:79], v7 offset:34816
    v_mfma_f32_16x16x32_bf16 v[116:119], a[68:71], v[80:83], v[116:119]
    s_add_u32 s95, s14, 16384
    s_add_u32 m0, s92, 24576
    s_waitcnt lgkmcnt(4)
    v_mfma_f32_16x16x32_bf16 v[120:123], a[64:67], v[84:87], v[120:123]
    ds_read_b128 v[80:83], v7 offset:36864
    v_mfma_f32_16x16x32_bf16 v[124:127], a[68:71], v[84:87], v[124:127]
    buffer_load_dwordx4 v9, s[32:35], s95 offen sc1 lds
    s_waitcnt lgkmcnt(4)
    v_mfma_f32_16x16x32_bf16 v[128:131], a[64:67], v[88:91], v[128:131]
    ds_read_b128 v[84:87], v7 offset:21504
    v_mfma_f32_16x16x32_bf16 v[132:135], a[68:71], v[88:91], v[132:135]
    s_waitcnt lgkmcnt(4)
    v_mfma_f32_16x16x32_bf16 v[136:139], a[64:67], v[92:95], v[136:139]
    ds_read_b128 v[88:91], v7 offset:23552
    v_mfma_f32_16x16x32_bf16 v[140:143], a[68:71], v[92:95], v[140:143]
    s_add_u32 m0, s92, 28672
    s_waitcnt lgkmcnt(4)
    v_mfma_f32_16x16x32_bf16 v[144:147], a[64:67], v[72:75], v[144:147]
    ds_read_b128 v[92:95], v7 offset:25600
    v_mfma_f32_16x16x32_bf16 v[148:151], a[68:71], v[72:75], v[148:151]
    buffer_load_dwordx4 v10, s[32:35], s95 offen sc1 lds
    s_waitcnt lgkmcnt(4)
    v_mfma_f32_16x16x32_bf16 v[152:155], a[64:67], v[76:79], v[152:155]
    ds_read_b128 v[72:75], v7 offset:27648
    v_mfma_f32_16x16x32_bf16 v[156:159], a[68:71], v[76:79], v[156:159]
    s_waitcnt lgkmcnt(4)
    v_mfma_f32_16x16x32_bf16 v[160:163], a[64:67], v[80:83], v[160:163]
    ds_read_b128 v[76:79], v7 offset:29696
    v_mfma_f32_16x16x32_bf16 v[164:167], a[68:71], v[80:83], v[164:167]
    s_add_u32 m0, s92, 32768
    s_waitcnt lgkmcnt(4)
    v_mfma_f32_16x16x32_bf16 v[96:99], a[72:75], v[84:87], v[96:99]
    ds_read_b128 v[80:83], v7 offset:31744
    v_mfma_f32_16x16x32_bf16 v[100:103], a[76:79], v[84:87], v[100:103]
    buffer_load_dwordx4 v11, s[32:35], s95 offen sc1 lds
    s_waitcnt lgkmcnt(4)
    v_mfma_f32_16x16x32_bf16 v[104:107], a[72:75], v[88:91], v[104:107]
    ds_read_b128 v[84:87], v7 offset:33792
    v_mfma_f32_16x16x32_bf16 v[108:111], a[76:79], v[88:91], v[108:111]
    s_waitcnt lgkmcnt(4)
    v_mfma_f32_16x16x32_bf16 v[112:115], a[72:75], v[92:95], v[112:115]
    ds_read_b128 v[88:91], v7 offset:35840
    v_mfma_f32_16x16x32_bf16 v[116:119], a[76:79], v[92:95], v[116:119]
    s_add_u32 m0, s92, 36864
    s_waitcnt lgkmcnt(4)
    v_mfma_f32_16x16x32_bf16 v[120:123], a[72:75], v[72:75], v[120:123]
    ds_read_b128 v[92:95], v7 offset:37888
    v_mfma_f32_16x16x32_bf16 v[124:127], a[76:79], v[72:75], v[124:127]
    buffer_load_dwordx4 v12, s[32:35], s95 offen sc1 lds
    s_waitcnt lgkmcnt(4)
    v_mfma_f32_16x16x32_bf16 v[128:131], a[72:75], v[76:79], v[128:131]
    s_waitcnt vmcnt(14)
    s_barrier
    ds_read_b128 v[72:75], v7 offset:40960
    v_mfma_f32_16x16x32_bf16 v[132:135], a[76:79], v[76:79], v[132:135]
    s_waitcnt lgkmcnt(4)
    v_mfma_f32_16x16x32_bf16 v[136:139], a[72:75], v[80:83], v[136:139]
    ds_read_b128 v[76:79], v7 offset:43008
    v_mfma_f32_16x16x32_bf16 v[140:143], a[76:79], v[80:83], v[140:143]
    s_add_u32 m0, s92, 40960
    s_waitcnt lgkmcnt(4)
    v_mfma_f32_16x16x32_bf16 v[144:147], a[72:75], v[84:87], v[144:147]
    ds_read_b128 v[80:83], v7 offset:45056
    v_mfma_f32_16x16x32_bf16 v[148:151], a[76:79], v[84:87], v[148:151]
    buffer_load_dwordx4 v13, s[32:35], s95 offen sc1 lds
    s_waitcnt lgkmcnt(4)
    v_mfma_f32_16x16x32_bf16 v[152:155], a[72:75], v[88:91], v[152:155]
    ds_read_b128 v[84:87], v7 offset:47104
    v_mfma_f32_16x16x32_bf16 v[156:159], a[76:79], v[88:91], v[156:159]
    s_waitcnt lgkmcnt(4)
    v_mfma_f32_16x16x32_bf16 v[160:163], a[72:75], v[92:95], v[160:163]
    ds_read_b128 v[88:91], v7 offset:49152
    v_mfma_f32_16x16x32_bf16 v[164:167], a[76:79], v[92:95], v[164:167]
    s_add_u32 s95, s14, 18432
    s_add_u32 m0, s92, 45056
    s_waitcnt lgkmcnt(4)
    v_mfma_f32_16x16x32_bf16 v[96:99], a[80:83], v[72:75], v[96:99]
    ds_read_b128 v[92:95], v7 offset:51200
    v_mfma_f32_16x16x32_bf16 v[100:103], a[84:87], v[72:75], v[100:103]
    buffer_load_dwordx4 v9, s[32:35], s95 offen sc1 lds
    s_waitcnt lgkmcnt(4)
    v_mfma_f32_16x16x32_bf16 v[104:107], a[80:83], v[76:79], v[104:107]
    ds_read_b128 v[72:75], v7 offset:53248
    v_mfma_f32_16x16x32_bf16 v[108:111], a[84:87], v[76:79], v[108:111]
    s_waitcnt lgkmcnt(4)
    v_mfma_f32_16x16x32_bf16 v[112:115], a[80:83], v[80:83], v[112:115]
    ds_read_b128 v[76:79], v7 offset:55296
    v_mfma_f32_16x16x32_bf16 v[116:119], a[84:87], v[80:83], v[116:119]
    s_add_u32 m0, s92, 49152
    s_waitcnt lgkmcnt(4)
    v_mfma_f32_16x16x32_bf16 v[120:123], a[80:83], v[84:87], v[120:123]
    ds_read_b128 v[80:83], v7 offset:57344
    v_mfma_f32_16x16x32_bf16 v[124:127], a[84:87], v[84:87], v[124:127]
    buffer_load_dwordx4 v10, s[32:35], s95 offen sc1 lds
    s_waitcnt lgkmcnt(4)
    v_mfma_f32_16x16x32_bf16 v[128:131], a[80:83], v[88:91], v[128:131]
    ds_read_b128 v[84:87], v7 offset:41984
    v_mfma_f32_16x16x32_bf16 v[132:135], a[84:87], v[88:91], v[132:135]
    s_waitcnt lgkmcnt(4)
    v_mfma_f32_16x16x32_bf16 v[136:139], a[80:83], v[92:95], v[136:139]
    ds_read_b128 v[88:91], v7 offset:44032
    v_mfma_f32_16x16x32_bf16 v[140:143], a[84:87], v[92:95], v[140:143]
    s_add_u32 m0, s92, 53248
    s_waitcnt lgkmcnt(4)
    v_mfma_f32_16x16x32_bf16 v[144:147], a[80:83], v[72:75], v[144:147]
    ds_read_b128 v[92:95], v7 offset:46080
    v_mfma_f32_16x16x32_bf16 v[148:151], a[84:87], v[72:75], v[148:151]
    buffer_load_dwordx4 v11, s[32:35], s95 offen sc1 lds
    s_waitcnt lgkmcnt(4)
    v_mfma_f32_16x16x32_bf16 v[152:155], a[80:83], v[76:79], v[152:155]
    ds_read_b128 v[72:75], v7 offset:48128
    v_mfma_f32_16x16x32_bf16 v[156:159], a[84:87], v[76:79], v[156:159]
    s_waitcnt lgkmcnt(4)
    v_mfma_f32_16x16x32_bf16 v[160:163], a[80:83], v[80:83], v[160:163]
    ds_read_b128 v[76:79], v7 offset:50176
    v_mfma_f32_16x16x32_bf16 v[164:167], a[84:87], v[80:83], v[164:167]
    s_add_u32 m0, s92, 57344
    s_waitcnt lgkmcnt(4)
    v_mfma_f32_16x16x32_bf16 v[96:99], a[88:91], v[84:87], v[96:99]
    ds_read_b128 v[80:83], v7 offset:52224
    v_mfma_f32_16x16x32_bf16 v[100:103], a[92:95], v[84:87], v[100:103]
    buffer_load_dwordx4 v12, s[32:35], s95 offen sc1 lds
    s_waitcnt lgkmcnt(4)
    v_mfma_f32_16x16x32_bf16 v[104:107], a[88:91], v[88:91], v[104:107]
    ds_read_b128 v[84:87], v7 offset:54272
    v_mfma_f32_16x16x32_bf16 v[108:111], a[92:95], v[88:91], v[108:111]
    s_waitcnt lgkmcnt(4)
    v_mfma_f32_16x16x32_bf16 v[112:115], a[88:91], v[92:95], v[112:115]
    ds_read_b128 v[88:91], v7 offset:56320
    v_mfma_f32_16x16x32_bf16 v[116:119], a[92:95], v[92:95], v[116:119]
    s_add_u32 m0, s92, 61440
    s_waitcnt lgkmcnt(4)
    v_mfma_f32_16x16x32_bf16 v[120:123], a[88:91], v[72:75], v[120:123]
    ds_read_b128 v[92:95], v7 offset:58368
    v_mfma_f32_16x16x32_bf16 v[124:127], a[92:95], v[72:75], v[124:127]
    buffer_load_dwordx4 v13, s[32:35], s95 offen sc1 lds
    s_waitcnt lgkmcnt(4)
    v_mfma_f32_16x16x32_bf16 v[128:131], a[88:91], v[76:79], v[128:131]
    s_waitcnt vmcnt(15)
    s_barrier
    ds_read_b128 v[72:75], v8 offset:0
    v_mfma_f32_16x16x32_bf16 v[132:135], a[92:95], v[76:79], v[132:135]
    s_waitcnt lgkmcnt(4)
    v_mfma_f32_16x16x32_bf16 v[136:139], a[88:91], v[80:83], v[136:139]
    ds_read_b128 v[76:79], v8 offset:2048
    v_mfma_f32_16x16x32_bf16 v[140:143], a[92:95], v[80:83], v[140:143]
    s_waitcnt lgkmcnt(4)
    v_mfma_f32_16x16x32_bf16 v[144:147], a[88:91], v[84:87], v[144:147]
    ds_read_b128 v[80:83], v8 offset:4096
    v_mfma_f32_16x16x32_bf16 v[148:151], a[92:95], v[84:87], v[148:151]
    s_waitcnt lgkmcnt(4)
    v_mfma_f32_16x16x32_bf16 v[152:155], a[88:91], v[88:91], v[152:155]
    ds_read_b128 v[84:87], v8 offset:6144
    v_mfma_f32_16x16x32_bf16 v[156:159], a[92:95], v[88:91], v[156:159]
    s_waitcnt lgkmcnt(4)
    v_mfma_f32_16x16x32_bf16 v[160:163], a[88:91], v[92:95], v[160:163]
    ds_read_b128 v[88:91], v8 offset:8192
    v_mfma_f32_16x16x32_bf16 v[164:167], a[92:95], v[92:95], v[164:167]
    s_waitcnt lgkmcnt(4)
    v_mfma_f32_16x16x32_bf16 v[96:99], a[96:99], v[72:75], v[96:99]
    ds_read_b128 v[92:95], v8 offset:10240
    v_mfma_f32_16x16x32_bf16 v[100:103], a[100:103], v[72:75], v[100:103]
    s_waitcnt lgkmcnt(4)
    v_mfma_f32_16x16x32_bf16 v[104:107], a[96:99], v[76:79], v[104:107]
    ds_read_b128 v[72:75], v8 offset:12288
    v_mfma_f32_16x16x32_bf16 v[108:111], a[100:103], v[76:79], v[108:111]
    s_waitcnt lgkmcnt(4)
    v_mfma_f32_16x16x32_bf16 v[112:115], a[96:99], v[80:83], v[112:115]
    ds_read_b128 v[76:79], v8 offset:14336
    v_mfma_f32_16x16x32_bf16 v[116:119], a[100:103], v[80:83], v[116:119]
    s_waitcnt lgkmcnt(4)
    v_mfma_f32_16x16x32_bf16 v[120:123], a[96:99], v[84:87], v[120:123]
    ds_read_b128 v[80:83], v8 offset:16384
    v_mfma_f32_16x16x32_bf16 v[124:127], a[100:103], v[84:87], v[124:127]
    s_waitcnt lgkmcnt(4)
    v_mfma_f32_16x16x32_bf16 v[128:131], a[96:99], v[88:91], v[128:131]
    ds_read_b128 v[84:87], v8 offset:1024
    v_mfma_f32_16x16x32_bf16 v[132:135], a[100:103], v[88:91], v[132:135]
    s_waitcnt lgkmcnt(4)
    v_mfma_f32_16x16x32_bf16 v[136:139], a[96:99], v[92:95], v[136:139]
    ds_read_b128 v[88:91], v8 offset:3072
    v_mfma_f32_16x16x32_bf16 v[140:143], a[100:103], v[92:95], v[140:143]
    s_waitcnt lgkmcnt(4)
    v_mfma_f32_16x16x32_bf16 v[144:147], a[96:99], v[72:75], v[144:147]
    ds_read_b128 v[92:95], v8 offset:5120
    v_mfma_f32_16x16x32_bf16 v[148:151], a[100:103], v[72:75], v[148:151]
    s_waitcnt lgkmcnt(4)
    v_mfma_f32_16x16x32_bf16 v[152:155], a[96:99], v[76:79], v[152:155]
    ds_read_b128 v[72:75], v8 offset:7168
    v_mfma_f32_16x16x32_bf16 v[156:159], a[100:103], v[76:79], v[156:159]
    s_waitcnt lgkmcnt(4)
    v_mfma_f32_16x16x32_bf16 v[160:163], a[96:99], v[80:83], v[160:163]
    ds_read_b128 v[76:79], v8 offset:9216
    v_mfma_f32_16x16x32_bf16 v[164:167], a[100:103], v[80:83], v[164:167]
    s_waitcnt lgkmcnt(4)
    v_mfma_f32_16x16x32_bf16 v[96:99], a[104:107], v[84:87], v[96:99]
    ds_read_b128 v[80:83], v8 offset:11264
    v_mfma_f32_16x16x32_bf16 v[100:103], a[108:111], v[84:87], v[100:103]
    s_waitcnt lgkmcnt(4)
    v_mfma_f32_16x16x32_bf16 v[104:107], a[104:107], v[88:91], v[104:107]
    ds_read_b128 v[84:87], v8 offset:13312
    v_mfma_f32_16x16x32_bf16 v[108:111], a[108:111], v[88:91], v[108:111]
    s_waitcnt lgkmcnt(4)
    v_mfma_f32_16x16x32_bf16 v[112:115], a[104:107], v[92:95], v[112:115]
    ds_read_b128 v[88:91], v8 offset:15360
    v_mfma_f32_16x16x32_bf16 v[116:119], a[108:111], v[92:95], v[116:119]
    s_waitcnt lgkmcnt(4)
    v_mfma_f32_16x16x32_bf16 v[120:123], a[104:107], v[72:75], v[120:123]
    ds_read_b128 v[92:95], v8 offset:17408
    v_mfma_f32_16x16x32_bf16 v[124:127], a[108:111], v[72:75], v[124:127]
    s_waitcnt lgkmcnt(4)
    v_mfma_f32_16x16x32_bf16 v[128:131], a[104:107], v[76:79], v[128:131]
    s_waitcnt vmcnt(10)
    s_barrier
    ds_read_b128 v[72:75], v6 offset:0
    v_mfma_f32_16x16x32_bf16 v[132:135], a[108:111], v[76:79], v[132:135]
    s_waitcnt lgkmcnt(4)
    v_mfma_f32_16x16x32_bf16 v[136:139], a[104:107], v[80:83], v[136:139]
    ds_read_b128 v[76:79], v6 offset:2048
    v_mfma_f32_16x16x32_bf16 v[140:143], a[108:111], v[80:83], v[140:143]
    s_waitcnt lgkmcnt(4)
    v_mfma_f32_16x16x32_bf16 v[144:147], a[104:107], v[84:87], v[144:147]
    ds_read_b128 v[80:83], v6 offset:4096
    v_mfma_f32_16x16x32_bf16 v[148:151], a[108:111], v[84:87], v[148:151]
    s_waitcnt lgkmcnt(4)
    v_mfma_f32_16x16x32_bf16 v[152:155], a[104:107], v[88:91], v[152:155]
    ds_read_b128 v[84:87], v6 offset:6144
    v_mfma_f32_16x16x32_bf16 v[156:159], a[108:111], v[88:91], v[156:159]
    s_waitcnt lgkmcnt(4)
    v_mfma_f32_16x16x32_bf16 v[160:163], a[104:107], v[92:95], v[160:163]
    ds_read_b128 v[88:91], v6 offset:8192
    v_mfma_f32_16x16x32_bf16 v[164:167], a[108:111], v[92:95], v[164:167]
    s_waitcnt lgkmcnt(4)
    v_mfma_f32_16x16x32_bf16 v[96:99], a[112:115], v[72:75], v[96:99]
    ds_read_b128 v[92:95], v6 offset:10240
    v_mfma_f32_16x16x32_bf16 v[100:103], a[116:119], v[72:75], v[100:103]
    s_waitcnt lgkmcnt(4)
    v_mfma_f32_16x16x32_bf16 v[104:107], a[112:115], v[76:79], v[104:107]
    ds_read_b128 v[72:75], v6 offset:12288
    v_mfma_f32_16x16x32_bf16 v[108:111], a[116:119], v[76:79], v[108:111]
    s_waitcnt lgkmcnt(4)
    v_mfma_f32_16x16x32_bf16 v[112:115], a[112:115], v[80:83], v[112:115]
    ds_read_b128 v[76:79], v6 offset:14336
    v_mfma_f32_16x16x32_bf16 v[116:119], a[116:119], v[80:83], v[116:119]
    s_lshl_b32 s88, s10, 3
    s_add_u32 s88, s88, 1
    s_mul_i32 s88, s88, 640
    s_add_u32 s88, s88, 18432
    v_lshrrev_b32 v22, 4, v0
    v_mul_u32_u24 v22, 640, v22
    v_lshl_add_u32 v22, v2, 3, v22
    v_mov_b32 v60, v22
    s_mov_b32 s85, s88
    buffer_load_dwordx2 v[48:49], v22, s[40:43], s88 offen offset:0 sc1
    buffer_load_dwordx2 v[50:51], v22, s[40:43], s88 offen offset:128 sc1
    buffer_load_dwordx2 v[52:53], v22, s[40:43], s88 offen offset:256 sc1
    buffer_load_dwordx2 v[54:55], v22, s[40:43], s88 offen offset:384 sc1
    buffer_load_dwordx2 v[56:57], v22, s[40:43], s88 offen offset:512 sc1
    s_waitcnt lgkmcnt(4)
    v_mfma_f32_16x16x32_bf16 v[120:123], a[112:115], v[84:87], v[120:123]
    ds_read_b128 v[80:83], v6 offset:16384
    v_mfma_f32_16x16x32_bf16 v[124:127], a[116:119], v[84:87], v[124:127]
    s_waitcnt lgkmcnt(4)
    v_mfma_f32_16x16x32_bf16 v[128:131], a[112:115], v[88:91], v[128:131]
    ds_read_b128 v[84:87], v6 offset:1024
    v_mfma_f32_16x16x32_bf16 v[132:135], a[116:119], v[88:91], v[132:135]
    s_waitcnt lgkmcnt(4)
    v_mfma_f32_16x16x32_bf16 v[136:139], a[112:115], v[92:95], v[136:139]
    ds_read_b128 v[88:91], v6 offset:3072
    v_mfma_f32_16x16x32_bf16 v[140:143], a[116:119], v[92:95], v[140:143]
    s_waitcnt lgkmcnt(4)
    v_mfma_f32_16x16x32_bf16 v[144:147], a[112:115], v[72:75], v[144:147]
    ds_read_b128 v[92:95], v6 offset:5120
    v_mfma_f32_16x16x32_bf16 v[148:151], a[116:119], v[72:75], v[148:151]
    s_waitcnt lgkmcnt(4)
    v_mfma_f32_16x16x32_bf16 v[152:155], a[112:115], v[76:79], v[152:155]
    ds_read_b128 v[72:75], v6 offset:7168
    v_mfma_f32_16x16x32_bf16 v[156:159], a[116:119], v[76:79], v[156:159]
    s_waitcnt lgkmcnt(4)
    v_mfma_f32_16x16x32_bf16 v[160:163], a[112:115], v[80:83], v[160:163]
    ds_read_b128 v[76:79], v6 offset:9216
    v_mfma_f32_16x16x32_bf16 v[164:167], a[116:119], v[80:83], v[164:167]
    s_waitcnt lgkmcnt(4)
    v_mfma_f32_16x16x32_bf16 v[96:99], a[120:123], v[84:87], v[96:99]
    ds_read_b128 v[80:83], v6 offset:11264
    v_mfma_f32_16x16x32_bf16 v[100:103], a[124:127], v[84:87], v[100:103]
    s_waitcnt lgkmcnt(4)
    v_mfma_f32_16x16x32_bf16 v[104:107], a[120:123], v[88:91], v[104:107]
    ds_read_b128 v[84:87], v6 offset:13312
    v_mfma_f32_16x16x32_bf16 v[108:111], a[124:127], v[88:91], v[108:111]
    s_waitcnt lgkmcnt(4)
    v_mfma_f32_16x16x32_bf16 v[112:115], a[120:123], v[92:95], v[112:115]
    ds_read_b128 v[88:91], v6 offset:15360
    v_mfma_f32_16x16x32_bf16 v[116:119], a[124:127], v[92:95], v[116:119]
    s_waitcnt lgkmcnt(4)
    v_mfma_f32_16x16x32_bf16 v[120:123], a[120:123], v[72:75], v[120:123]
    ds_read_b128 v[92:95], v6 offset:17408
    v_mfma_f32_16x16x32_bf16 v[124:127], a[124:127], v[72:75], v[124:127]
    s_waitcnt lgkmcnt(4)
    v_mfma_f32_16x16x32_bf16 v[128:131], a[120:123], v[76:79], v[128:131]
    s_waitcnt vmcnt(10)
    s_barrier
    ds_read_b128 v[72:75], v6 offset:20480
    v_mfma_f32_16x16x32_bf16 v[132:135], a[124:127], v[76:79], v[132:135]
    s_waitcnt lgkmcnt(4)
    v_mfma_f32_16x16x32_bf16 v[136:139], a[120:123], v[80:83], v[136:139]
    ds_read_b128 v[76:79], v6 offset:22528
    v_mfma_f32_16x16x32_bf16 v[140:143], a[124:127], v[80:83], v[140:143]
    s_waitcnt lgkmcnt(4)
    v_mfma_f32_16x16x32_bf16 v[144:147], a[120:123], v[84:87], v[144:147]
    ds_read_b128 v[80:83], v6 offset:24576
    v_mfma_f32_16x16x32_bf16 v[148:151], a[124:127], v[84:87], v[148:151]
    s_waitcnt lgkmcnt(4)
    v_mfma_f32_16x16x32_bf16 v[152:155], a[120:123], v[88:91], v[152:155]
    ds_read_b128 v[84:87], v6 offset:26624
    v_mfma_f32_16x16x32_bf16 v[156:159], a[124:127], v[88:91], v[156:159]
    s_waitcnt lgkmcnt(4)
    v_mfma_f32_16x16x32_bf16 v[160:163], a[120:123], v[92:95], v[160:163]
    ds_read_b128 v[88:91], v6 offset:28672
    v_mfma_f32_16x16x32_bf16 v[164:167], a[124:127], v[92:95], v[164:167]
    s_waitcnt lgkmcnt(4)
    v_mfma_f32_16x16x32_bf16 v[96:99], a[128:131], v[72:75], v[96:99]
    ds_read_b128 v[92:95], v6 offset:30720
    v_mfma_f32_16x16x32_bf16 v[100:103], a[132:135], v[72:75], v[100:103]
    s_waitcnt lgkmcnt(4)
    v_mfma_f32_16x16x32_bf16 v[104:107], a[128:131], v[76:79], v[104:107]
    ds_read_b128 v[72:75], v6 offset:32768
    v_mfma_f32_16x16x32_bf16 v[108:111], a[132:135], v[76:79], v[108:111]
    s_waitcnt lgkmcnt(4)
    v_mfma_f32_16x16x32_bf16 v[112:115], a[128:131], v[80:83], v[112:115]
    ds_read_b128 v[76:79], v6 offset:34816
    v_mfma_f32_16x16x32_bf16 v[116:119], a[132:135], v[80:83], v[116:119]
    s_waitcnt lgkmcnt(4)
    v_mfma_f32_16x16x32_bf16 v[120:123], a[128:131], v[84:87], v[120:123]
    ds_read_b128 v[80:83], v6 offset:36864
    v_mfma_f32_16x16x32_bf16 v[124:127], a[132:135], v[84:87], v[124:127]
    s_waitcnt lgkmcnt(4)
    v_mfma_f32_16x16x32_bf16 v[128:131], a[128:131], v[88:91], v[128:131]
    ds_read_b128 v[84:87], v6 offset:21504
    v_mfma_f32_16x16x32_bf16 v[132:135], a[132:135], v[88:91], v[132:135]
    s_waitcnt lgkmcnt(4)
    v_mfma_f32_16x16x32_bf16 v[136:139], a[128:131], v[92:95], v[136:139]
    ds_read_b128 v[88:91], v6 offset:23552
    v_mfma_f32_16x16x32_bf16 v[140:143], a[132:135], v[92:95], v[140:143]
    s_waitcnt lgkmcnt(4)
    v_mfma_f32_16x16x32_bf16 v[144:147], a[128:131], v[72:75], v[144:147]
    ds_read_b128 v[92:95], v6 offset:25600
    v_mfma_f32_16x16x32_bf16 v[148:151], a[132:135], v[72:75], v[148:151]
    s_waitcnt lgkmcnt(4)
    v_mfma_f32_16x16x32_bf16 v[152:155], a[128:131], v[76:79], v[152:155]
    ds_read_b128 v[72:75], v6 offset:27648
    v_mfma_f32_16x16x32_bf16 v[156:159], a[132:135], v[76:79], v[156:159]
    s_waitcnt lgkmcnt(4)
    v_mfma_f32_16x16x32_bf16 v[160:163], a[128:131], v[80:83], v[160:163]
    ds_read_b128 v[76:79], v6 offset:29696
    v_mfma_f32_16x16x32_bf16 v[164:167], a[132:135], v[80:83], v[164:167]
    s_waitcnt lgkmcnt(4)
    v_mfma_f32_16x16x32_bf16 v[96:99], a[136:139], v[84:87], v[96:99]
    ds_read_b128 v[80:83], v6 offset:31744
    v_mfma_f32_16x16x32_bf16 v[100:103], a[140:143], v[84:87], v[100:103]
    s_waitcnt lgkmcnt(4)
    v_mfma_f32_16x16x32_bf16 v[104:107], a[136:139], v[88:91], v[104:107]
    ds_read_b128 v[84:87], v6 offset:33792
    v_mfma_f32_16x16x32_bf16 v[108:111], a[140:143], v[88:91], v[108:111]
    s_waitcnt lgkmcnt(4)
    v_mfma_f32_16x16x32_bf16 v[112:115], a[136:139], v[92:95], v[112:115]
    ds_read_b128 v[88:91], v6 offset:35840
    v_mfma_f32_16x16x32_bf16 v[116:119], a[140:143], v[92:95], v[116:119]
    s_waitcnt lgkmcnt(4)
    v_mfma_f32_16x16x32_bf16 v[120:123], a[136:139], v[72:75], v[120:123]
    ds_read_b128 v[92:95], v6 offset:37888
    v_mfma_f32_16x16x32_bf16 v[124:127], a[140:143], v[72:75], v[124:127]
    s_waitcnt lgkmcnt(4)
    v_mfma_f32_16x16x32_bf16 v[128:131], a[136:139], v[76:79], v[128:131]
    s_waitcnt vmcnt(5)
    s_barrier
    ds_read_b128 v[72:75], v6 offset:40960
    v_mfma_f32_16x16x32_bf16 v[132:135], a[140:143], v[76:79], v[132:135]
    s_waitcnt lgkmcnt(4)
    v_mfma_f32_16x16x32_bf16 v[136:139], a[136:139], v[80:83], v[136:139]
    ds_read_b128 v[76:79], v6 offset:43008
    v_mfma_f32_16x16x32_bf16 v[140:143], a[140:143], v[80:83], v[140:143]
    s_waitcnt lgkmcnt(4)
    v_mfma_f32_16x16x32_bf16 v[144:147], a[136:139], v[84:87], v[144:147]
    ds_read_b128 v[80:83], v6 offset:45056
    v_mfma_f32_16x16x32_bf16 v[148:151], a[140:143], v[84:87], v[148:151]
    s_waitcnt lgkmcnt(4)
    v_mfma_f32_16x16x32_bf16 v[152:155], a[136:139], v[88:91], v[152:155]
    ds_read_b128 v[84:87], v6 offset:47104
    v_mfma_f32_16x16x32_bf16 v[156:159], a[140:143], v[88:91], v[156:159]
    s_waitcnt lgkmcnt(4)
    v_mfma_f32_16x16x32_bf16 v[160:163], a[136:139], v[92:95], v[160:163]
    ds_read_b128 v[88:91], v6 offset:49152
    v_mfma_f32_16x16x32_bf16 v[164:167], a[140:143], v[92:95], v[164:167]
    s_waitcnt lgkmcnt(4)
    v_mfma_f32_16x16x32_bf16 v[96:99], a[144:147], v[72:75], v[96:99]
    ds_read_b128 v[92:95], v6 offset:51200
    v_mfma_f32_16x16x32_bf16 v[100:103], a[148:151], v[72:75], v[100:103]
    s_waitcnt lgkmcnt(4)
    v_mfma_f32_16x16x32_bf16 v[104:107], a[144:147], v[76:79], v[104:107]
    ds_read_b128 v[72:75], v6 offset:53248
    v_mfma_f32_16x16x32_bf16 v[108:111], a[148:151], v[76:79], v[108:111]
    s_waitcnt lgkmcnt(4)
    v_mfma_f32_16x16x32_bf16 v[112:115], a[144:147], v[80:83], v[112:115]
    ds_read_b128 v[76:79], v6 offset:55296
    v_mfma_f32_16x16x32_bf16 v[116:119], a[148:151], v[80:83], v[116:119]
    s_waitcnt lgkmcnt(4)
    v_mfma_f32_16x16x32_bf16 v[120:123], a[144:147], v[84:87], v[120:123]
    ds_read_b128 v[80:83], v6 offset:57344
    v_mfma_f32_16x16x32_bf16 v[124:127], a[148:151], v[84:87], v[124:127]
    s_waitcnt lgkmcnt(4)
    v_mfma_f32_16x16x32_bf16 v[128:131], a[144:147], v[88:91], v[128:131]
    ds_read_b128 v[84:87], v6 offset:41984
    v_mfma_f32_16x16x32_bf16 v[132:135], a[148:151], v[88:91], v[132:135]
    s_waitcnt lgkmcnt(4)
    v_mfma_f32_16x16x32_bf16 v[136:139], a[144:147], v[92:95], v[136:139]
    ds_read_b128 v[88:91], v6 offset:44032
    v_mfma_f32_16x16x32_bf16 v[140:143], a[148:151], v[92:95], v[140:143]
    s_waitcnt lgkmcnt(4)
    v_mfma_f32_16x16x32_bf16 v[144:147], a[144:147], v[72:75], v[144:147]
    ds_read_b128 v[92:95], v6 offset:46080
    v_mfma_f32_16x16x32_bf16 v[148:151], a[148:151], v[72:75], v[148:151]
    s_waitcnt lgkmcnt(4)
    v_mfma_f32_16x16x32_bf16 v[152:155], a[144:147], v[76:79], v[152:155]
    ds_read_b128 v[72:75], v6 offset:48128
    v_mfma_f32_16x16x32_bf16 v[156:159], a[148:151], v[76:79], v[156:159]
    s_waitcnt lgkmcnt(4)
    v_mfma_f32_16x16x32_bf16 v[160:163], a[144:147], v[80:83], v[160:163]
    ds_read_b128 v[76:79], v6 offset:50176
    v_mfma_f32_16x16x32_bf16 v[164:167], a[148:151], v[80:83], v[164:167]
    s_waitcnt lgkmcnt(4)
    v_mfma_f32_16x16x32_bf16 v[96:99], a[152:155], v[84:87], v[96:99]
    ds_read_b128 v[80:83], v6 offset:52224
    v_mfma_f32_16x16x32_bf16 v[100:103], a[156:159], v[84:87], v[100:103]
    s_waitcnt lgkmcnt(4)
    v_mfma_f32_16x16x32_bf16 v[104:107], a[152:155], v[88:91], v[104:107]
    ds_read_b128 v[84:87], v6 offset:54272
    v_mfma_f32_16x16x32_bf16 v[108:111], a[156:159], v[88:91], v[108:111]
    s_waitcnt lgkmcnt(4)
    v_mfma_f32_16x16x32_bf16 v[112:115], a[152:155], v[92:95], v[112:115]
    ds_read_b128 v[88:91], v6 offset:56320
    v_mfma_f32_16x16x32_bf16 v[116:119], a[156:159], v[92:95], v[116:119]
    s_waitcnt lgkmcnt(4)
    v_mfma_f32_16x16x32_bf16 v[120:123], a[152:155], v[72:75], v[120:123]
    ds_read_b128 v[92:95], v6 offset:58368
    v_mfma_f32_16x16x32_bf16 v[124:127], a[156:159], v[72:75], v[124:127]
    s_waitcnt lgkmcnt(4)
    v_mfma_f32_16x16x32_bf16 v[128:131], a[152:155], v[76:79], v[128:131]
    v_mfma_f32_16x16x32_bf16 v[132:135], a[156:159], v[76:79], v[132:135]
    s_waitcnt lgkmcnt(3)
    v_mfma_f32_16x16x32_bf16 v[136:139], a[152:155], v[80:83], v[136:139]
    v_mfma_f32_16x16x32_bf16 v[140:143], a[156:159], v[80:83], v[140:143]
    s_waitcnt lgkmcnt(2)
    v_mfma_f32_16x16x32_bf16 v[144:147], a[152:155], v[84:87], v[144:147]
    v_mfma_f32_16x16x32_bf16 v[148:151], a[156:159], v[84:87], v[148:151]
    s_waitcnt lgkmcnt(1)
    v_mfma_f32_16x16x32_bf16 v[152:155], a[152:155], v[88:91], v[152:155]
    v_mfma_f32_16x16x32_bf16 v[156:159], a[156:159], v[88:91], v[156:159]
    s_waitcnt lgkmcnt(0)
    v_mfma_f32_16x16x32_bf16 v[160:163], a[152:155], v[92:95], v[160:163]
    v_mfma_f32_16x16x32_bf16 v[164:167], a[156:159], v[92:95], v[164:167]
    s_waitcnt vmcnt(3)
    v_and_b32 v58, v49, v51
    s_waitcnt vmcnt(1)
    v_and_b32 v59, v53, v55
    s_waitcnt vmcnt(0)
    v_and_b32 v58, v58, v57
    v_and_b32 v58, v58, v59
    v_cmp_gt_u32 vcc, 144, v0
    s_nop 1
    s_mov_b64 s[86:87], vcc
    v_cmp_le_i32 vcc, 0, v58
    s_nop 0
    s_and_b64 vcc, vcc, s[86:87]
    s_cbranch_vccnz CL_p3_slow_27
CL_p3_back_28:
    v_and_b32 v49, 0x7fffffff, v49
    v_and_b32 v51, 0x7fffffff, v51
    v_and_b32 v53, 0x7fffffff, v53
    v_and_b32 v55, 0x7fffffff, v55
    v_and_b32 v57, 0x7fffffff, v57
    v_pk_add_f32 v[48:49], v[48:49], v[50:51]
    v_pk_add_f32 v[48:49], v[48:49], v[52:53]
    v_pk_add_f32 v[48:49], v[48:49], v[54:55]
    v_pk_add_f32 v[48:49], v[48:49], v[56:57]
    s_mov_b32 s88, 0x3acccccd
    v_mul_f32 v48, s88, v48
    v_mul_f32 v49, s88, v49
    v_fma_f32 v49, -v48, v48, v49
    v_max_f32 v49, 0, v49
    v_add_f32 v49, 0x3727c5ac, v49
    v_rsq_f32 v50, v49
    s_nop 0
    v_mul_f32 v51, v48, v50
    v_sub_f32 v51, 0, v51
    v_lshlrev_b32 v22, 3, v0
    v_cmp_gt_u32 vcc, 160, v0
    s_nop 0
    s_and_saveexec_b64 s[86:87], vcc
    ds_write_b64 v22, v[50:51] offset:0
    s_mov_b64 exec, s[86:87]
    s_waitcnt lgkmcnt(0)
    s_barrier
    v_mov_b32 v48, 0
    v_mov_b32 v49, 0
    v_mov_b32 v50, 0
    v_mov_b32 v51, 0
    v_mul_u32_u24 v22, 80, v0
    ds_write_b128 v22, v[48:51] offset:4144
    v_cmp_gt_u32 vcc, 64, v0
    s_nop 0
    s_and_saveexec_b64 s[86:87], vcc
    ds_write_b128 v22, v[48:51] offset:24624
    s_mov_b64 exec, s[86:87]
    v_lshlrev_b32 v22, 3, v2
    ds_read_b64 v[52:53], v22 offset:0
    ds_read_b64 v[54:55], v22 offset:128
    ds_read_b64 v[56:57], v22 offset:256
    ds_read_b64 v[58:59], v22 offset:384
    ds_read_b64 v[60:61], v22 offset:512
    ds_read_b64 v[62:63], v22 offset:640
    ds_read_b64 v[64:65], v22 offset:768
    ds_read_b64 v[66:67], v22 offset:896
    ds_read_b64 v[68:69], v22 offset:1024
    s_waitcnt lgkmcnt(8)
    v_pk_mul_f32 v[72:73], v[28:29], v[52:53] op_sel:[0,1] op_sel_hi:[1,1]
    v_pk_mul_f32 v[78:79], v[32:33], v[52:53] op_sel:[0,1] op_sel_hi:[1,1]
    s_waitcnt lgkmcnt(7)
    v_pk_mul_f32 v[84:85], v[28:29], v[54:55] op_sel:[0,1] op_sel_hi:[1,1]
    v_pk_mul_f32 v[90:91], v[32:33], v[54:55] op_sel:[0,1] op_sel_hi:[1,1]
    v_pk_mul_f32 v[74:75], v[30:31], v[52:53] op_sel:[0,1] op_sel_hi:[1,1]
    v_pk_mul_f32 v[80:81], v[34:35], v[52:53] op_sel:[0,1] op_sel_hi:[1,1]
    v_pk_mul_f32 v[86:87], v[30:31], v[54:55] op_sel:[0,1] op_sel_hi:[1,1]
    v_pk_mul_f32 v[92:93], v[34:35], v[54:55] op_sel:[0,1] op_sel_hi:[1,1]
    v_pk_fma_f32 v[72:73], v[96:97], v[52:53], v[72:73] op_sel:[0,0,0] op_sel_hi:[1,0,1]
    v_pk_fma_f32 v[78:79], v[100:101], v[52:53], v[78:79] op_sel:[0,0,0] op_sel_hi:[1,0,1]
    v_pk_fma_f32 v[84:85], v[104:105], v[54:55], v[84:85] op_sel:[0,0,0] op_sel_hi:[1,0,1]
    v_pk_fma_f32 v[90:91], v[108:109], v[54:55], v[90:91] op_sel:[0,0,0] op_sel_hi:[1,0,1]
    v_pk_fma_f32 v[74:75], v[98:99], v[52:53], v[74:75] op_sel:[0,0,0] op_sel_hi:[1,0,1]
    v_pk_fma_f32 v[80:81], v[102:103], v[52:53], v[80:81] op_sel:[0,0,0] op_sel_hi:[1,0,1]
    v_pk_fma_f32 v[86:87], v[106:107], v[54:55], v[86:87] op_sel:[0,0,0] op_sel_hi:[1,0,1]
    v_pk_fma_f32 v[92:93], v[110:111], v[54:55], v[92:93] op_sel:[0,0,0] op_sel_hi:[1,0,1]
    v_cvt_pk_bf16_f32 v76, v72, v73
    v_cvt_pk_bf16_f32 v82, v78, v79
    v_cvt_pk_bf16_f32 v88, v84, v85
    v_cvt_pk_bf16_f32 v94, v90, v91
    v_cvt_pk_bf16_f32 v77, v74, v75
    v_cvt_pk_bf16_f32 v83, v80, v81
    v_cvt_pk_bf16_f32 v89, v86, v87
    v_cvt_pk_bf16_f32 v95, v92, v93
    ds_write_b64 v14, v[76:77] offset:0
    ds_write_b64 v15, v[82:83] offset:0
    ds_write_b64 v14, v[88:89] offset:1280
    ds_write_b64 v15, v[94:95] offset:1280
    s_waitcnt lgkmcnt(10)
    v_pk_mul_f32 v[72:73], v[28:29], v[56:57] op_sel:[0,1] op_sel_hi:[1,1]
    v_pk_mul_f32 v[78:79], v[32:33], v[56:57] op_sel:[0,1] op_sel_hi:[1,1]
    s_waitcnt lgkmcnt(9)
    v_pk_mul_f32 v[84:85], v[28:29], v[58:59] op_sel:[0,1] op_sel_hi:[1,1]
    v_pk_mul_f32 v[90:91], v[32:33], v[58:59] op_sel:[0,1] op_sel_hi:[1,1]
    v_pk_mul_f32 v[74:75], v[30:31], v[56:57] op_sel:[0,1] op_sel_hi:[1,1]
    v_pk_mul_f32 v[80:81], v[34:35], v[56:57] op_sel:[0,1] op_sel_hi:[1,1]
    v_pk_mul_f32 v[86:87], v[30:31], v[58:59] op_sel:[0,1] op_sel_hi:[1,1]
    v_pk_mul_f32 v[92:93], v[34:35], v[58:59] op_sel:[0,1] op_sel_hi:[1,1]
    v_pk_fma_f32 v[72:73], v[112:113], v[56:57], v[72:73] op_sel:[0,0,0] op_sel_hi:[1,0,1]
    v_pk_fma_f32 v[78:79], v[116:117], v[56:57], v[78:79] op_sel:[0,0,0] op_sel_hi:[1,0,1]
    v_pk_fma_f32 v[84:85], v[120:121], v[58:59], v[84:85] op_sel:[0,0,0] op_sel_hi:[1,0,1]
    v_pk_fma_f32 v[90:91], v[124:125], v[58:59], v[90:91] op_sel:[0,0,0] op_sel_hi:[1,0,1]
    v_pk_fma_f32 v[74:75], v[114:115], v[56:57], v[74:75] op_sel:[0,0,0] op_sel_hi:[1,0,1]
    v_pk_fma_f32 v[80:81], v[118:119], v[56:57], v[80:81] op_sel:[0,0,0] op_sel_hi:[1,0,1]
    v_pk_fma_f32 v[86:87], v[122:123], v[58:59], v[86:87] op_sel:[0,0,0] op_sel_hi:[1,0,1]
    v_pk_fma_f32 v[92:93], v[126:127], v[58:59], v[92:93] op_sel:[0,0,0] op_sel_hi:[1,0,1]
    v_cvt_pk_bf16_f32 v76, v72, v73
    v_cvt_pk_bf16_f32 v82, v78, v79
    v_cvt_pk_bf16_f32 v88, v84, v85
    v_cvt_pk_bf16_f32 v94, v90, v91
    v_cvt_pk_bf16_f32 v77, v74, v75
    v_cvt_pk_bf16_f32 v83, v80, v81
    v_cvt_pk_bf16_f32 v89, v86, v87
    v_cvt_pk_bf16_f32 v95, v92, v93
    ds_write_b64 v14, v[76:77] offset:2560
    ds_write_b64 v15, v[82:83] offset:2560
    ds_write_b64 v14, v[88:89] offset:3840
    ds_write_b64 v15, v[94:95] offset:3840
    s_waitcnt lgkmcnt(12)
    v_pk_mul_f32 v[72:73], v[28:29], v[60:61] op_sel:[0,1] op_sel_hi:[1,1]
    v_pk_mul_f32 v[78:79], v[32:33], v[60:61] op_sel:[0,1] op_sel_hi:[1,1]
    s_waitcnt lgkmcnt(11)
    v_pk_mul_f32 v[84:85], v[28:29], v[62:63] op_sel:[0,1] op_sel_hi:[1,1]
    v_pk_mul_f32 v[90:91], v[32:33], v[62:63] op_sel:[0,1] op_sel_hi:[1,1]
    v_pk_mul_f32 v[74:75], v[30:31], v[60:61] op_sel:[0,1] op_sel_hi:[1,1]
    v_pk_mul_f32 v[80:81], v[34:35], v[60:61] op_sel:[0,1] op_sel_hi:[1,1]
    v_pk_mul_f32 v[86:87], v[30:31], v[62:63] op_sel:[0,1] op_sel_hi:[1,1]
    v_pk_mul_f32 v[92:93], v[34:35], v[62:63] op_sel:[0,1] op_sel_hi:[1,1]
    v_pk_fma_f32 v[72:73], v[128:129], v[60:61], v[72:73] op_sel:[0,0,0] op_sel_hi:[1,0,1]
    v_pk_fma_f32 v[78:79], v[132:133], v[60:61], v[78:79] op_sel:[0,0,0] op_sel_hi:[1,0,1]
    v_pk_fma_f32 v[84:85], v[136:137], v[62:63], v[84:85] op_sel:[0,0,0] op_sel_hi:[1,0,1]
    v_pk_fma_f32 v[90:91], v[140:141], v[62:63], v[90:91] op_sel:[0,0,0] op_sel_hi:[1,0,1]
    v_pk_fma_f32 v[74:75], v[130:131], v[60:61], v[74:75] op_sel:[0,0,0] op_sel_hi:[1,0,1]
    v_pk_fma_f32 v[80:81], v[134:135], v[60:61], v[80:81] op_sel:[0,0,0] op_sel_hi:[1,0,1]
    v_pk_fma_f32 v[86:87], v[138:139], v[62:63], v[86:87] op_sel:[0,0,0] op_sel_hi:[1,0,1]
    v_pk_fma_f32 v[92:93], v[142:143], v[62:63], v[92:93] op_sel:[0,0,0] op_sel_hi:[1,0,1]
    v_cvt_pk_bf16_f32 v76, v72, v73
    v_cvt_pk_bf16_f32 v82, v78, v79
    v_cvt_pk_bf16_f32 v88, v84, v85
    v_cvt_pk_bf16_f32 v94, v90, v91
    v_cvt_pk_bf16_f32 v77, v74, v75
    v_cvt_pk_bf16_f32 v83, v80, v81
    v_cvt_pk_bf16_f32 v89, v86, v87
    v_cvt_pk_bf16_f32 v95, v92, v93
    ds_write_b64 v14, v[76:77] offset:5120
    ds_write_b64 v15, v[82:83] offset:5120
    ds_write_b64 v14, v[88:89] offset:6400
    ds_write_b64 v15, v[94:95] offset:6400
    s_waitcnt lgkmcnt(14)
    v_pk_mul_f32 v[72:73], v[28:29], v[64:65] op_sel:[0,1] op_sel_hi:[1,1]
    v_pk_mul_f32 v[78:79], v[32:33], v[64:65] op_sel:[0,1] op_sel_hi:[1,1]
    s_waitcnt lgkmcnt(13)
    v_pk_mul_f32 v[84:85], v[28:29], v[66:67] op_sel:[0,1] op_sel_hi:[1,1]
    v_pk_mul_f32 v[90:91], v[32:33], v[66:67] op_sel:[0,1] op_sel_hi:[1,1]
    v_pk_mul_f32 v[74:75], v[30:31], v[64:65] op_sel:[0,1] op_sel_hi:[1,1]
    v_pk_mul_f32 v[80:81], v[34:35], v[64:65] op_sel:[0,1] op_sel_hi:[1,1]
    v_pk_mul_f32 v[86:87], v[30:31], v[66:67] op_sel:[0,1] op_sel_hi:[1,1]
    v_pk_mul_f32 v[92:93], v[34:35], v[66:67] op_sel:[0,1] op_sel_hi:[1,1]
    v_pk_fma_f32 v[72:73], v[144:145], v[64:65], v[72:73] op_sel:[0,0,0] op_sel_hi:[1,0,1]
    v_pk_fma_f32 v[78:79], v[148:149], v[64:65], v[78:79] op_sel:[0,0,0] op_sel_hi:[1,0,1]
    v_pk_fma_f32 v[84:85], v[152:153], v[66:67], v[84:85] op_sel:[0,0,0] op_sel_hi:[1,0,1]
    v_pk_fma_f32 v[90:91], v[156:157], v[66:67], v[90:91] op_sel:[0,0,0] op_sel_hi:[1,0,1]
    v_pk_fma_f32 v[74:75], v[146:147], v[64:65], v[74:75] op_sel:[0,0,0] op_sel_hi:[1,0,1]
    v_pk_fma_f32 v[80:81], v[150:151], v[64:65], v[80:81] op_sel:[0,0,0] op_sel_hi:[1,0,1]
    v_pk_fma_f32 v[86:87], v[154:155], v[66:67], v[86:87] op_sel:[0,0,0] op_sel_hi:[1,0,1]
    v_pk_fma_f32 v[92:93], v[158:159], v[66:67], v[92:93] op_sel:[0,0,0] op_sel_hi:[1,0,1]
    v_cvt_pk_bf16_f32 v76, v72, v73
    v_cvt_pk_bf16_f32 v82, v78, v79
    v_cvt_pk_bf16_f32 v88, v84, v85
    v_cvt_pk_bf16_f32 v94, v90, v91
    v_cvt_pk_bf16_f32 v77, v74, v75
    v_cvt_pk_bf16_f32 v83, v80, v81
    v_cvt_pk_bf16_f32 v89, v86, v87
    v_cvt_pk_bf16_f32 v95, v92, v93
    ds_write_b64 v14, v[76:77] offset:7680
    ds_write_b64 v15, v[82:83] offset:7680
    ds_write_b64 v14, v[88:89] offset:8960
    ds_write_b64 v15, v[94:95] offset:8960
    s_waitcnt lgkmcnt(15)
    v_pk_mul_f32 v[72:73], v[28:29], v[68:69] op_sel:[0,1] op_sel_hi:[1,1]
    v_pk_mul_f32 v[78:79], v[32:33], v[68:69] op_sel:[0,1] op_sel_hi:[1,1]
    v_pk_mul_f32 v[74:75], v[30:31], v[68:69] op_sel:[0,1] op_sel_hi:[1,1]
    v_pk_mul_f32 v[80:81], v[34:35], v[68:69] op_sel:[0,1] op_sel_hi:[1,1]
    v_pk_fma_f32 v[72:73], v[160:161], v[68:69], v[72:73] op_sel:[0,0,0] op_sel_hi:[1,0,1]
    v_pk_fma_f32 v[78:79], v[164:165], v[68:69], v[78:79] op_sel:[0,0,0] op_sel_hi:[1,0,1]
    v_pk_fma_f32 v[74:75], v[162:163], v[68:69], v[74:75] op_sel:[0,0,0] op_sel_hi:[1,0,1]
    v_pk_fma_f32 v[80:81], v[166:167], v[68:69], v[80:81] op_sel:[0,0,0] op_sel_hi:[1,0,1]
    v_cvt_pk_bf16_f32 v76, v72, v73
    v_cvt_pk_bf16_f32 v82, v78, v79
    v_cvt_pk_bf16_f32 v77, v74, v75
    v_cvt_pk_bf16_f32 v83, v80, v81
    ds_write_b64 v14, v[76:77] offset:10240
    ds_write_b64 v15, v[82:83] offset:10240
    s_waitcnt lgkmcnt(0)
    s_barrier
    ds_read_b128 v[96:99], v16 offset:0
    ds_read_b128 v[100:103], v17 offset:0
    ds_read_b128 v[104:107], v16 offset:80
    ds_read_b128 v[108:111], v18 offset:0
    ds_read_b128 v[118:121], v16 offset:2560
    ds_read_b128 v[122:125], v17 offset:2560
    ds_read_b128 v[126:129], v16 offset:2640
    ds_read_b128 v[130:133], v18 offset:2560
    ds_read_b128 v[140:143], v16 offset:5120
    ds_read_b128 v[144:147], v17 offset:5120
    ds_read_b128 v[148:151], v16 offset:5200
    ds_read_b128 v[152:155], v18 offset:5120
    ds_read_b128 v[162:165], v16 offset:7680
    ds_read_b128 v[166:169], v17 offset:7680
    ds_read_b128 v[170:173], v16 offset:7760
    ds_read_b128 v[174:177], v18 offset:7680
    s_mov_b32 s90, 0x3ea52b5c
    s_lshl_b32 s15, s10, 3
    s_lshr_b32 s88, s3, 1
    s_add_u32 s15, s15, s88
    s_add_u32 s15, s15, 2
    s_lshl_b32 s89, s8, 8
    s_add_u32 s85, s89, s15
    s_mul_i32 s15, s15, 20480
    v_cmp_gt_u32 vcc, 8, v2
    s_nop 1
    v_cndmask_b32 v22, 0, -1, vcc
    v_not_b32 v23, v22
    s_waitcnt lgkmcnt(14)
    v_mfma_f32_16x16x32_bf16 v[112:115], v[96:99], v[100:103], 0
    s_waitcnt lgkmcnt(10)
    v_mfma_f32_16x16x32_bf16 v[134:137], v[118:121], v[122:125], 0
    s_waitcnt lgkmcnt(6)
    v_mfma_f32_16x16x32_bf16 v[156:159], v[140:143], v[144:147], 0
    s_waitcnt lgkmcnt(2)
    v_mfma_f32_16x16x32_bf16 v[178:181], v[162:165], v[166:169], 0
    v_mfma_f32_16x16x32_bf16 v[112:115], v[104:107], v[108:111], v[112:115]
    v_mfma_f32_16x16x32_bf16 v[134:137], v[126:129], v[130:133], v[134:137]
    v_mfma_f32_16x16x32_bf16 v[156:159], v[148:151], v[152:155], v[156:159]
    s_waitcnt lgkmcnt(0)
    v_mfma_f32_16x16x32_bf16 v[178:181], v[170:173], v[174:177], v[178:181]
    ds_read_b64_tr_b16 v[96:97], v19 offset:0
    ds_read_b64_tr_b16 v[98:99], v19 offset:80
    ds_read_b64_tr_b16 v[100:101], v19 offset:32
    ds_read_b64_tr_b16 v[102:103], v19 offset:112
    ds_read_b64_tr_b16 v[118:119], v19 offset:2560
    ds_read_b64_tr_b16 v[120:121], v19 offset:2640
    ds_read_b64_tr_b16 v[122:123], v19 offset:2592
    ds_read_b64_tr_b16 v[124:125], v19 offset:2672
    ds_read_b64_tr_b16 v[140:141], v19 offset:5120
    ds_read_b64_tr_b16 v[142:143], v19 offset:5200
    ds_read_b64_tr_b16 v[144:145], v19 offset:5152
    ds_read_b64_tr_b16 v[146:147], v19 offset:5232
    ds_read_b64_tr_b16 v[162:163], v19 offset:7680
    ds_read_b64_tr_b16 v[164:165], v19 offset:7760
    ds_read_b64_tr_b16 v[166:167], v19 offset:7712
    ds_read_b64_tr_b16 v[168:169], v19 offset:7792
    s_mov_b32 s62, s90
    s_mov_b32 s63, s90
    v_pk_fma_f32 v[112:113], v[112:113], s[62:63], v[24:25]
    v_pk_fma_f32 v[134:135], v[134:135], s[62:63], v[24:25]
    v_pk_fma_f32 v[156:157], v[156:157], s[62:63], v[24:25]
    v_pk_fma_f32 v[178:179], v[178:179], s[62:63], v[24:25]
    v_pk_fma_f32 v[114:115], v[114:115], s[62:63], v[26:27]
    v_pk_fma_f32 v[136:137], v[136:137], s[62:63], v[26:27]
    v_pk_fma_f32 v[158:159], v[158:159], s[62:63], v[26:27]
    v_pk_fma_f32 v[180:181], v[180:181], s[62:63], v[26:27]
    s_cmp_lg_u32 s85, 2
    s_cbranch_scc1 CL_start_29
    v_cmp_gt_u32 vcc, 2, v3
    v_mov_b32 v116, 0xf149f2ca
    s_nop 0
    v_cndmask_b32 v112, v112, v116, vcc
    v_cndmask_b32 v113, v113, v116, vcc
    v_cndmask_b32 v114, v114, v116, vcc
    v_cndmask_b32 v115, v115, v116, vcc
CL_start_29:
    v_max3_f32 v116, v112, v113, v114
    v_max3_f32 v138, v134, v135, v136
    v_max3_f32 v160, v156, v157, v158
    v_max3_f32 v182, v178, v179, v180
    v_max_f32 v116, v116, v115
    v_max_f32 v138, v138, v137
    v_max_f32 v160, v160, v159
    v_max_f32 v182, v182, v181
    v_mov_b32 v117, v116
    v_mov_b32 v139, v138
    v_mov_b32 v161, v160
    v_mov_b32 v183, v182
    v_permlane32_swap_b32 v116, v117
    v_permlane32_swap_b32 v138, v139
    v_permlane32_swap_b32 v160, v161
    v_permlane32_swap_b32 v182, v183
    v_max_f32 v116, v116, v117
    v_max_f32 v138, v138, v139
    v_max_f32 v160, v160, v161
    v_max_f32 v182, v182, v183
    v_mov_b32 v117, v116
    v_mov_b32 v139, v138
    v_mov_b32 v161, v160
    v_mov_b32 v183, v182
    v_permlane16_swap_b32 v116, v117
    v_permlane16_swap_b32 v138, v139
    v_permlane16_swap_b32 v160, v161
    v_permlane16_swap_b32 v182, v183
    v_max_f32 v116, v116, v117
    v_max_f32 v138, v138, v139
    v_max_f32 v160, v160, v161
    v_max_f32 v182, v182, v183
    v_pk_add_f32 v[112:113], v[112:113], v[116:117] op_sel_hi:[1,0] neg_lo:[0,1] neg_hi:[0,1]
    v_pk_add_f32 v[134:135], v[134:135], v[138:139] op_sel_hi:[1,0] neg_lo:[0,1] neg_hi:[0,1]
    v_pk_add_f32 v[156:157], v[156:157], v[160:161] op_sel_hi:[1,0] neg_lo:[0,1] neg_hi:[0,1]
    v_pk_add_f32 v[178:179], v[178:179], v[182:183] op_sel_hi:[1,0] neg_lo:[0,1] neg_hi:[0,1]
    v_pk_add_f32 v[114:115], v[114:115], v[116:117] op_sel_hi:[1,0] neg_lo:[0,1] neg_hi:[0,1]
    v_pk_add_f32 v[136:137], v[136:137], v[138:139] op_sel_hi:[1,0] neg_lo:[0,1] neg_hi:[0,1]
    v_pk_add_f32 v[158:159], v[158:159], v[160:161] op_sel_hi:[1,0] neg_lo:[0,1] neg_hi:[0,1]
    v_pk_add_f32 v[180:181], v[180:181], v[182:183] op_sel_hi:[1,0] neg_lo:[0,1] neg_hi:[0,1]
    v_exp_f32 v112, v112
    v_exp_f32 v134, v134
    v_exp_f32 v156, v156
    v_exp_f32 v178, v178
    v_exp_f32 v113, v113
    v_exp_f32 v135, v135
    v_exp_f32 v157, v157
    v_exp_f32 v179, v179
    v_exp_f32 v114, v114
    v_exp_f32 v136, v136
    v_exp_f32 v158, v158
    v_exp_f32 v180, v180
    v_exp_f32 v115, v115
    v_exp_f32 v137, v137
    v_exp_f32 v159, v159
    v_exp_f32 v181, v181
    v_cvt_pk_bf16_f32 v116, v112, v113
    v_cvt_pk_bf16_f32 v138, v134, v135
    v_cvt_pk_bf16_f32 v160, v156, v157
    v_cvt_pk_bf16_f32 v182, v178, v179
    v_cvt_pk_bf16_f32 v117, v114, v115
    v_cvt_pk_bf16_f32 v139, v136, v137
    v_cvt_pk_bf16_f32 v161, v158, v159
    v_cvt_pk_bf16_f32 v183, v180, v181
    v_and_b32 v104, v116, v22
    v_and_b32 v126, v138, v22
    v_and_b32 v148, v160, v22
    v_and_b32 v170, v182, v22
    v_and_b32 v105, v117, v22
    v_and_b32 v127, v139, v22
    v_and_b32 v149, v161, v22
    v_and_b32 v171, v183, v22
    v_and_b32 v106, v116, v23
    v_and_b32 v128, v138, v23
    v_and_b32 v150, v160, v23
    v_and_b32 v172, v182, v23
    v_and_b32 v107, v117, v23
    v_and_b32 v129, v139, v23
    v_and_b32 v151, v161, v23
    v_and_b32 v173, v183, v23
    s_mov_b32 s88, 0x3f803f80
    v_mov_b32 v248, s88
    v_mov_b32 v249, s88
    v_mov_b32 v250, s88
    v_mov_b32 v251, s88
    s_nop 1
    v_mfma_f32_16x16x32_bf16 v[112:115], v[248:251], v[104:107], 0
    s_waitcnt lgkmcnt(14)
    v_mfma_f32_16x16x32_bf16 v[108:111], v[96:99], v[104:107], 0
    v_mfma_f32_16x16x32_bf16 v[134:137], v[248:251], v[126:129], 0
    s_waitcnt lgkmcnt(10)
    v_mfma_f32_16x16x32_bf16 v[130:133], v[118:121], v[126:129], 0
    v_mfma_f32_16x16x32_bf16 v[156:159], v[248:251], v[148:151], 0
    s_waitcnt lgkmcnt(6)
    v_mfma_f32_16x16x32_bf16 v[152:155], v[140:143], v[148:151], 0
    v_mfma_f32_16x16x32_bf16 v[178:181], v[248:251], v[170:173], 0
    s_waitcnt lgkmcnt(2)
    v_mfma_f32_16x16x32_bf16 v[174:177], v[162:165], v[170:173], 0
    v_mfma_f32_16x16x32_bf16 v[96:99], v[100:103], v[104:107], 0
    v_mfma_f32_16x16x32_bf16 v[118:121], v[122:125], v[126:129], 0
    v_mfma_f32_16x16x32_bf16 v[140:143], v[144:147], v[148:151], 0
    s_waitcnt lgkmcnt(0)
    v_mfma_f32_16x16x32_bf16 v[162:165], v[166:169], v[170:173], 0
    v_rcp_f32 v116, v112
    v_rcp_f32 v138, v134
    v_rcp_f32 v160, v156
    v_rcp_f32 v182, v178
    v_pk_mul_f32 v[108:109], v[108:109], v[116:117] op_sel_hi:[1,0]
    v_pk_mul_f32 v[130:131], v[130:131], v[138:139] op_sel_hi:[1,0]
    v_pk_mul_f32 v[152:153], v[152:153], v[160:161] op_sel_hi:[1,0]
    v_pk_mul_f32 v[174:175], v[174:175], v[182:183] op_sel_hi:[1,0]
    v_pk_mul_f32 v[110:111], v[110:111], v[116:117] op_sel_hi:[1,0]
    v_pk_mul_f32 v[132:133], v[132:133], v[138:139] op_sel_hi:[1,0]
    v_pk_mul_f32 v[154:155], v[154:155], v[160:161] op_sel_hi:[1,0]
    v_pk_mul_f32 v[176:177], v[176:177], v[182:183] op_sel_hi:[1,0]
    v_pk_mul_f32 v[96:97], v[96:97], v[116:117] op_sel_hi:[1,0]
    v_pk_mul_f32 v[118:119], v[118:119], v[138:139] op_sel_hi:[1,0]
    v_pk_mul_f32 v[140:141], v[140:141], v[160:161] op_sel_hi:[1,0]
    v_pk_mul_f32 v[162:163], v[162:163], v[182:183] op_sel_hi:[1,0]
    v_pk_mul_f32 v[98:99], v[98:99], v[116:117] op_sel_hi:[1,0]
    v_pk_mul_f32 v[120:121], v[120:121], v[138:139] op_sel_hi:[1,0]
    v_pk_mul_f32 v[142:143], v[142:143], v[160:161] op_sel_hi:[1,0]
    v_pk_mul_f32 v[164:165], v[164:165], v[182:183] op_sel_hi:[1,0]
    v_cvt_pk_bf16_f32 v104, v108, v109
    v_cvt_pk_bf16_f32 v105, v110, v111
    v_cvt_pk_bf16_f32 v126, v130, v131
    v_cvt_pk_bf16_f32 v127, v132, v133
    v_cvt_pk_bf16_f32 v148, v152, v153
    v_cvt_pk_bf16_f32 v149, v154, v155
    v_cvt_pk_bf16_f32 v170, v174, v175
    v_cvt_pk_bf16_f32 v171, v176, v177
    v_cvt_pk_bf16_f32 v106, v96, v97
    v_cvt_pk_bf16_f32 v107, v98, v99
    v_cvt_pk_bf16_f32 v128, v118, v119
    v_cvt_pk_bf16_f32 v129, v120, v121
    v_cvt_pk_bf16_f32 v150, v140, v141
    v_cvt_pk_bf16_f32 v151, v142, v143
    v_cvt_pk_bf16_f32 v172, v162, v163
    v_cvt_pk_bf16_f32 v173, v164, v165
    s_add_u32 s88, s15, 0
    buffer_store_dwordx2 v[104:105], v20, s[36:39], s88 offen
    buffer_store_dwordx2 v[106:107], v21, s[36:39], s88 offen
    s_add_u32 s89, s15, 40960
    buffer_store_dwordx2 v[126:127], v20, s[36:39], s89 offen
    buffer_store_dwordx2 v[128:129], v21, s[36:39], s89 offen
    s_add_u32 s88, s15, 81920
    buffer_store_dwordx2 v[148:149], v20, s[36:39], s88 offen
    buffer_store_dwordx2 v[150:151], v21, s[36:39], s88 offen
    s_add_u32 s89, s15, 122880
    buffer_store_dwordx2 v[170:171], v20, s[36:39], s89 offen
    buffer_store_dwordx2 v[172:173], v21, s[36:39], s89 offen
    s_waitcnt vmcnt(0) lgkmcnt(0)
    s_barrier
    s_cmp_lg_u32 s3, 0
    s_cbranch_scc1 CL_xb_skip_30
    v_mov_b32 v22, 1
    s_lshl_b32 s88, s9, 2
    v_mov_b32 v23, 0
    v_cmp_eq_u32 vcc, 0, v1
    s_nop 0
    s_and_saveexec_b64 s[86:87], vcc
    buffer_store_dword v22, v23, s[52:55], s88 offen offset:512
    s_mov_b64 exec, s[86:87]
CL_xb_skip_30:
    v_lshlrev_b32 v160, 16, v36
    v_and_b32 v161, 0xffff0000, v36
    v_lshlrev_b32 v162, 16, v37
    v_and_b32 v163, 0xffff0000, v37
    v_lshlrev_b32 v164, 16, v38
    v_and_b32 v165, 0xffff0000, v38
    v_lshlrev_b32 v166, 16, v39
    v_and_b32 v167, 0xffff0000, v39
    v_lshlrev_b32 v168, 16, v40
    v_and_b32 v169, 0xffff0000, v40
    v_lshlrev_b32 v170, 16, v41
    v_and_b32 v171, 0xffff0000, v41
    v_lshlrev_b32 v172, 16, v42
    v_and_b32 v173, 0xffff0000, v42
    v_lshlrev_b32 v174, 16, v43
    v_and_b32 v175, 0xffff0000, v43
    v_lshlrev_b32 v176, 16, v44
    v_and_b32 v177, 0xffff0000, v44
    v_lshlrev_b32 v178, 16, v45
    v_and_b32 v179, 0xffff0000, v45
    v_lshlrev_b32 v180, 16, v46
    v_and_b32 v181, 0xffff0000, v46
    v_lshlrev_b32 v182, 16, v47
    v_and_b32 v183, 0xffff0000, v47
    s_cmp_lg_u32 s3, 0
    s_cbranch_scc1 CL_xb_skip_31
    v_and_b32 v23, 31, v1
    v_lshlrev_b32 v23, 2, v23
    s_mov_b32 s89, 1048576
CL_xb_loop_32:
    buffer_load_dword v22, v23, s[52:55], 0 offen offset:512 sc1
    s_waitcnt vmcnt(0)
    v_cmp_eq_u32 vcc, 0, v22
    s_cbranch_vccz CL_xb_done_33
    s_sub_u32 s89, s89, 1
    s_cmp_eq_u32 s89, 0
    s_cbranch_scc1 L_k2_end
    s_branch CL_xb_loop_32
CL_xb_done_33:
CL_xb_skip_31:
    s_barrier
    s_add_u32 s14, s98, s92
    s_mul_i32 s15, s3, 3072
    v_add_u32 v96, 20480, v5
    v_add_u32 v97, 40960, v5
    s_add_u32 s90, s14, 0
    s_add_u32 m0, s15, 4096
    s_nop 0
    buffer_load_dwordx4 v5, s[36:39], s90 offen sc1 lds
    s_add_u32 m0, s15, 5120
    s_nop 0
    buffer_load_dwordx4 v96, s[36:39], s90 offen sc1 lds
    s_add_u32 m0, s15, 6144
    s_nop 0
    buffer_load_dwordx4 v97, s[36:39], s90 offen sc1 lds
    s_add_u32 s90, s14, 4096
    s_add_u32 m0, s15, 16384
    s_nop 0
    buffer_load_dwordx4 v5, s[36:39], s90 offen sc1 lds
    s_add_u32 m0, s15, 17408
    s_nop 0
    buffer_load_dwordx4 v96, s[36:39], s90 offen sc1 lds
    s_add_u32 m0, s15, 18432
    s_nop 0
    buffer_load_dwordx4 v97, s[36:39], s90 offen sc1 lds
    s_add_u32 s90, s14, 8192
    s_add_u32 m0, s15, 28672
    s_nop 0
    buffer_load_dwordx4 v5, s[36:39], s90 offen sc1 lds
    s_add_u32 m0, s15, 29696
    s_nop 0
    buffer_load_dwordx4 v96, s[36:39], s90 offen sc1 lds
    s_add_u32 m0, s15, 30720
    s_nop 0
    buffer_load_dwordx4 v97, s[36:39], s90 offen sc1 lds
    s_waitcnt vmcnt(6)
    s_barrier
    ds_read_b128 v[72:75], v5 offset:4096
    ds_read_b128 v[76:79], v5 offset:5120
    ds_read_b128 v[80:83], v5 offset:6144
    ds_read_b128 v[84:87], v5 offset:7168
    s_add_u32 s90, s14, 12288
    s_add_u32 m0, s15, 40960
    s_waitcnt lgkmcnt(3)
    v_mfma_f32_16x16x32_bf16 v[160:163], a[160:163], v[72:75], v[160:163]
    ds_read_b128 v[88:91], v5 offset:8192
    v_mfma_f32_16x16x32_bf16 v[164:167], a[164:167], v[72:75], v[164:167]
    buffer_load_dwordx4 v5, s[36:39], s90 offen sc1 lds
    s_waitcnt lgkmcnt(3)
    v_mfma_f32_16x16x32_bf16 v[168:171], a[160:163], v[76:79], v[168:171]
    ds_read_b128 v[92:95], v5 offset:9216
    v_mfma_f32_16x16x32_bf16 v[172:175], a[164:167], v[76:79], v[172:175]
    s_add_u32 m0, s15, 41984
    s_waitcnt lgkmcnt(3)
    v_mfma_f32_16x16x32_bf16 v[176:179], a[160:163], v[80:83], v[176:179]
    ds_read_b128 v[72:75], v5 offset:10240
    v_mfma_f32_16x16x32_bf16 v[180:183], a[164:167], v[80:83], v[180:183]
    buffer_load_dwordx4 v96, s[36:39], s90 offen sc1 lds
    s_waitcnt lgkmcnt(3)
    v_mfma_f32_16x16x32_bf16 v[160:163], a[168:171], v[84:87], v[160:163]
    ds_read_b128 v[76:79], v5 offset:11264
    v_mfma_f32_16x16x32_bf16 v[164:167], a[172:175], v[84:87], v[164:167]
    s_add_u32 m0, s15, 43008
    s_waitcnt lgkmcnt(3)
    v_mfma_f32_16x16x32_bf16 v[168:171], a[168:171], v[88:91], v[168:171]
    ds_read_b128 v[80:83], v5 offset:12288
    v_mfma_f32_16x16x32_bf16 v[172:175], a[172:175], v[88:91], v[172:175]
    buffer_load_dwordx4 v97, s[36:39], s90 offen sc1 lds
    s_waitcnt lgkmcnt(3)
    v_mfma_f32_16x16x32_bf16 v[176:179], a[168:171], v[92:95], v[176:179]
    ds_read_b128 v[84:87], v5 offset:13312
    v_mfma_f32_16x16x32_bf16 v[180:183], a[172:175], v[92:95], v[180:183]
    s_add_u32 s90, s14, 16384
    s_add_u32 m0, s15, 53248
    s_waitcnt lgkmcnt(3)
    v_mfma_f32_16x16x32_bf16 v[160:163], a[176:179], v[72:75], v[160:163]
    ds_read_b128 v[88:91], v5 offset:14336
    v_mfma_f32_16x16x32_bf16 v[164:167], a[180:183], v[72:75], v[164:167]
    buffer_load_dwordx4 v5, s[36:39], s90 offen sc1 lds
    s_waitcnt lgkmcnt(3)
    v_mfma_f32_16x16x32_bf16 v[168:171], a[176:179], v[76:79], v[168:171]
    ds_read_b128 v[92:95], v5 offset:15360
    v_mfma_f32_16x16x32_bf16 v[172:175], a[180:183], v[76:79], v[172:175]
    s_add_u32 m0, s15, 54272
    s_waitcnt lgkmcnt(3)
    v_mfma_f32_16x16x32_bf16 v[176:179], a[176:179], v[80:83], v[176:179]
    s_waitcnt vmcnt(7)
    s_barrier
    ds_read_b128 v[72:75], v5 offset:16384
    v_mfma_f32_16x16x32_bf16 v[180:183], a[180:183], v[80:83], v[180:183]
    buffer_load_dwordx4 v96, s[36:39], s90 offen sc1 lds
    s_waitcnt lgkmcnt(3)
    v_mfma_f32_16x16x32_bf16 v[160:163], a[184:187], v[84:87], v[160:163]
    ds_read_b128 v[76:79], v5 offset:17408
    v_mfma_f32_16x16x32_bf16 v[164:167], a[188:191], v[84:87], v[164:167]
    s_add_u32 m0, s15, 55296
    s_waitcnt lgkmcnt(3)
    v_mfma_f32_16x16x32_bf16 v[168:171], a[184:187], v[88:91], v[168:171]
    ds_read_b128 v[80:83], v5 offset:18432
    v_mfma_f32_16x16x32_bf16 v[172:175], a[188:191], v[88:91], v[172:175]
    buffer_load_dwordx4 v97, s[36:39], s90 offen sc1 lds
    s_waitcnt lgkmcnt(3)
    v_mfma_f32_16x16x32_bf16 v[176:179], a[184:187], v[92:95], v[176:179]
    ds_read_b128 v[84:87], v5 offset:19456
    v_mfma_f32_16x16x32_bf16 v[180:183], a[188:191], v[92:95], v[180:183]
    s_waitcnt lgkmcnt(3)
    v_mfma_f32_16x16x32_bf16 v[160:163], a[192:195], v[72:75], v[160:163]
    ds_read_b128 v[88:91], v5 offset:20480
    v_mfma_f32_16x16x32_bf16 v[164:167], a[196:199], v[72:75], v[164:167]
    s_waitcnt lgkmcnt(3)
    v_mfma_f32_16x16x32_bf16 v[168:171], a[192:195], v[76:79], v[168:171]
    ds_read_b128 v[92:95], v5 offset:21504
    v_mfma_f32_16x16x32_bf16 v[172:175], a[196:199], v[76:79], v[172:175]
    s_waitcnt lgkmcnt(3)
    v_mfma_f32_16x16x32_bf16 v[176:179], a[192:195], v[80:83], v[176:179]
    ds_read_b128 v[72:75], v5 offset:22528
    v_mfma_f32_16x16x32_bf16 v[180:183], a[196:199], v[80:83], v[180:183]
    s_waitcnt lgkmcnt(3)
    v_mfma_f32_16x16x32_bf16 v[160:163], a[200:203], v[84:87], v[160:163]
    ds_read_b128 v[76:79], v5 offset:23552
    v_mfma_f32_16x16x32_bf16 v[164:167], a[204:207], v[84:87], v[164:167]
    s_waitcnt lgkmcnt(3)
    v_mfma_f32_16x16x32_bf16 v[168:171], a[200:203], v[88:91], v[168:171]
    ds_read_b128 v[80:83], v5 offset:24576
    v_mfma_f32_16x16x32_bf16 v[172:175], a[204:207], v[88:91], v[172:175]
    s_waitcnt lgkmcnt(3)
    v_mfma_f32_16x16x32_bf16 v[176:179], a[200:203], v[92:95], v[176:179]
    ds_read_b128 v[84:87], v5 offset:25600
    v_mfma_f32_16x16x32_bf16 v[180:183], a[204:207], v[92:95], v[180:183]
    s_waitcnt lgkmcnt(3)
    v_mfma_f32_16x16x32_bf16 v[160:163], a[208:211], v[72:75], v[160:163]
    ds_read_b128 v[88:91], v5 offset:26624
    v_mfma_f32_16x16x32_bf16 v[164:167], a[212:215], v[72:75], v[164:167]
    s_waitcnt lgkmcnt(3)
    v_mfma_f32_16x16x32_bf16 v[168:171], a[208:211], v[76:79], v[168:171]
    ds_read_b128 v[92:95], v5 offset:27648
    v_mfma_f32_16x16x32_bf16 v[172:175], a[212:215], v[76:79], v[172:175]
    s_waitcnt lgkmcnt(3)
    v_mfma_f32_16x16x32_bf16 v[176:179], a[208:211], v[80:83], v[176:179]
    s_waitcnt vmcnt(6)
    s_barrier
    ds_read_b128 v[72:75], v5 offset:28672
    v_mfma_f32_16x16x32_bf16 v[180:183], a[212:215], v[80:83], v[180:183]
    s_waitcnt lgkmcnt(3)
    v_mfma_f32_16x16x32_bf16 v[160:163], a[216:219], v[84:87], v[160:163]
    ds_read_b128 v[76:79], v5 offset:29696
    v_mfma_f32_16x16x32_bf16 v[164:167], a[220:223], v[84:87], v[164:167]
    s_waitcnt lgkmcnt(3)
    v_mfma_f32_16x16x32_bf16 v[168:171], a[216:219], v[88:91], v[168:171]
    ds_read_b128 v[80:83], v5 offset:30720
    v_mfma_f32_16x16x32_bf16 v[172:175], a[220:223], v[88:91], v[172:175]
    s_waitcnt lgkmcnt(3)
    v_mfma_f32_16x16x32_bf16 v[176:179], a[216:219], v[92:95], v[176:179]
    ds_read_b128 v[84:87], v5 offset:31744
    v_mfma_f32_16x16x32_bf16 v[180:183], a[220:223], v[92:95], v[180:183]
    s_waitcnt lgkmcnt(3)
    v_mfma_f32_16x16x32_bf16 v[160:163], a[224:227], v[72:75], v[160:163]
    ds_read_b128 v[88:91], v5 offset:32768
    v_mfma_f32_16x16x32_bf16 v[164:167], a[228:231], v[72:75], v[164:167]
    s_waitcnt lgkmcnt(3)
    v_mfma_f32_16x16x32_bf16 v[168:171], a[224:227], v[76:79], v[168:171]
    ds_read_b128 v[92:95], v5 offset:33792
    v_mfma_f32_16x16x32_bf16 v[172:175], a[228:231], v[76:79], v[172:175]
    s_waitcnt lgkmcnt(3)
    v_mfma_f32_16x16x32_bf16 v[176:179], a[224:227], v[80:83], v[176:179]
    ds_read_b128 v[72:75], v5 offset:34816
    v_mfma_f32_16x16x32_bf16 v[180:183], a[228:231], v[80:83], v[180:183]
    s_waitcnt lgkmcnt(3)
    v_mfma_f32_16x16x32_bf16 v[160:163], a[232:235], v[84:87], v[160:163]
    ds_read_b128 v[76:79], v5 offset:35840
    v_mfma_f32_16x16x32_bf16 v[164:167], a[236:239], v[84:87], v[164:167]
    s_waitcnt lgkmcnt(3)
    v_mfma_f32_16x16x32_bf16 v[168:171], a[232:235], v[88:91], v[168:171]
    ds_read_b128 v[80:83], v5 offset:36864
    v_mfma_f32_16x16x32_bf16 v[172:175], a[236:239], v[88:91], v[172:175]
    s_waitcnt lgkmcnt(3)
    v_mfma_f32_16x16x32_bf16 v[176:179], a[232:235], v[92:95], v[176:179]
    ds_read_b128 v[84:87], v5 offset:37888
    v_mfma_f32_16x16x32_bf16 v[180:183], a[236:239], v[92:95], v[180:183]
    s_waitcnt lgkmcnt(3)
    v_mfma_f32_16x16x32_bf16 v[160:163], a[240:243], v[72:75], v[160:163]
    ds_read_b128 v[88:91], v5 offset:38912
    v_mfma_f32_16x16x32_bf16 v[164:167], a[244:247], v[72:75], v[164:167]
    s_waitcnt lgkmcnt(3)
    v_mfma_f32_16x16x32_bf16 v[168:171], a[240:243], v[76:79], v[168:171]
    ds_read_b128 v[92:95], v5 offset:39936
    v_mfma_f32_16x16x32_bf16 v[172:175], a[244:247], v[76:79], v[172:175]
    s_waitcnt lgkmcnt(3)
    v_mfma_f32_16x16x32_bf16 v[176:179], a[240:243], v[80:83], v[176:179]
    s_waitcnt vmcnt(3)
    s_barrier
    ds_read_b128 v[72:75], v5 offset:40960
    v_mfma_f32_16x16x32_bf16 v[180:183], a[244:247], v[80:83], v[180:183]
    s_waitcnt lgkmcnt(3)
    v_mfma_f32_16x16x32_bf16 v[160:163], a[248:251], v[84:87], v[160:163]
    ds_read_b128 v[76:79], v5 offset:41984
    v_mfma_f32_16x16x32_bf16 v[164:167], a[252:255], v[84:87], v[164:167]
    s_waitcnt lgkmcnt(3)
    v_mfma_f32_16x16x32_bf16 v[168:171], a[248:251], v[88:91], v[168:171]
    ds_read_b128 v[80:83], v5 offset:43008
    v_mfma_f32_16x16x32_bf16 v[172:175], a[252:255], v[88:91], v[172:175]
    s_waitcnt lgkmcnt(3)
    v_mfma_f32_16x16x32_bf16 v[176:179], a[248:251], v[92:95], v[176:179]
    ds_read_b128 v[84:87], v5 offset:44032
    v_mfma_f32_16x16x32_bf16 v[180:183], a[252:255], v[92:95], v[180:183]
    s_waitcnt lgkmcnt(3)
    v_mfma_f32_16x16x32_bf16 v[160:163], v[184:187], v[72:75], v[160:163]
    ds_read_b128 v[88:91], v5 offset:45056
    v_mfma_f32_16x16x32_bf16 v[164:167], v[188:191], v[72:75], v[164:167]
    s_waitcnt lgkmcnt(3)
    v_mfma_f32_16x16x32_bf16 v[168:171], v[184:187], v[76:79], v[168:171]
    ds_read_b128 v[92:95], v5 offset:46080
    v_mfma_f32_16x16x32_bf16 v[172:175], v[188:191], v[76:79], v[172:175]
    s_waitcnt lgkmcnt(3)
    v_mfma_f32_16x16x32_bf16 v[176:179], v[184:187], v[80:83], v[176:179]
    ds_read_b128 v[72:75], v5 offset:47104
    v_mfma_f32_16x16x32_bf16 v[180:183], v[188:191], v[80:83], v[180:183]
    s_waitcnt lgkmcnt(3)
    v_mfma_f32_16x16x32_bf16 v[160:163], v[192:195], v[84:87], v[160:163]
    ds_read_b128 v[76:79], v5 offset:48128
    v_mfma_f32_16x16x32_bf16 v[164:167], v[196:199], v[84:87], v[164:167]
    s_waitcnt lgkmcnt(3)
    v_mfma_f32_16x16x32_bf16 v[168:171], v[192:195], v[88:91], v[168:171]
    ds_read_b128 v[80:83], v5 offset:49152
    v_mfma_f32_16x16x32_bf16 v[172:175], v[196:199], v[88:91], v[172:175]
    s_waitcnt lgkmcnt(3)
    v_mfma_f32_16x16x32_bf16 v[176:179], v[192:195], v[92:95], v[176:179]
    ds_read_b128 v[84:87], v5 offset:50176
    v_mfma_f32_16x16x32_bf16 v[180:183], v[196:199], v[92:95], v[180:183]
    s_waitcnt lgkmcnt(3)
    v_mfma_f32_16x16x32_bf16 v[160:163], v[200:203], v[72:75], v[160:163]
    ds_read_b128 v[88:91], v5 offset:51200
    v_mfma_f32_16x16x32_bf16 v[164:167], v[204:207], v[72:75], v[164:167]
    s_waitcnt lgkmcnt(3)
    v_mfma_f32_16x16x32_bf16 v[168:171], v[200:203], v[76:79], v[168:171]
    ds_read_b128 v[92:95], v5 offset:52224
    v_mfma_f32_16x16x32_bf16 v[172:175], v[204:207], v[76:79], v[172:175]
    s_waitcnt lgkmcnt(3)
    v_mfma_f32_16x16x32_bf16 v[176:179], v[200:203], v[80:83], v[176:179]
    s_waitcnt vmcnt(0)
    s_barrier
    ds_read_b128 v[72:75], v5 offset:53248
    v_mfma_f32_16x16x32_bf16 v[180:183], v[204:207], v[80:83], v[180:183]
    s_waitcnt lgkmcnt(3)
    v_mfma_f32_16x16x32_bf16 v[160:163], v[208:211], v[84:87], v[160:163]
    ds_read_b128 v[76:79], v5 offset:54272
    v_mfma_f32_16x16x32_bf16 v[164:167], v[212:215], v[84:87], v[164:167]
    s_waitcnt lgkmcnt(3)
    v_mfma_f32_16x16x32_bf16 v[168:171], v[208:211], v[88:91], v[168:171]
    ds_read_b128 v[80:83], v5 offset:55296
    v_mfma_f32_16x16x32_bf16 v[172:175], v[212:215], v[88:91], v[172:175]
    s_waitcnt lgkmcnt(3)
    v_mfma_f32_16x16x32_bf16 v[176:179], v[208:211], v[92:95], v[176:179]
    ds_read_b128 v[84:87], v5 offset:56320
    v_mfma_f32_16x16x32_bf16 v[180:183], v[212:215], v[92:95], v[180:183]
    s_waitcnt lgkmcnt(3)
    v_mfma_f32_16x16x32_bf16 v[160:163], v[216:219], v[72:75], v[160:163]
    ds_read_b128 v[88:91], v5 offset:57344
    v_mfma_f32_16x16x32_bf16 v[164:167], v[220:223], v[72:75], v[164:167]
    s_waitcnt lgkmcnt(3)
    v_mfma_f32_16x16x32_bf16 v[168:171], v[216:219], v[76:79], v[168:171]
    ds_read_b128 v[92:95], v5 offset:58368
    v_mfma_f32_16x16x32_bf16 v[172:175], v[220:223], v[76:79], v[172:175]
    s_waitcnt lgkmcnt(3)
    v_mfma_f32_16x16x32_bf16 v[176:179], v[216:219], v[80:83], v[176:179]
    ds_read_b128 v[72:75], v5 offset:59392
    v_mfma_f32_16x16x32_bf16 v[180:183], v[220:223], v[80:83], v[180:183]
    s_waitcnt lgkmcnt(3)
    v_mfma_f32_16x16x32_bf16 v[160:163], v[224:227], v[84:87], v[160:163]
    ds_read_b128 v[76:79], v5 offset:60416
    v_mfma_f32_16x16x32_bf16 v[164:167], v[228:231], v[84:87], v[164:167]
    s_waitcnt lgkmcnt(3)
    v_mfma_f32_16x16x32_bf16 v[168:171], v[224:227], v[88:91], v[168:171]
    ds_read_b128 v[80:83], v5 offset:61440
    v_mfma_f32_16x16x32_bf16 v[172:175], v[228:231], v[88:91], v[172:175]
    s_waitcnt lgkmcnt(3)
    v_mfma_f32_16x16x32_bf16 v[176:179], v[224:227], v[92:95], v[176:179]
    ds_read_b128 v[84:87], v5 offset:62464
    v_mfma_f32_16x16x32_bf16 v[180:183], v[228:231], v[92:95], v[180:183]
    s_waitcnt lgkmcnt(3)
    v_mfma_f32_16x16x32_bf16 v[160:163], v[232:235], v[72:75], v[160:163]
    ds_read_b128 v[88:91], v5 offset:63488
    v_mfma_f32_16x16x32_bf16 v[164:167], v[236:239], v[72:75], v[164:167]
    s_waitcnt lgkmcnt(3)
    v_mfma_f32_16x16x32_bf16 v[168:171], v[232:235], v[76:79], v[168:171]
    ds_read_b128 v[92:95], v5 offset:64512
    v_mfma_f32_16x16x32_bf16 v[172:175], v[236:239], v[76:79], v[172:175]
    s_waitcnt lgkmcnt(3)
    v_mfma_f32_16x16x32_bf16 v[176:179], v[232:235], v[80:83], v[176:179]
    v_mfma_f32_16x16x32_bf16 v[180:183], v[236:239], v[80:83], v[180:183]
    s_waitcnt lgkmcnt(2)
    v_mfma_f32_16x16x32_bf16 v[160:163], v[240:243], v[84:87], v[160:163]
    v_mfma_f32_16x16x32_bf16 v[164:167], v[244:247], v[84:87], v[164:167]
    s_waitcnt lgkmcnt(1)
    v_mfma_f32_16x16x32_bf16 v[168:171], v[240:243], v[88:91], v[168:171]
    v_mfma_f32_16x16x32_bf16 v[172:175], v[244:247], v[88:91], v[172:175]
    s_waitcnt lgkmcnt(0)
    v_mfma_f32_16x16x32_bf16 v[176:179], v[240:243], v[92:95], v[176:179]
    v_mfma_f32_16x16x32_bf16 v[180:183], v[244:247], v[92:95], v[180:183]
    s_mov_b32 s60, s6
    s_mov_b32 s61, s7
    s_mov_b32 s62, 2621440
    s_mov_b32 s63, 0x20000
    v_mul_u32_u24 v22, 272, v4
    v_lshl_add_u32 v22, v3, 3, v22
    s_lshl_b32 s88, s3, 6
    v_add_u32 v22, s88, v22
    v_cvt_pk_bf16_f32 v208, v160, v161
    v_cvt_pk_bf16_f32 v209, v162, v163
    v_cvt_pk_bf16_f32 v210, v164, v165
    v_cvt_pk_bf16_f32 v211, v166, v167
    v_cvt_pk_bf16_f32 v212, v168, v169
    v_cvt_pk_bf16_f32 v213, v170, v171
    v_cvt_pk_bf16_f32 v214, v172, v173
    v_cvt_pk_bf16_f32 v215, v174, v175
    v_cvt_pk_bf16_f32 v216, v176, v177
    v_cvt_pk_bf16_f32 v217, v178, v179
    v_cvt_pk_bf16_f32 v218, v180, v181
    v_cvt_pk_bf16_f32 v219, v182, v183
    v_lshrrev_b32 v184, 4, v0
    v_mul_u32_u24 v185, 272, v184
    v_lshl_add_u32 v185, v2, 4, v185
    v_mul_u32_u24 v186, 1280, v184
    v_lshl_add_u32 v186, v2, 4, v186
    s_mul_i32 s88, s12, 3
    s_lshl_b32 s89, s8, 4
    s_add_u32 s89, s89, s88
    s_sub_u32 s89, s89, 1
    s_mul_i32 s89, s89, 20480
    s_lshl_b32 s90, s13, 8
    s_add_u32 s89, s89, s90
    s_waitcnt lgkmcnt(0)
    s_barrier
    ds_write_b64 v22, v[208:209] offset:4096
    ds_write_b64 v22, v[210:211] offset:4128
    ds_write_b64 v22, v[212:213] offset:8448
    ds_write_b64 v22, v[214:215] offset:8480
    ds_write_b64 v22, v[216:217] offset:12800
    ds_write_b64 v22, v[218:219] offset:12832
    s_waitcnt lgkmcnt(0)
    s_barrier
    ds_read_b128 v[192:195], v185 offset:4096
    ds_read_b128 v[196:199], v185 offset:8448
    ds_read_b128 v[200:203], v185 offset:12800
    s_add_u32 s90, s88, 4294967295
    s_cmp_lt_u32 s90, 16
    s_cselect_b32 s90, s89, 0x40000000
    s_waitcnt lgkmcnt(2)
    buffer_store_dwordx4 v[192:195], v186, s[60:63], s90 offen sc1
    s_add_u32 s89, s89, 20480
    s_add_u32 s90, s88, 0
    s_cmp_lt_u32 s90, 16
    s_cselect_b32 s90, s89, 0x40000000
    s_waitcnt lgkmcnt(1)
    buffer_store_dwordx4 v[196:199], v186, s[60:63], s90 offen sc1
    s_add_u32 s89, s89, 20480
    s_add_u32 s90, s88, 1
    s_cmp_lt_u32 s90, 16
    s_cselect_b32 s90, s89, 0x40000000
    s_waitcnt lgkmcnt(0)
    buffer_store_dwordx4 v[200:203], v186, s[60:63], s90 offen sc1
    s_add_u32 s89, s89, 20480
L_k2_end:
    s_endpgm
CL_sf_slow_13:
    s_mov_b32 s89, 1048576
CL_sf_slow_13_loop:
    buffer_load_dword v61, v62, s[52:55], s90 offen sc1
    s_waitcnt vmcnt(0)
    v_cmp_eq_u32 vcc, 0, v61
    s_nop 1
    s_cbranch_vccz CL_sf_back_14
    s_sub_u32 s89, s89, 1
    s_cmp_eq_u32 s89, 0
    s_cbranch_scc1 L_k2_end
    s_branch CL_sf_slow_13_loop

CL_p3_slow_27:
    s_mov_b32 s89, 1048576
CL_p3_slow_27_loop:
    buffer_load_dwordx2 v[48:49], v60, s[40:43], s85 offen offset:0 sc1
    buffer_load_dwordx2 v[50:51], v60, s[40:43], s85 offen offset:128 sc1
    buffer_load_dwordx2 v[52:53], v60, s[40:43], s85 offen offset:256 sc1
    buffer_load_dwordx2 v[54:55], v60, s[40:43], s85 offen offset:384 sc1
    buffer_load_dwordx2 v[56:57], v60, s[40:43], s85 offen offset:512 sc1
    s_waitcnt vmcnt(0)
    v_and_b32 v58, v49, v51
    v_and_b32 v59, v53, v55
    v_and_b32 v58, v58, v57
    v_and_b32 v58, v58, v59
    v_cmp_gt_u32 vcc, 144, v0
    s_nop 1
    s_mov_b64 s[86:87], vcc
    v_cmp_le_i32 vcc, 0, v58
    s_nop 1
    s_and_b64 vcc, vcc, s[86:87]
    s_cbranch_vccz CL_p3_back_28
    s_sub_u32 s89, s89, 1
    s_cmp_eq_u32 s89, 0
    s_cbranch_scc1 L_k2_end
    s_branch CL_p3_slow_27_loop

code_end:
.section .rodata,"a"
.p2align 6
.amdhsa_kernel pre_kernel
  .amdhsa_next_free_vgpr 256
  .amdhsa_next_free_sgpr 102
  .amdhsa_accum_offset 256
  .amdhsa_group_segment_fixed_size 0
  .amdhsa_kernarg_size 96
  .amdhsa_user_sgpr_count 2
  .amdhsa_user_sgpr_kernarg_segment_ptr 1
  .amdhsa_system_sgpr_workgroup_id_x 1
  .amdhsa_float_denorm_mode_32 3
.end_amdhsa_kernel
.p2align 6
.amdhsa_kernel conv_kernel
  .amdhsa_next_free_vgpr 512
  .amdhsa_next_free_sgpr 102
  .amdhsa_accum_offset 256
  .amdhsa_group_segment_fixed_size 0
  .amdhsa_kernarg_size 96
  .amdhsa_user_sgpr_count 2
  .amdhsa_user_sgpr_kernarg_segment_ptr 1
  .amdhsa_system_sgpr_workgroup_id_x 1
  .amdhsa_float_denorm_mode_32 3
.end_amdhsa_kernel
.p2align 6
.amdhsa_kernel interleave_layers__ssm_conv_h3__sliding_local_dilated__prompt_kernel
  .amdhsa_next_free_vgpr 512
  .amdhsa_next_free_sgpr 102
  .amdhsa_accum_offset 256
  .amdhsa_group_segment_fixed_size 0
  .amdhsa_kernarg_size 96
  .amdhsa_user_sgpr_count 2
  .amdhsa_user_sgpr_kernarg_segment_ptr 1
  .amdhsa_system_sgpr_workgroup_id_x 1
  .amdhsa_float_denorm_mode_32 3
.end_amdhsa_kernel
```
